```python
import torch

def _softmax(x, axis=-1):
    return torch.softmax(x, dim=axis)
def _gelu(x):
    return torch.nn.functional.gelu(x, approximate="tanh")
def _silu(x):
    return torch.nn.functional.silu(x)
def _sigmoid(x):
    return torch.sigmoid(x)
def _layernorm(x, axis=-1, eps=1e-5):
    m = x.mean(dim=axis, keepdim=True)
    v = x.var(dim=axis, keepdim=True, unbiased=False)
    return (x - m) / torch.sqrt(v + eps)
def _scatter_add(tgt, idx, src, axis=0):
    return tgt.clone().index_add_(axis, idx, src)
def _segment_sum(src, seg, n):
    out = torch.zeros((n,) + src.shape[1:], dtype=src.dtype)
    return out.index_add_(0, seg, src)
def _pad(x, pw):
    flat = tuple(v for pair in reversed(pw) for v in pair)
    return torch.nn.functional.pad(x, flat)

kernel_name = 'parallel_sum__gqa_block_cached__mixer_channel_mlp__decode'

def setup_inputs():

    _w = (lambda a: (lambda t: t.to(torch.bfloat16) if t.is_floating_point() else t)(torch.as_tensor(a)))
    def _A_setup():
        B, Sq, D = 8, 1, 640
        Hq, Hkv, Sk, Dh = 32, 32, 4096, 128
        assert Hq % Hkv == 0, (Hq, Hkv)
        return {
            "x": _w((lambda *s: torch.randn(*s, dtype=torch.bfloat16) * 0.05)(B, Sq, D)),
            "k_cache": _w((lambda *s: torch.randn(*s, dtype=torch.bfloat16) * 3.2)(B, Hkv, Sk, Dh)),
            "v_cache": _w((lambda *s: torch.randn(*s, dtype=torch.bfloat16) * 0.4)(B, Hkv, Sk, Dh)),
            "wq": _w((lambda *s: torch.randn(*s, dtype=torch.bfloat16) * 3.2)(D, Hq * Dh) * (D ** -0.5)),
            "wo": _w((lambda *s: torch.randn(*s, dtype=torch.bfloat16) * 0.4)(Hq * Dh, D) * ((Hq * Dh) ** -0.5)),
        }
    _A_in = _A_setup()

    def _B_setup():
        B, S, D, F = 8, 1, 640, 1728
        return {
            "x": _w((lambda *s: torch.randn(*s, dtype=torch.bfloat16) * 0.05)(B, S, D)),
            "w1": _w((lambda *s: torch.randn(*s, dtype=torch.bfloat16) * 1.6)(D, F) * (D ** -0.5)),
            "b1": _w((lambda *s: torch.randn(*s, dtype=torch.bfloat16) * 1.6)(F)),
            "w2": _w((lambda *s: torch.randn(*s, dtype=torch.bfloat16) * 0.1)(F, D) * (F ** -0.5)),
            "b2": _w((lambda *s: torch.randn(*s, dtype=torch.bfloat16) * 0.1)(D)),
        }
    _B_in = _B_setup()

    return {
        "A_x": _A_in["x"],
        "A_k_cache": _A_in["k_cache"],
        "A_v_cache": _A_in["v_cache"],
        "A_wq": _A_in["wq"],
        "A_wo": _A_in["wo"],
        "B_x": _B_in["x"],
        "B_w1": _B_in["w1"],
        "B_b1": _B_in["b1"],
        "B_w2": _B_in["w2"],
        "B_b2": _B_in["b2"],
    }

def reference(A_x, A_k_cache, A_v_cache, A_wq, A_wo, B_x, B_w1, B_b1, B_w2, B_b2):
    def _A_ref(x, k_cache, v_cache, wq, wo):
        B, Sq, D = x.shape
        Hq, Dh = 32, 128
        Hkv = k_cache.shape[1]
        rep = Hq // Hkv
        q = (lambda x, *d: x.permute(*d))((x @ wq).reshape(B, Sq, Hq, Dh), 0, 2, 1, 3)
        k = (lambda x, n, axis: torch.repeat_interleave(x, n, dim=axis))(k_cache, rep, axis=1)
        v = (lambda x, n, axis: torch.repeat_interleave(x, n, dim=axis))(v_cache, rep, axis=1)
        scores = torch.einsum("bhqd,bhkd->bhqk", q, k) * (Dh ** -0.5)
        p = _softmax(scores, axis=-1)
        o = torch.einsum("bhqk,bhkd->bhqd", p, v)
        return (lambda x, *d: x.permute(*d))(o, 0, 2, 1, 3).reshape(B, Sq, Hq * Dh) @ wo

    def _B_ref(x, w1, b1, w2, b2):
        y = _layernorm(x, axis=-1)
        h = _gelu(torch.einsum("bsd,df->bsf", y, w1) + b1)
        return torch.einsum("bsf,fd->bsd", h, w2) + b2

    x = A_x
    xn = _layernorm(x, axis=-1)
    return x + _A_ref(xn, A_k_cache, A_v_cache, A_wq, A_wo) + _B_ref(xn, B_w1, B_b1, B_w2, B_b2)
```

```asm
; @launch grid=(256,1,1) block=(512,1,1) lds=157696
.amdgcn_target "amdgcn-amd-amdhsa--gfx950"
.text
.globl parallel_sum__gqa_block_cached__mixer_channel_mlp__decode_kernel
.p2align 8
.type parallel_sum__gqa_block_cached__mixer_channel_mlp__decode_kernel,@function
parallel_sum__gqa_block_cached__mixer_channel_mlp__decode_kernel:
  s_cmp_ge_u32 s2, 256
  s_cbranch_scc1 L_end
  s_load_dwordx16 s[16:31], s[0:1], 0
  s_load_dwordx8 s[32:39], s[0:1], 64
  s_load_dwordx2 s[40:41], s[0:1], 96
  v_and_b32 v1, 63, v0
  v_lshrrev_b32 v5, 6, v0
  s_nop 0
  v_readfirstlane_b32 s3, v5
  s_lshr_b32 s4, s2, 5
  s_and_b32 s5, s2, 31
  v_lshlrev_b32 v2, 4, v1
  v_lshrrev_b32 v3, 4, v1
  v_and_b32 v4, 15, v1
  s_and_b32 s79, s3, 3
  s_mov_b32 s75, 0x3fb8aa3b
  v_and_b32 v9, 1, v3
  v_lshlrev_b32 v9, 1, v9
  v_lshrrev_b32 v6, 1, v3
  v_or_b32 v9, v9, v6
  v_lshl_add_u32 v5, v4, 3, v9
  v_lshlrev_b32 v11, 2, v5
  s_cmp_ge_u32 s3, 4
  s_cbranch_scc1 L_stream
  s_add_u32 s78, s79, s4
  s_and_b32 s78, s78, 3
  s_and_b32 s6, s5, 7
  s_lshl_b32 s6, s6, 2
  s_lshr_b32 s7, s5, 3
  s_add_u32 s6, s6, s7
  s_mul_i32 s76, s78, 160
  v_add_u32 v5, s76, v3
  v_lshlrev_b32 v39, 13, v5
  v_lshl_add_u32 v39, v4, 4, v39
  v_lshl_add_u32 v6, v4, 2, v3
  v_add_u32 v7, s76, v6
  v_lshlrev_b32 v7, 1, v7
  v_lshlrev_b32 v8, 2, v1
  s_lshl_b32 s76, s4, 8
  s_waitcnt lgkmcnt(0)
  s_load_dword s100, s[40:41], s76
  s_load_dword s11, s[40:41], 0
  v_mov_b32 v10, 0
  ds_write_b32 v10, v10 offset:3488
  ds_write_b32 v10, v10 offset:3492
  ds_write_b32 v10, v10 offset:3496
  ds_write_b32 v10, v10 offset:3500
  ds_write_b32 v10, v10 offset:3504
  ds_write_b32 v10, v10 offset:3508
  ds_write_b32 v10, v10 offset:3520
  ds_write_b32 v10, v10 offset:3536
  s_waitcnt lgkmcnt(0)
  s_add_u32 s100, s100, 1
  s_mul_i32 s76, s4, 1280
  s_add_u32 s52, s16, s76
  s_addc_u32 s53, s17, 0
  s_and_b32 s53, s53, 0xffff
  s_mov_b32 s54, 1280
  s_mov_b32 s55, 0x20000
  s_lshl_b32 s7, s5, 8
  s_add_u32 s60, s22, s7
  s_addc_u32 s61, s23, 0
  s_and_b32 s61, s61, 0xffff
  s_sub_u32 s62, 5242880, s7
  s_mov_b32 s63, 0x20000
  buffer_load_dwordx4 v[224:227], v2, s[52:55], 0 offen
  buffer_load_dword v228, v8, s[52:55], 0 offen offset:1024
  buffer_load_ushort v240, v7, s[52:55], 0 offen offset:0
  buffer_load_ushort v241, v7, s[52:55], 0 offen offset:128
  buffer_load_ushort v242, v7, s[52:55], 0 offen offset:256
  s_mov_b32 s7, 0
  buffer_load_dwordx4 v[64:67], v39, s[60:63], s7 offen
  s_mov_b32 s7, 32768
  buffer_load_dwordx4 v[68:71], v39, s[60:63], s7 offen
  s_mov_b32 s7, 65536
  buffer_load_dwordx4 v[72:75], v39, s[60:63], s7 offen
  s_mov_b32 s7, 98304
  buffer_load_dwordx4 v[76:79], v39, s[60:63], s7 offen
  s_barrier
  s_waitcnt vmcnt(4)
  v_lshlrev_b32 v230, 16, v224
  v_and_b32 v231, 0xffff0000, v224
  v_lshlrev_b32 v232, 16, v225
  v_and_b32 v233, 0xffff0000, v225
  v_lshlrev_b32 v234, 16, v226
  v_and_b32 v235, 0xffff0000, v226
  v_lshlrev_b32 v236, 16, v227
  v_and_b32 v237, 0xffff0000, v227
  v_lshlrev_b32 v238, 16, v228
  v_and_b32 v239, 0xffff0000, v228
  v_lshlrev_b32 v240, 16, v240
  v_lshlrev_b32 v241, 16, v241
  v_lshlrev_b32 v242, 16, v242
  v_add_f32 v5, v230, v231
  v_add_f32 v6, v232, v233
  v_add_f32 v7, v234, v235
  v_add_f32 v8, v236, v237
  v_add_f32 v5, v5, v6
  v_add_f32 v6, v238, v239
  v_add_f32 v7, v7, v8
  v_add_f32 v5, v5, v6
  v_add_f32 v5, v5, v7
  s_nop 1
  v_add_f32_dpp v5, v5, v5 quad_perm:[1,0,3,2] row_mask:0xf bank_mask:0xf
  s_nop 1
  v_add_f32_dpp v5, v5, v5 quad_perm:[2,3,0,1] row_mask:0xf bank_mask:0xf
  s_nop 1
  v_add_f32_dpp v5, v5, v5 row_half_mirror row_mask:0xf bank_mask:0xf
  s_nop 1
  v_add_f32_dpp v5, v5, v5 row_mirror row_mask:0xf bank_mask:0xf
  v_mov_b32 v6, v5
  s_nop 1
  v_permlane16_swap_b32 v5, v6
  v_add_f32 v5, v5, v6
  v_mov_b32 v6, v5
  s_nop 1
  v_permlane32_swap_b32 v5, v6
  v_add_f32 v5, v5, v6
  v_mul_f32 v7, 0x3acccccd, v5
  v_cvt_pk_bf16_f32 v8, 0, v7
  v_sub_f32 v6, v230, v7
  v_mul_f32 v5, v6, v6
  v_sub_f32 v6, v231, v7
  v_fmac_f32 v5, v6, v6
  v_sub_f32 v6, v232, v7
  v_fmac_f32 v5, v6, v6
  v_sub_f32 v6, v233, v7
  v_fmac_f32 v5, v6, v6
  v_sub_f32 v6, v234, v7
  v_fmac_f32 v5, v6, v6
  v_sub_f32 v6, v235, v7
  v_fmac_f32 v5, v6, v6
  v_sub_f32 v6, v236, v7
  v_fmac_f32 v5, v6, v6
  v_sub_f32 v6, v237, v7
  v_fmac_f32 v5, v6, v6
  v_sub_f32 v6, v238, v7
  v_fmac_f32 v5, v6, v6
  v_sub_f32 v6, v239, v7
  v_fmac_f32 v5, v6, v6
  s_nop 1
  v_add_f32_dpp v5, v5, v5 quad_perm:[1,0,3,2] row_mask:0xf bank_mask:0xf
  s_nop 1
  v_add_f32_dpp v5, v5, v5 quad_perm:[2,3,0,1] row_mask:0xf bank_mask:0xf
  s_nop 1
  v_add_f32_dpp v5, v5, v5 row_half_mirror row_mask:0xf bank_mask:0xf
  s_nop 1
  v_add_f32_dpp v5, v5, v5 row_mirror row_mask:0xf bank_mask:0xf
  v_mov_b32 v6, v5
  s_nop 1
  v_permlane16_swap_b32 v5, v6
  v_add_f32 v5, v5, v6
  v_mov_b32 v6, v5
  s_nop 1
  v_permlane32_swap_b32 v5, v6
  v_add_f32 v5, v5, v6
  v_mul_f32 v5, 0x3acccccd, v5
  v_cvt_pk_bf16_f32 v5, 0, v5
  v_add_f32 v5, 0x3727c5ac, v5
  v_cvt_pk_bf16_f32 v5, 0, v5
  v_sqrt_f32 v5, v5
  s_nop 0
  v_cvt_pk_bf16_f32 v5, 0, v5
  v_rcp_f32 v5, v5
  v_sub_f32 v230, v230, v8
  v_sub_f32 v231, v231, v8
  v_sub_f32 v232, v232, v8
  v_sub_f32 v233, v233, v8
  v_sub_f32 v234, v234, v8
  v_sub_f32 v235, v235, v8
  v_sub_f32 v236, v236, v8
  v_sub_f32 v237, v237, v8
  v_sub_f32 v238, v238, v8
  v_sub_f32 v239, v239, v8
  v_sub_f32 v240, v240, v8
  v_sub_f32 v241, v241, v8
  v_sub_f32 v242, v242, v8
  v_cvt_pk_bf16_f32 v230, 0, v230
  v_cvt_pk_bf16_f32 v231, 0, v231
  v_cvt_pk_bf16_f32 v232, 0, v232
  v_cvt_pk_bf16_f32 v233, 0, v233
  v_cvt_pk_bf16_f32 v234, 0, v234
  v_cvt_pk_bf16_f32 v235, 0, v235
  v_cvt_pk_bf16_f32 v236, 0, v236
  v_cvt_pk_bf16_f32 v237, 0, v237
  v_cvt_pk_bf16_f32 v238, 0, v238
  v_cvt_pk_bf16_f32 v239, 0, v239
  v_cvt_pk_bf16_f32 v240, 0, v240
  v_cvt_pk_bf16_f32 v241, 0, v241
  v_cvt_pk_bf16_f32 v242, 0, v242
  v_mul_f32 v230, v230, v5
  v_mul_f32 v231, v231, v5
  v_mul_f32 v232, v232, v5
  v_mul_f32 v233, v233, v5
  v_mul_f32 v234, v234, v5
  v_mul_f32 v235, v235, v5
  v_mul_f32 v236, v236, v5
  v_mul_f32 v237, v237, v5
  v_mul_f32 v238, v238, v5
  v_mul_f32 v239, v239, v5
  v_mul_f32 v240, v240, v5
  v_mul_f32 v241, v241, v5
  v_mul_f32 v242, v242, v5
  v_cvt_pk_bf16_f32 v230, 0, v230
  v_cvt_pk_bf16_f32 v231, 0, v231
  v_cvt_pk_bf16_f32 v232, 0, v232
  v_cvt_pk_bf16_f32 v233, 0, v233
  v_cvt_pk_bf16_f32 v234, 0, v234
  v_cvt_pk_bf16_f32 v235, 0, v235
  v_cvt_pk_bf16_f32 v236, 0, v236
  v_cvt_pk_bf16_f32 v237, 0, v237
  v_cvt_pk_bf16_f32 v238, 0, v238
  v_cvt_pk_bf16_f32 v239, 0, v239
  v_cvt_pk_bf16_f32 v240, 0, v240
  v_cvt_pk_bf16_f32 v241, 0, v241
  v_cvt_pk_bf16_f32 v242, 0, v242
  v_mov_b32 v13, v240
  v_lshrrev_b32 v12, 16, v240
  v_mov_b32 v15, v241
  v_lshrrev_b32 v14, 16, v241
  v_mov_b32 v17, v242
  v_lshrrev_b32 v16, 16, v242
  v_mov_b32 v24, 0
  v_mov_b32 v25, 0
  v_mov_b32 v26, 0
  v_mov_b32 v27, 0
  v_mov_b32 v28, 0
  v_mov_b32 v29, 0
  v_mov_b32 v30, 0
  v_mov_b32 v31, 0
  s_waitcnt vmcnt(3)
  s_mov_b32 s7, 131072
  buffer_load_dwordx4 v[80:83], v39, s[60:63], s7 offen
  v_dot2c_f32_bf16_dpp v24, v12, v64 row_newbcast:0 row_mask:0xf bank_mask:0xf
  v_dot2c_f32_bf16_dpp v25, v13, v64 row_newbcast:0 row_mask:0xf bank_mask:0xf
  v_dot2c_f32_bf16_dpp v26, v12, v65 row_newbcast:0 row_mask:0xf bank_mask:0xf
  v_dot2c_f32_bf16_dpp v27, v13, v65 row_newbcast:0 row_mask:0xf bank_mask:0xf
  v_dot2c_f32_bf16_dpp v28, v12, v66 row_newbcast:0 row_mask:0xf bank_mask:0xf
  v_dot2c_f32_bf16_dpp v29, v13, v66 row_newbcast:0 row_mask:0xf bank_mask:0xf
  v_dot2c_f32_bf16_dpp v30, v12, v67 row_newbcast:0 row_mask:0xf bank_mask:0xf
  v_dot2c_f32_bf16_dpp v31, v13, v67 row_newbcast:0 row_mask:0xf bank_mask:0xf
  s_waitcnt vmcnt(3)
  s_mov_b32 s7, 163840
  buffer_load_dwordx4 v[84:87], v39, s[60:63], s7 offen
  v_dot2c_f32_bf16_dpp v24, v12, v68 row_newbcast:1 row_mask:0xf bank_mask:0xf
  v_dot2c_f32_bf16_dpp v25, v13, v68 row_newbcast:1 row_mask:0xf bank_mask:0xf
  v_dot2c_f32_bf16_dpp v26, v12, v69 row_newbcast:1 row_mask:0xf bank_mask:0xf
  v_dot2c_f32_bf16_dpp v27, v13, v69 row_newbcast:1 row_mask:0xf bank_mask:0xf
  v_dot2c_f32_bf16_dpp v28, v12, v70 row_newbcast:1 row_mask:0xf bank_mask:0xf
  v_dot2c_f32_bf16_dpp v29, v13, v70 row_newbcast:1 row_mask:0xf bank_mask:0xf
  v_dot2c_f32_bf16_dpp v30, v12, v71 row_newbcast:1 row_mask:0xf bank_mask:0xf
  v_dot2c_f32_bf16_dpp v31, v13, v71 row_newbcast:1 row_mask:0xf bank_mask:0xf
  s_waitcnt vmcnt(3)
  s_mov_b32 s7, 196608
  buffer_load_dwordx4 v[88:91], v39, s[60:63], s7 offen
  v_dot2c_f32_bf16_dpp v24, v12, v72 row_newbcast:2 row_mask:0xf bank_mask:0xf
  v_dot2c_f32_bf16_dpp v25, v13, v72 row_newbcast:2 row_mask:0xf bank_mask:0xf
  v_dot2c_f32_bf16_dpp v26, v12, v73 row_newbcast:2 row_mask:0xf bank_mask:0xf
  v_dot2c_f32_bf16_dpp v27, v13, v73 row_newbcast:2 row_mask:0xf bank_mask:0xf
  v_dot2c_f32_bf16_dpp v28, v12, v74 row_newbcast:2 row_mask:0xf bank_mask:0xf
  v_dot2c_f32_bf16_dpp v29, v13, v74 row_newbcast:2 row_mask:0xf bank_mask:0xf
  v_dot2c_f32_bf16_dpp v30, v12, v75 row_newbcast:2 row_mask:0xf bank_mask:0xf
  v_dot2c_f32_bf16_dpp v31, v13, v75 row_newbcast:2 row_mask:0xf bank_mask:0xf
  s_waitcnt vmcnt(3)
  s_mov_b32 s7, 229376
  buffer_load_dwordx4 v[92:95], v39, s[60:63], s7 offen
  v_dot2c_f32_bf16_dpp v24, v12, v76 row_newbcast:3 row_mask:0xf bank_mask:0xf
  v_dot2c_f32_bf16_dpp v25, v13, v76 row_newbcast:3 row_mask:0xf bank_mask:0xf
  v_dot2c_f32_bf16_dpp v26, v12, v77 row_newbcast:3 row_mask:0xf bank_mask:0xf
  v_dot2c_f32_bf16_dpp v27, v13, v77 row_newbcast:3 row_mask:0xf bank_mask:0xf
  v_dot2c_f32_bf16_dpp v28, v12, v78 row_newbcast:3 row_mask:0xf bank_mask:0xf
  v_dot2c_f32_bf16_dpp v29, v13, v78 row_newbcast:3 row_mask:0xf bank_mask:0xf
  v_dot2c_f32_bf16_dpp v30, v12, v79 row_newbcast:3 row_mask:0xf bank_mask:0xf
  v_dot2c_f32_bf16_dpp v31, v13, v79 row_newbcast:3 row_mask:0xf bank_mask:0xf
  s_waitcnt vmcnt(3)
  s_mov_b32 s7, 262144
  buffer_load_dwordx4 v[96:99], v39, s[60:63], s7 offen
  v_dot2c_f32_bf16_dpp v24, v12, v80 row_newbcast:4 row_mask:0xf bank_mask:0xf
  v_dot2c_f32_bf16_dpp v25, v13, v80 row_newbcast:4 row_mask:0xf bank_mask:0xf
  v_dot2c_f32_bf16_dpp v26, v12, v81 row_newbcast:4 row_mask:0xf bank_mask:0xf
  v_dot2c_f32_bf16_dpp v27, v13, v81 row_newbcast:4 row_mask:0xf bank_mask:0xf
  v_dot2c_f32_bf16_dpp v28, v12, v82 row_newbcast:4 row_mask:0xf bank_mask:0xf
  v_dot2c_f32_bf16_dpp v29, v13, v82 row_newbcast:4 row_mask:0xf bank_mask:0xf
  v_dot2c_f32_bf16_dpp v30, v12, v83 row_newbcast:4 row_mask:0xf bank_mask:0xf
  v_dot2c_f32_bf16_dpp v31, v13, v83 row_newbcast:4 row_mask:0xf bank_mask:0xf
  s_waitcnt vmcnt(3)
  s_mov_b32 s7, 294912
  buffer_load_dwordx4 v[100:103], v39, s[60:63], s7 offen
  v_dot2c_f32_bf16_dpp v24, v12, v84 row_newbcast:5 row_mask:0xf bank_mask:0xf
  v_dot2c_f32_bf16_dpp v25, v13, v84 row_newbcast:5 row_mask:0xf bank_mask:0xf
  v_dot2c_f32_bf16_dpp v26, v12, v85 row_newbcast:5 row_mask:0xf bank_mask:0xf
  v_dot2c_f32_bf16_dpp v27, v13, v85 row_newbcast:5 row_mask:0xf bank_mask:0xf
  v_dot2c_f32_bf16_dpp v28, v12, v86 row_newbcast:5 row_mask:0xf bank_mask:0xf
  v_dot2c_f32_bf16_dpp v29, v13, v86 row_newbcast:5 row_mask:0xf bank_mask:0xf
  v_dot2c_f32_bf16_dpp v30, v12, v87 row_newbcast:5 row_mask:0xf bank_mask:0xf
  v_dot2c_f32_bf16_dpp v31, v13, v87 row_newbcast:5 row_mask:0xf bank_mask:0xf
  s_waitcnt vmcnt(3)
  s_mov_b32 s7, 327680
  buffer_load_dwordx4 v[104:107], v39, s[60:63], s7 offen
  v_dot2c_f32_bf16_dpp v24, v12, v88 row_newbcast:6 row_mask:0xf bank_mask:0xf
  v_dot2c_f32_bf16_dpp v25, v13, v88 row_newbcast:6 row_mask:0xf bank_mask:0xf
  v_dot2c_f32_bf16_dpp v26, v12, v89 row_newbcast:6 row_mask:0xf bank_mask:0xf
  v_dot2c_f32_bf16_dpp v27, v13, v89 row_newbcast:6 row_mask:0xf bank_mask:0xf
  v_dot2c_f32_bf16_dpp v28, v12, v90 row_newbcast:6 row_mask:0xf bank_mask:0xf
  v_dot2c_f32_bf16_dpp v29, v13, v90 row_newbcast:6 row_mask:0xf bank_mask:0xf
  v_dot2c_f32_bf16_dpp v30, v12, v91 row_newbcast:6 row_mask:0xf bank_mask:0xf
  v_dot2c_f32_bf16_dpp v31, v13, v91 row_newbcast:6 row_mask:0xf bank_mask:0xf
  s_waitcnt vmcnt(3)
  s_mov_b32 s7, 360448
  buffer_load_dwordx4 v[108:111], v39, s[60:63], s7 offen
  v_dot2c_f32_bf16_dpp v24, v12, v92 row_newbcast:7 row_mask:0xf bank_mask:0xf
  v_dot2c_f32_bf16_dpp v25, v13, v92 row_newbcast:7 row_mask:0xf bank_mask:0xf
  v_dot2c_f32_bf16_dpp v26, v12, v93 row_newbcast:7 row_mask:0xf bank_mask:0xf
  v_dot2c_f32_bf16_dpp v27, v13, v93 row_newbcast:7 row_mask:0xf bank_mask:0xf
  v_dot2c_f32_bf16_dpp v28, v12, v94 row_newbcast:7 row_mask:0xf bank_mask:0xf
  v_dot2c_f32_bf16_dpp v29, v13, v94 row_newbcast:7 row_mask:0xf bank_mask:0xf
  v_dot2c_f32_bf16_dpp v30, v12, v95 row_newbcast:7 row_mask:0xf bank_mask:0xf
  v_dot2c_f32_bf16_dpp v31, v13, v95 row_newbcast:7 row_mask:0xf bank_mask:0xf
  s_waitcnt vmcnt(3)
  s_mov_b32 s7, 393216
  buffer_load_dwordx4 v[112:115], v39, s[60:63], s7 offen
  v_dot2c_f32_bf16_dpp v24, v12, v96 row_newbcast:8 row_mask:0xf bank_mask:0xf
  v_dot2c_f32_bf16_dpp v25, v13, v96 row_newbcast:8 row_mask:0xf bank_mask:0xf
  v_dot2c_f32_bf16_dpp v26, v12, v97 row_newbcast:8 row_mask:0xf bank_mask:0xf
  v_dot2c_f32_bf16_dpp v27, v13, v97 row_newbcast:8 row_mask:0xf bank_mask:0xf
  v_dot2c_f32_bf16_dpp v28, v12, v98 row_newbcast:8 row_mask:0xf bank_mask:0xf
  v_dot2c_f32_bf16_dpp v29, v13, v98 row_newbcast:8 row_mask:0xf bank_mask:0xf
  v_dot2c_f32_bf16_dpp v30, v12, v99 row_newbcast:8 row_mask:0xf bank_mask:0xf
  v_dot2c_f32_bf16_dpp v31, v13, v99 row_newbcast:8 row_mask:0xf bank_mask:0xf
  s_waitcnt vmcnt(3)
  s_mov_b32 s7, 425984
  buffer_load_dwordx4 v[116:119], v39, s[60:63], s7 offen
  v_dot2c_f32_bf16_dpp v24, v12, v100 row_newbcast:9 row_mask:0xf bank_mask:0xf
  v_dot2c_f32_bf16_dpp v25, v13, v100 row_newbcast:9 row_mask:0xf bank_mask:0xf
  v_dot2c_f32_bf16_dpp v26, v12, v101 row_newbcast:9 row_mask:0xf bank_mask:0xf
  v_dot2c_f32_bf16_dpp v27, v13, v101 row_newbcast:9 row_mask:0xf bank_mask:0xf
  v_dot2c_f32_bf16_dpp v28, v12, v102 row_newbcast:9 row_mask:0xf bank_mask:0xf
  v_dot2c_f32_bf16_dpp v29, v13, v102 row_newbcast:9 row_mask:0xf bank_mask:0xf
  v_dot2c_f32_bf16_dpp v30, v12, v103 row_newbcast:9 row_mask:0xf bank_mask:0xf
  v_dot2c_f32_bf16_dpp v31, v13, v103 row_newbcast:9 row_mask:0xf bank_mask:0xf
  s_waitcnt vmcnt(3)
  s_mov_b32 s7, 458752
  buffer_load_dwordx4 v[120:123], v39, s[60:63], s7 offen
  v_dot2c_f32_bf16_dpp v24, v12, v104 row_newbcast:10 row_mask:0xf bank_mask:0xf
  v_dot2c_f32_bf16_dpp v25, v13, v104 row_newbcast:10 row_mask:0xf bank_mask:0xf
  v_dot2c_f32_bf16_dpp v26, v12, v105 row_newbcast:10 row_mask:0xf bank_mask:0xf
  v_dot2c_f32_bf16_dpp v27, v13, v105 row_newbcast:10 row_mask:0xf bank_mask:0xf
  v_dot2c_f32_bf16_dpp v28, v12, v106 row_newbcast:10 row_mask:0xf bank_mask:0xf
  v_dot2c_f32_bf16_dpp v29, v13, v106 row_newbcast:10 row_mask:0xf bank_mask:0xf
  v_dot2c_f32_bf16_dpp v30, v12, v107 row_newbcast:10 row_mask:0xf bank_mask:0xf
  v_dot2c_f32_bf16_dpp v31, v13, v107 row_newbcast:10 row_mask:0xf bank_mask:0xf
  s_waitcnt vmcnt(3)
  s_mov_b32 s7, 491520
  buffer_load_dwordx4 v[124:127], v39, s[60:63], s7 offen
  v_dot2c_f32_bf16_dpp v24, v12, v108 row_newbcast:11 row_mask:0xf bank_mask:0xf
  v_dot2c_f32_bf16_dpp v25, v13, v108 row_newbcast:11 row_mask:0xf bank_mask:0xf
  v_dot2c_f32_bf16_dpp v26, v12, v109 row_newbcast:11 row_mask:0xf bank_mask:0xf
  v_dot2c_f32_bf16_dpp v27, v13, v109 row_newbcast:11 row_mask:0xf bank_mask:0xf
  v_dot2c_f32_bf16_dpp v28, v12, v110 row_newbcast:11 row_mask:0xf bank_mask:0xf
  v_dot2c_f32_bf16_dpp v29, v13, v110 row_newbcast:11 row_mask:0xf bank_mask:0xf
  v_dot2c_f32_bf16_dpp v30, v12, v111 row_newbcast:11 row_mask:0xf bank_mask:0xf
  v_dot2c_f32_bf16_dpp v31, v13, v111 row_newbcast:11 row_mask:0xf bank_mask:0xf
  s_waitcnt vmcnt(3)
  s_mov_b32 s7, 524288
  buffer_load_dwordx4 v[128:131], v39, s[60:63], s7 offen
  v_dot2c_f32_bf16_dpp v24, v12, v112 row_newbcast:12 row_mask:0xf bank_mask:0xf
  v_dot2c_f32_bf16_dpp v25, v13, v112 row_newbcast:12 row_mask:0xf bank_mask:0xf
  v_dot2c_f32_bf16_dpp v26, v12, v113 row_newbcast:12 row_mask:0xf bank_mask:0xf
  v_dot2c_f32_bf16_dpp v27, v13, v113 row_newbcast:12 row_mask:0xf bank_mask:0xf
  v_dot2c_f32_bf16_dpp v28, v12, v114 row_newbcast:12 row_mask:0xf bank_mask:0xf
  v_dot2c_f32_bf16_dpp v29, v13, v114 row_newbcast:12 row_mask:0xf bank_mask:0xf
  v_dot2c_f32_bf16_dpp v30, v12, v115 row_newbcast:12 row_mask:0xf bank_mask:0xf
  v_dot2c_f32_bf16_dpp v31, v13, v115 row_newbcast:12 row_mask:0xf bank_mask:0xf
  s_waitcnt vmcnt(3)
  s_mov_b32 s7, 557056
  buffer_load_dwordx4 v[132:135], v39, s[60:63], s7 offen
  v_dot2c_f32_bf16_dpp v24, v12, v116 row_newbcast:13 row_mask:0xf bank_mask:0xf
  v_dot2c_f32_bf16_dpp v25, v13, v116 row_newbcast:13 row_mask:0xf bank_mask:0xf
  v_dot2c_f32_bf16_dpp v26, v12, v117 row_newbcast:13 row_mask:0xf bank_mask:0xf
  v_dot2c_f32_bf16_dpp v27, v13, v117 row_newbcast:13 row_mask:0xf bank_mask:0xf
  v_dot2c_f32_bf16_dpp v28, v12, v118 row_newbcast:13 row_mask:0xf bank_mask:0xf
  v_dot2c_f32_bf16_dpp v29, v13, v118 row_newbcast:13 row_mask:0xf bank_mask:0xf
  v_dot2c_f32_bf16_dpp v30, v12, v119 row_newbcast:13 row_mask:0xf bank_mask:0xf
  v_dot2c_f32_bf16_dpp v31, v13, v119 row_newbcast:13 row_mask:0xf bank_mask:0xf
  s_waitcnt vmcnt(3)
  s_mov_b32 s7, 589824
  buffer_load_dwordx4 v[136:139], v39, s[60:63], s7 offen
  v_dot2c_f32_bf16_dpp v24, v12, v120 row_newbcast:14 row_mask:0xf bank_mask:0xf
  v_dot2c_f32_bf16_dpp v25, v13, v120 row_newbcast:14 row_mask:0xf bank_mask:0xf
  v_dot2c_f32_bf16_dpp v26, v12, v121 row_newbcast:14 row_mask:0xf bank_mask:0xf
  v_dot2c_f32_bf16_dpp v27, v13, v121 row_newbcast:14 row_mask:0xf bank_mask:0xf
  v_dot2c_f32_bf16_dpp v28, v12, v122 row_newbcast:14 row_mask:0xf bank_mask:0xf
  v_dot2c_f32_bf16_dpp v29, v13, v122 row_newbcast:14 row_mask:0xf bank_mask:0xf
  v_dot2c_f32_bf16_dpp v30, v12, v123 row_newbcast:14 row_mask:0xf bank_mask:0xf
  v_dot2c_f32_bf16_dpp v31, v13, v123 row_newbcast:14 row_mask:0xf bank_mask:0xf
  s_waitcnt vmcnt(3)
  s_mov_b32 s7, 622592
  buffer_load_dwordx4 v[140:143], v39, s[60:63], s7 offen
  v_dot2c_f32_bf16_dpp v24, v12, v124 row_newbcast:15 row_mask:0xf bank_mask:0xf
  v_dot2c_f32_bf16_dpp v25, v13, v124 row_newbcast:15 row_mask:0xf bank_mask:0xf
  v_dot2c_f32_bf16_dpp v26, v12, v125 row_newbcast:15 row_mask:0xf bank_mask:0xf
  v_dot2c_f32_bf16_dpp v27, v13, v125 row_newbcast:15 row_mask:0xf bank_mask:0xf
  v_dot2c_f32_bf16_dpp v28, v12, v126 row_newbcast:15 row_mask:0xf bank_mask:0xf
  v_dot2c_f32_bf16_dpp v29, v13, v126 row_newbcast:15 row_mask:0xf bank_mask:0xf
  v_dot2c_f32_bf16_dpp v30, v12, v127 row_newbcast:15 row_mask:0xf bank_mask:0xf
  v_dot2c_f32_bf16_dpp v31, v13, v127 row_newbcast:15 row_mask:0xf bank_mask:0xf
  s_waitcnt vmcnt(3)
  s_mov_b32 s7, 655360
  buffer_load_dwordx4 v[144:147], v39, s[60:63], s7 offen
  v_dot2c_f32_bf16_dpp v24, v14, v128 row_newbcast:0 row_mask:0xf bank_mask:0xf
  v_dot2c_f32_bf16_dpp v25, v15, v128 row_newbcast:0 row_mask:0xf bank_mask:0xf
  v_dot2c_f32_bf16_dpp v26, v14, v129 row_newbcast:0 row_mask:0xf bank_mask:0xf
  v_dot2c_f32_bf16_dpp v27, v15, v129 row_newbcast:0 row_mask:0xf bank_mask:0xf
  v_dot2c_f32_bf16_dpp v28, v14, v130 row_newbcast:0 row_mask:0xf bank_mask:0xf
  v_dot2c_f32_bf16_dpp v29, v15, v130 row_newbcast:0 row_mask:0xf bank_mask:0xf
  v_dot2c_f32_bf16_dpp v30, v14, v131 row_newbcast:0 row_mask:0xf bank_mask:0xf
  v_dot2c_f32_bf16_dpp v31, v15, v131 row_newbcast:0 row_mask:0xf bank_mask:0xf
  s_waitcnt vmcnt(3)
  s_mov_b32 s7, 688128
  buffer_load_dwordx4 v[148:151], v39, s[60:63], s7 offen
  v_dot2c_f32_bf16_dpp v24, v14, v132 row_newbcast:1 row_mask:0xf bank_mask:0xf
  v_dot2c_f32_bf16_dpp v25, v15, v132 row_newbcast:1 row_mask:0xf bank_mask:0xf
  v_dot2c_f32_bf16_dpp v26, v14, v133 row_newbcast:1 row_mask:0xf bank_mask:0xf
  v_dot2c_f32_bf16_dpp v27, v15, v133 row_newbcast:1 row_mask:0xf bank_mask:0xf
  v_dot2c_f32_bf16_dpp v28, v14, v134 row_newbcast:1 row_mask:0xf bank_mask:0xf
  v_dot2c_f32_bf16_dpp v29, v15, v134 row_newbcast:1 row_mask:0xf bank_mask:0xf
  v_dot2c_f32_bf16_dpp v30, v14, v135 row_newbcast:1 row_mask:0xf bank_mask:0xf
  v_dot2c_f32_bf16_dpp v31, v15, v135 row_newbcast:1 row_mask:0xf bank_mask:0xf
  s_waitcnt vmcnt(3)
  s_mov_b32 s7, 720896
  buffer_load_dwordx4 v[152:155], v39, s[60:63], s7 offen
  v_dot2c_f32_bf16_dpp v24, v14, v136 row_newbcast:2 row_mask:0xf bank_mask:0xf
  v_dot2c_f32_bf16_dpp v25, v15, v136 row_newbcast:2 row_mask:0xf bank_mask:0xf
  v_dot2c_f32_bf16_dpp v26, v14, v137 row_newbcast:2 row_mask:0xf bank_mask:0xf
  v_dot2c_f32_bf16_dpp v27, v15, v137 row_newbcast:2 row_mask:0xf bank_mask:0xf
  v_dot2c_f32_bf16_dpp v28, v14, v138 row_newbcast:2 row_mask:0xf bank_mask:0xf
  v_dot2c_f32_bf16_dpp v29, v15, v138 row_newbcast:2 row_mask:0xf bank_mask:0xf
  v_dot2c_f32_bf16_dpp v30, v14, v139 row_newbcast:2 row_mask:0xf bank_mask:0xf
  v_dot2c_f32_bf16_dpp v31, v15, v139 row_newbcast:2 row_mask:0xf bank_mask:0xf
  s_waitcnt vmcnt(3)
  s_mov_b32 s7, 753664
  buffer_load_dwordx4 v[156:159], v39, s[60:63], s7 offen
  v_dot2c_f32_bf16_dpp v24, v14, v140 row_newbcast:3 row_mask:0xf bank_mask:0xf
  v_dot2c_f32_bf16_dpp v25, v15, v140 row_newbcast:3 row_mask:0xf bank_mask:0xf
  v_dot2c_f32_bf16_dpp v26, v14, v141 row_newbcast:3 row_mask:0xf bank_mask:0xf
  v_dot2c_f32_bf16_dpp v27, v15, v141 row_newbcast:3 row_mask:0xf bank_mask:0xf
  v_dot2c_f32_bf16_dpp v28, v14, v142 row_newbcast:3 row_mask:0xf bank_mask:0xf
  v_dot2c_f32_bf16_dpp v29, v15, v142 row_newbcast:3 row_mask:0xf bank_mask:0xf
  v_dot2c_f32_bf16_dpp v30, v14, v143 row_newbcast:3 row_mask:0xf bank_mask:0xf
  v_dot2c_f32_bf16_dpp v31, v15, v143 row_newbcast:3 row_mask:0xf bank_mask:0xf
  s_waitcnt vmcnt(3)
  s_mov_b32 s7, 786432
  buffer_load_dwordx4 v[160:163], v39, s[60:63], s7 offen
  v_dot2c_f32_bf16_dpp v24, v14, v144 row_newbcast:4 row_mask:0xf bank_mask:0xf
  v_dot2c_f32_bf16_dpp v25, v15, v144 row_newbcast:4 row_mask:0xf bank_mask:0xf
  v_dot2c_f32_bf16_dpp v26, v14, v145 row_newbcast:4 row_mask:0xf bank_mask:0xf
  v_dot2c_f32_bf16_dpp v27, v15, v145 row_newbcast:4 row_mask:0xf bank_mask:0xf
  v_dot2c_f32_bf16_dpp v28, v14, v146 row_newbcast:4 row_mask:0xf bank_mask:0xf
  v_dot2c_f32_bf16_dpp v29, v15, v146 row_newbcast:4 row_mask:0xf bank_mask:0xf
  v_dot2c_f32_bf16_dpp v30, v14, v147 row_newbcast:4 row_mask:0xf bank_mask:0xf
  v_dot2c_f32_bf16_dpp v31, v15, v147 row_newbcast:4 row_mask:0xf bank_mask:0xf
  s_waitcnt vmcnt(3)
  s_mov_b32 s7, 819200
  buffer_load_dwordx4 v[164:167], v39, s[60:63], s7 offen
  v_dot2c_f32_bf16_dpp v24, v14, v148 row_newbcast:5 row_mask:0xf bank_mask:0xf
  v_dot2c_f32_bf16_dpp v25, v15, v148 row_newbcast:5 row_mask:0xf bank_mask:0xf
  v_dot2c_f32_bf16_dpp v26, v14, v149 row_newbcast:5 row_mask:0xf bank_mask:0xf
  v_dot2c_f32_bf16_dpp v27, v15, v149 row_newbcast:5 row_mask:0xf bank_mask:0xf
  v_dot2c_f32_bf16_dpp v28, v14, v150 row_newbcast:5 row_mask:0xf bank_mask:0xf
  v_dot2c_f32_bf16_dpp v29, v15, v150 row_newbcast:5 row_mask:0xf bank_mask:0xf
  v_dot2c_f32_bf16_dpp v30, v14, v151 row_newbcast:5 row_mask:0xf bank_mask:0xf
  v_dot2c_f32_bf16_dpp v31, v15, v151 row_newbcast:5 row_mask:0xf bank_mask:0xf
  s_waitcnt vmcnt(3)
  s_mov_b32 s7, 851968
  buffer_load_dwordx4 v[168:171], v39, s[60:63], s7 offen
  v_dot2c_f32_bf16_dpp v24, v14, v152 row_newbcast:6 row_mask:0xf bank_mask:0xf
  v_dot2c_f32_bf16_dpp v25, v15, v152 row_newbcast:6 row_mask:0xf bank_mask:0xf
  v_dot2c_f32_bf16_dpp v26, v14, v153 row_newbcast:6 row_mask:0xf bank_mask:0xf
  v_dot2c_f32_bf16_dpp v27, v15, v153 row_newbcast:6 row_mask:0xf bank_mask:0xf
  v_dot2c_f32_bf16_dpp v28, v14, v154 row_newbcast:6 row_mask:0xf bank_mask:0xf
  v_dot2c_f32_bf16_dpp v29, v15, v154 row_newbcast:6 row_mask:0xf bank_mask:0xf
  v_dot2c_f32_bf16_dpp v30, v14, v155 row_newbcast:6 row_mask:0xf bank_mask:0xf
  v_dot2c_f32_bf16_dpp v31, v15, v155 row_newbcast:6 row_mask:0xf bank_mask:0xf
  s_waitcnt vmcnt(3)
  s_mov_b32 s7, 884736
  buffer_load_dwordx4 v[172:175], v39, s[60:63], s7 offen
  v_dot2c_f32_bf16_dpp v24, v14, v156 row_newbcast:7 row_mask:0xf bank_mask:0xf
  v_dot2c_f32_bf16_dpp v25, v15, v156 row_newbcast:7 row_mask:0xf bank_mask:0xf
  v_dot2c_f32_bf16_dpp v26, v14, v157 row_newbcast:7 row_mask:0xf bank_mask:0xf
  v_dot2c_f32_bf16_dpp v27, v15, v157 row_newbcast:7 row_mask:0xf bank_mask:0xf
  v_dot2c_f32_bf16_dpp v28, v14, v158 row_newbcast:7 row_mask:0xf bank_mask:0xf
  v_dot2c_f32_bf16_dpp v29, v15, v158 row_newbcast:7 row_mask:0xf bank_mask:0xf
  v_dot2c_f32_bf16_dpp v30, v14, v159 row_newbcast:7 row_mask:0xf bank_mask:0xf
  v_dot2c_f32_bf16_dpp v31, v15, v159 row_newbcast:7 row_mask:0xf bank_mask:0xf
  s_waitcnt vmcnt(3)
  s_mov_b32 s7, 917504
  buffer_load_dwordx4 v[176:179], v39, s[60:63], s7 offen
  v_dot2c_f32_bf16_dpp v24, v14, v160 row_newbcast:8 row_mask:0xf bank_mask:0xf
  v_dot2c_f32_bf16_dpp v25, v15, v160 row_newbcast:8 row_mask:0xf bank_mask:0xf
  v_dot2c_f32_bf16_dpp v26, v14, v161 row_newbcast:8 row_mask:0xf bank_mask:0xf
  v_dot2c_f32_bf16_dpp v27, v15, v161 row_newbcast:8 row_mask:0xf bank_mask:0xf
  v_dot2c_f32_bf16_dpp v28, v14, v162 row_newbcast:8 row_mask:0xf bank_mask:0xf
  v_dot2c_f32_bf16_dpp v29, v15, v162 row_newbcast:8 row_mask:0xf bank_mask:0xf
  v_dot2c_f32_bf16_dpp v30, v14, v163 row_newbcast:8 row_mask:0xf bank_mask:0xf
  v_dot2c_f32_bf16_dpp v31, v15, v163 row_newbcast:8 row_mask:0xf bank_mask:0xf
  s_waitcnt vmcnt(3)
  s_mov_b32 s7, 950272
  buffer_load_dwordx4 v[180:183], v39, s[60:63], s7 offen
  v_dot2c_f32_bf16_dpp v24, v14, v164 row_newbcast:9 row_mask:0xf bank_mask:0xf
  v_dot2c_f32_bf16_dpp v25, v15, v164 row_newbcast:9 row_mask:0xf bank_mask:0xf
  v_dot2c_f32_bf16_dpp v26, v14, v165 row_newbcast:9 row_mask:0xf bank_mask:0xf
  v_dot2c_f32_bf16_dpp v27, v15, v165 row_newbcast:9 row_mask:0xf bank_mask:0xf
  v_dot2c_f32_bf16_dpp v28, v14, v166 row_newbcast:9 row_mask:0xf bank_mask:0xf
  v_dot2c_f32_bf16_dpp v29, v15, v166 row_newbcast:9 row_mask:0xf bank_mask:0xf
  v_dot2c_f32_bf16_dpp v30, v14, v167 row_newbcast:9 row_mask:0xf bank_mask:0xf
  v_dot2c_f32_bf16_dpp v31, v15, v167 row_newbcast:9 row_mask:0xf bank_mask:0xf
  s_waitcnt vmcnt(3)
  s_mov_b32 s7, 983040
  buffer_load_dwordx4 v[184:187], v39, s[60:63], s7 offen
  v_dot2c_f32_bf16_dpp v24, v14, v168 row_newbcast:10 row_mask:0xf bank_mask:0xf
  v_dot2c_f32_bf16_dpp v25, v15, v168 row_newbcast:10 row_mask:0xf bank_mask:0xf
  v_dot2c_f32_bf16_dpp v26, v14, v169 row_newbcast:10 row_mask:0xf bank_mask:0xf
  v_dot2c_f32_bf16_dpp v27, v15, v169 row_newbcast:10 row_mask:0xf bank_mask:0xf
  v_dot2c_f32_bf16_dpp v28, v14, v170 row_newbcast:10 row_mask:0xf bank_mask:0xf
  v_dot2c_f32_bf16_dpp v29, v15, v170 row_newbcast:10 row_mask:0xf bank_mask:0xf
  v_dot2c_f32_bf16_dpp v30, v14, v171 row_newbcast:10 row_mask:0xf bank_mask:0xf
  v_dot2c_f32_bf16_dpp v31, v15, v171 row_newbcast:10 row_mask:0xf bank_mask:0xf
  s_waitcnt vmcnt(3)
  s_mov_b32 s7, 1015808
  buffer_load_dwordx4 v[188:191], v39, s[60:63], s7 offen
  v_dot2c_f32_bf16_dpp v24, v14, v172 row_newbcast:11 row_mask:0xf bank_mask:0xf
  v_dot2c_f32_bf16_dpp v25, v15, v172 row_newbcast:11 row_mask:0xf bank_mask:0xf
  v_dot2c_f32_bf16_dpp v26, v14, v173 row_newbcast:11 row_mask:0xf bank_mask:0xf
  v_dot2c_f32_bf16_dpp v27, v15, v173 row_newbcast:11 row_mask:0xf bank_mask:0xf
  v_dot2c_f32_bf16_dpp v28, v14, v174 row_newbcast:11 row_mask:0xf bank_mask:0xf
  v_dot2c_f32_bf16_dpp v29, v15, v174 row_newbcast:11 row_mask:0xf bank_mask:0xf
  v_dot2c_f32_bf16_dpp v30, v14, v175 row_newbcast:11 row_mask:0xf bank_mask:0xf
  v_dot2c_f32_bf16_dpp v31, v15, v175 row_newbcast:11 row_mask:0xf bank_mask:0xf
  s_waitcnt vmcnt(3)
  s_mov_b32 s7, 1048576
  buffer_load_dwordx4 v[192:195], v39, s[60:63], s7 offen
  v_dot2c_f32_bf16_dpp v24, v14, v176 row_newbcast:12 row_mask:0xf bank_mask:0xf
  v_dot2c_f32_bf16_dpp v25, v15, v176 row_newbcast:12 row_mask:0xf bank_mask:0xf
  v_dot2c_f32_bf16_dpp v26, v14, v177 row_newbcast:12 row_mask:0xf bank_mask:0xf
  v_dot2c_f32_bf16_dpp v27, v15, v177 row_newbcast:12 row_mask:0xf bank_mask:0xf
  v_dot2c_f32_bf16_dpp v28, v14, v178 row_newbcast:12 row_mask:0xf bank_mask:0xf
  v_dot2c_f32_bf16_dpp v29, v15, v178 row_newbcast:12 row_mask:0xf bank_mask:0xf
  v_dot2c_f32_bf16_dpp v30, v14, v179 row_newbcast:12 row_mask:0xf bank_mask:0xf
  v_dot2c_f32_bf16_dpp v31, v15, v179 row_newbcast:12 row_mask:0xf bank_mask:0xf
  s_waitcnt vmcnt(3)
  s_mov_b32 s7, 1081344
  buffer_load_dwordx4 v[196:199], v39, s[60:63], s7 offen
  v_dot2c_f32_bf16_dpp v24, v14, v180 row_newbcast:13 row_mask:0xf bank_mask:0xf
  v_dot2c_f32_bf16_dpp v25, v15, v180 row_newbcast:13 row_mask:0xf bank_mask:0xf
  v_dot2c_f32_bf16_dpp v26, v14, v181 row_newbcast:13 row_mask:0xf bank_mask:0xf
  v_dot2c_f32_bf16_dpp v27, v15, v181 row_newbcast:13 row_mask:0xf bank_mask:0xf
  v_dot2c_f32_bf16_dpp v28, v14, v182 row_newbcast:13 row_mask:0xf bank_mask:0xf
  v_dot2c_f32_bf16_dpp v29, v15, v182 row_newbcast:13 row_mask:0xf bank_mask:0xf
  v_dot2c_f32_bf16_dpp v30, v14, v183 row_newbcast:13 row_mask:0xf bank_mask:0xf
  v_dot2c_f32_bf16_dpp v31, v15, v183 row_newbcast:13 row_mask:0xf bank_mask:0xf
  s_waitcnt vmcnt(3)
  s_mov_b32 s7, 1114112
  buffer_load_dwordx4 v[200:203], v39, s[60:63], s7 offen
  v_dot2c_f32_bf16_dpp v24, v14, v184 row_newbcast:14 row_mask:0xf bank_mask:0xf
  v_dot2c_f32_bf16_dpp v25, v15, v184 row_newbcast:14 row_mask:0xf bank_mask:0xf
  v_dot2c_f32_bf16_dpp v26, v14, v185 row_newbcast:14 row_mask:0xf bank_mask:0xf
  v_dot2c_f32_bf16_dpp v27, v15, v185 row_newbcast:14 row_mask:0xf bank_mask:0xf
  v_dot2c_f32_bf16_dpp v28, v14, v186 row_newbcast:14 row_mask:0xf bank_mask:0xf
  v_dot2c_f32_bf16_dpp v29, v15, v186 row_newbcast:14 row_mask:0xf bank_mask:0xf
  v_dot2c_f32_bf16_dpp v30, v14, v187 row_newbcast:14 row_mask:0xf bank_mask:0xf
  v_dot2c_f32_bf16_dpp v31, v15, v187 row_newbcast:14 row_mask:0xf bank_mask:0xf
  s_waitcnt vmcnt(3)
  s_mov_b32 s7, 1146880
  buffer_load_dwordx4 v[204:207], v39, s[60:63], s7 offen
  v_dot2c_f32_bf16_dpp v24, v14, v188 row_newbcast:15 row_mask:0xf bank_mask:0xf
  v_dot2c_f32_bf16_dpp v25, v15, v188 row_newbcast:15 row_mask:0xf bank_mask:0xf
  v_dot2c_f32_bf16_dpp v26, v14, v189 row_newbcast:15 row_mask:0xf bank_mask:0xf
  v_dot2c_f32_bf16_dpp v27, v15, v189 row_newbcast:15 row_mask:0xf bank_mask:0xf
  v_dot2c_f32_bf16_dpp v28, v14, v190 row_newbcast:15 row_mask:0xf bank_mask:0xf
  v_dot2c_f32_bf16_dpp v29, v15, v190 row_newbcast:15 row_mask:0xf bank_mask:0xf
  v_dot2c_f32_bf16_dpp v30, v14, v191 row_newbcast:15 row_mask:0xf bank_mask:0xf
  v_dot2c_f32_bf16_dpp v31, v15, v191 row_newbcast:15 row_mask:0xf bank_mask:0xf
  s_waitcnt vmcnt(3)
  s_mov_b32 s7, 1179648
  buffer_load_dwordx4 v[208:211], v39, s[60:63], s7 offen
  v_dot2c_f32_bf16_dpp v24, v16, v192 row_newbcast:0 row_mask:0xf bank_mask:0xf
  v_dot2c_f32_bf16_dpp v25, v17, v192 row_newbcast:0 row_mask:0xf bank_mask:0xf
  v_dot2c_f32_bf16_dpp v26, v16, v193 row_newbcast:0 row_mask:0xf bank_mask:0xf
  v_dot2c_f32_bf16_dpp v27, v17, v193 row_newbcast:0 row_mask:0xf bank_mask:0xf
  v_dot2c_f32_bf16_dpp v28, v16, v194 row_newbcast:0 row_mask:0xf bank_mask:0xf
  v_dot2c_f32_bf16_dpp v29, v17, v194 row_newbcast:0 row_mask:0xf bank_mask:0xf
  v_dot2c_f32_bf16_dpp v30, v16, v195 row_newbcast:0 row_mask:0xf bank_mask:0xf
  v_dot2c_f32_bf16_dpp v31, v17, v195 row_newbcast:0 row_mask:0xf bank_mask:0xf
  s_waitcnt vmcnt(3)
  s_mov_b32 s7, 1212416
  buffer_load_dwordx4 v[212:215], v39, s[60:63], s7 offen
  v_dot2c_f32_bf16_dpp v24, v16, v196 row_newbcast:1 row_mask:0xf bank_mask:0xf
  v_dot2c_f32_bf16_dpp v25, v17, v196 row_newbcast:1 row_mask:0xf bank_mask:0xf
  v_dot2c_f32_bf16_dpp v26, v16, v197 row_newbcast:1 row_mask:0xf bank_mask:0xf
  v_dot2c_f32_bf16_dpp v27, v17, v197 row_newbcast:1 row_mask:0xf bank_mask:0xf
  v_dot2c_f32_bf16_dpp v28, v16, v198 row_newbcast:1 row_mask:0xf bank_mask:0xf
  v_dot2c_f32_bf16_dpp v29, v17, v198 row_newbcast:1 row_mask:0xf bank_mask:0xf
  v_dot2c_f32_bf16_dpp v30, v16, v199 row_newbcast:1 row_mask:0xf bank_mask:0xf
  v_dot2c_f32_bf16_dpp v31, v17, v199 row_newbcast:1 row_mask:0xf bank_mask:0xf
  s_waitcnt vmcnt(3)
  s_mov_b32 s7, 1245184
  buffer_load_dwordx4 v[216:219], v39, s[60:63], s7 offen
  v_dot2c_f32_bf16_dpp v24, v16, v200 row_newbcast:2 row_mask:0xf bank_mask:0xf
  v_dot2c_f32_bf16_dpp v25, v17, v200 row_newbcast:2 row_mask:0xf bank_mask:0xf
  v_dot2c_f32_bf16_dpp v26, v16, v201 row_newbcast:2 row_mask:0xf bank_mask:0xf
  v_dot2c_f32_bf16_dpp v27, v17, v201 row_newbcast:2 row_mask:0xf bank_mask:0xf
  v_dot2c_f32_bf16_dpp v28, v16, v202 row_newbcast:2 row_mask:0xf bank_mask:0xf
  v_dot2c_f32_bf16_dpp v29, v17, v202 row_newbcast:2 row_mask:0xf bank_mask:0xf
  v_dot2c_f32_bf16_dpp v30, v16, v203 row_newbcast:2 row_mask:0xf bank_mask:0xf
  v_dot2c_f32_bf16_dpp v31, v17, v203 row_newbcast:2 row_mask:0xf bank_mask:0xf
  s_waitcnt vmcnt(3)
  s_mov_b32 s7, 1277952
  buffer_load_dwordx4 v[220:223], v39, s[60:63], s7 offen
  v_dot2c_f32_bf16_dpp v24, v16, v204 row_newbcast:3 row_mask:0xf bank_mask:0xf
  v_dot2c_f32_bf16_dpp v25, v17, v204 row_newbcast:3 row_mask:0xf bank_mask:0xf
  v_dot2c_f32_bf16_dpp v26, v16, v205 row_newbcast:3 row_mask:0xf bank_mask:0xf
  v_dot2c_f32_bf16_dpp v27, v17, v205 row_newbcast:3 row_mask:0xf bank_mask:0xf
  v_dot2c_f32_bf16_dpp v28, v16, v206 row_newbcast:3 row_mask:0xf bank_mask:0xf
  v_dot2c_f32_bf16_dpp v29, v17, v206 row_newbcast:3 row_mask:0xf bank_mask:0xf
  v_dot2c_f32_bf16_dpp v30, v16, v207 row_newbcast:3 row_mask:0xf bank_mask:0xf
  v_dot2c_f32_bf16_dpp v31, v17, v207 row_newbcast:3 row_mask:0xf bank_mask:0xf
  s_waitcnt vmcnt(3)
  v_dot2c_f32_bf16_dpp v24, v16, v208 row_newbcast:4 row_mask:0xf bank_mask:0xf
  v_dot2c_f32_bf16_dpp v25, v17, v208 row_newbcast:4 row_mask:0xf bank_mask:0xf
  v_dot2c_f32_bf16_dpp v26, v16, v209 row_newbcast:4 row_mask:0xf bank_mask:0xf
  v_dot2c_f32_bf16_dpp v27, v17, v209 row_newbcast:4 row_mask:0xf bank_mask:0xf
  v_dot2c_f32_bf16_dpp v28, v16, v210 row_newbcast:4 row_mask:0xf bank_mask:0xf
  v_dot2c_f32_bf16_dpp v29, v17, v210 row_newbcast:4 row_mask:0xf bank_mask:0xf
  v_dot2c_f32_bf16_dpp v30, v16, v211 row_newbcast:4 row_mask:0xf bank_mask:0xf
  v_dot2c_f32_bf16_dpp v31, v17, v211 row_newbcast:4 row_mask:0xf bank_mask:0xf
  s_waitcnt vmcnt(2)
  v_dot2c_f32_bf16_dpp v24, v16, v212 row_newbcast:5 row_mask:0xf bank_mask:0xf
  v_dot2c_f32_bf16_dpp v25, v17, v212 row_newbcast:5 row_mask:0xf bank_mask:0xf
  v_dot2c_f32_bf16_dpp v26, v16, v213 row_newbcast:5 row_mask:0xf bank_mask:0xf
  v_dot2c_f32_bf16_dpp v27, v17, v213 row_newbcast:5 row_mask:0xf bank_mask:0xf
  v_dot2c_f32_bf16_dpp v28, v16, v214 row_newbcast:5 row_mask:0xf bank_mask:0xf
  v_dot2c_f32_bf16_dpp v29, v17, v214 row_newbcast:5 row_mask:0xf bank_mask:0xf
  v_dot2c_f32_bf16_dpp v30, v16, v215 row_newbcast:5 row_mask:0xf bank_mask:0xf
  v_dot2c_f32_bf16_dpp v31, v17, v215 row_newbcast:5 row_mask:0xf bank_mask:0xf
  s_waitcnt vmcnt(1)
  v_dot2c_f32_bf16_dpp v24, v16, v216 row_newbcast:6 row_mask:0xf bank_mask:0xf
  v_dot2c_f32_bf16_dpp v25, v17, v216 row_newbcast:6 row_mask:0xf bank_mask:0xf
  v_dot2c_f32_bf16_dpp v26, v16, v217 row_newbcast:6 row_mask:0xf bank_mask:0xf
  v_dot2c_f32_bf16_dpp v27, v17, v217 row_newbcast:6 row_mask:0xf bank_mask:0xf
  v_dot2c_f32_bf16_dpp v28, v16, v218 row_newbcast:6 row_mask:0xf bank_mask:0xf
  v_dot2c_f32_bf16_dpp v29, v17, v218 row_newbcast:6 row_mask:0xf bank_mask:0xf
  v_dot2c_f32_bf16_dpp v30, v16, v219 row_newbcast:6 row_mask:0xf bank_mask:0xf
  v_dot2c_f32_bf16_dpp v31, v17, v219 row_newbcast:6 row_mask:0xf bank_mask:0xf
  s_waitcnt vmcnt(0)
  v_dot2c_f32_bf16_dpp v24, v16, v220 row_newbcast:7 row_mask:0xf bank_mask:0xf
  v_dot2c_f32_bf16_dpp v25, v17, v220 row_newbcast:7 row_mask:0xf bank_mask:0xf
  v_dot2c_f32_bf16_dpp v26, v16, v221 row_newbcast:7 row_mask:0xf bank_mask:0xf
  v_dot2c_f32_bf16_dpp v27, v17, v221 row_newbcast:7 row_mask:0xf bank_mask:0xf
  v_dot2c_f32_bf16_dpp v28, v16, v222 row_newbcast:7 row_mask:0xf bank_mask:0xf
  v_dot2c_f32_bf16_dpp v29, v17, v222 row_newbcast:7 row_mask:0xf bank_mask:0xf
  v_dot2c_f32_bf16_dpp v30, v16, v223 row_newbcast:7 row_mask:0xf bank_mask:0xf
  v_dot2c_f32_bf16_dpp v31, v17, v223 row_newbcast:7 row_mask:0xf bank_mask:0xf
  v_permlane32_swap_b32 v24, v25
  v_permlane32_swap_b32 v26, v27
  v_permlane32_swap_b32 v28, v29
  v_permlane32_swap_b32 v30, v31
  v_add_f32 v24, v24, v25
  v_add_f32 v26, v26, v27
  v_add_f32 v28, v28, v29
  v_add_f32 v30, v30, v31
  v_permlane16_swap_b32 v24, v26
  s_nop 0
  v_permlane16_swap_b32 v28, v30
  v_add_f32 v7, v24, v26
  v_add_f32 v8, v28, v30
  s_lshl_b32 s7, s79, 9
  v_add_u32 v5, s7, v11
  ds_write2_b32 v5, v7, v8 offset0:0 offset1:4
  v_mov_b32 v5, 0
  v_mov_b32 v6, 1
  s_waitcnt lgkmcnt(0)
  s_mov_b64 exec, 1
  ds_add_rtn_u32 v7, v5, v6 offset:3488
  s_waitcnt lgkmcnt(0)
  v_readfirstlane_b32 s7, v7
  s_mov_b64 exec, -1
  s_cmp_lg_u32 s7, 3
  s_cbranch_scc1 L_qdone
  v_lshlrev_b32 v5, 3, v1
  ds_read_b64 v[230:231], v5 offset:0
  ds_read_b64 v[232:233], v5 offset:512
  ds_read_b64 v[234:235], v5 offset:1024
  ds_read_b64 v[236:237], v5 offset:1536
  s_waitcnt lgkmcnt(0)
  v_pk_add_f32 v[230:231], v[230:231], v[232:233]
  v_pk_add_f32 v[234:235], v[234:235], v[236:237]
  v_pk_add_f32 v[230:231], v[230:231], v[234:235]
  v_cvt_pk_bf16_f32 v230, v230, v231
  v_lshlrev_b32 v5, 2, v1
  ds_write_b32 v5, v230 offset:3072
  s_waitcnt lgkmcnt(0)
L_qdone:
  s_barrier
  v_lshlrev_b32 v230, 16, v224
  v_and_b32 v231, 0xffff0000, v224
  v_lshlrev_b32 v232, 16, v225
  v_and_b32 v233, 0xffff0000, v225
  v_lshlrev_b32 v234, 16, v226
  v_and_b32 v235, 0xffff0000, v226
  v_lshlrev_b32 v236, 16, v227
  v_and_b32 v237, 0xffff0000, v227
  v_lshlrev_b32 v238, 16, v228
  v_and_b32 v239, 0xffff0000, v228
  v_add_f32 v5, v230, v231
  v_add_f32 v6, v232, v233
  v_add_f32 v7, v234, v235
  v_add_f32 v8, v236, v237
  v_add_f32 v5, v5, v6
  v_add_f32 v6, v238, v239
  v_add_f32 v7, v7, v8
  v_add_f32 v5, v5, v6
  v_add_f32 v5, v5, v7
  s_nop 1
  v_add_f32_dpp v5, v5, v5 quad_perm:[1,0,3,2] row_mask:0xf bank_mask:0xf
  s_nop 1
  v_add_f32_dpp v5, v5, v5 quad_perm:[2,3,0,1] row_mask:0xf bank_mask:0xf
  s_nop 1
  v_add_f32_dpp v5, v5, v5 row_half_mirror row_mask:0xf bank_mask:0xf
  s_nop 1
  v_add_f32_dpp v5, v5, v5 row_mirror row_mask:0xf bank_mask:0xf
  v_mov_b32 v6, v5
  s_nop 1
  v_permlane16_swap_b32 v5, v6
  v_add_f32 v5, v5, v6
  v_mov_b32 v6, v5
  s_nop 1
  v_permlane32_swap_b32 v5, v6
  v_add_f32 v5, v5, v6
  v_mul_f32 v7, 0x3acccccd, v5
  v_cvt_pk_bf16_f32 v8, 0, v7
  v_sub_f32 v6, v230, v7
  v_mul_f32 v5, v6, v6
  v_sub_f32 v6, v231, v7
  v_fmac_f32 v5, v6, v6
  v_sub_f32 v6, v232, v7
  v_fmac_f32 v5, v6, v6
  v_sub_f32 v6, v233, v7
  v_fmac_f32 v5, v6, v6
  v_sub_f32 v6, v234, v7
  v_fmac_f32 v5, v6, v6
  v_sub_f32 v6, v235, v7
  v_fmac_f32 v5, v6, v6
  v_sub_f32 v6, v236, v7
  v_fmac_f32 v5, v6, v6
  v_sub_f32 v6, v237, v7
  v_fmac_f32 v5, v6, v6
  v_sub_f32 v6, v238, v7
  v_fmac_f32 v5, v6, v6
  v_sub_f32 v6, v239, v7
  v_fmac_f32 v5, v6, v6
  s_nop 1
  v_add_f32_dpp v5, v5, v5 quad_perm:[1,0,3,2] row_mask:0xf bank_mask:0xf
  s_nop 1
  v_add_f32_dpp v5, v5, v5 quad_perm:[2,3,0,1] row_mask:0xf bank_mask:0xf
  s_nop 1
  v_add_f32_dpp v5, v5, v5 row_half_mirror row_mask:0xf bank_mask:0xf
  s_nop 1
  v_add_f32_dpp v5, v5, v5 row_mirror row_mask:0xf bank_mask:0xf
  v_mov_b32 v6, v5
  s_nop 1
  v_permlane16_swap_b32 v5, v6
  v_add_f32 v5, v5, v6
  v_mov_b32 v6, v5
  s_nop 1
  v_permlane32_swap_b32 v5, v6
  v_add_f32 v5, v5, v6
  v_mul_f32 v5, 0x3acccccd, v5
  v_cvt_pk_bf16_f32 v5, 0, v5
  v_add_f32 v5, 0x3727c5ac, v5
  v_cvt_pk_bf16_f32 v5, 0, v5
  v_sqrt_f32 v5, v5
  s_nop 0
  v_cvt_pk_bf16_f32 v5, 0, v5
  v_rcp_f32 v5, v5
  v_sub_f32 v230, v230, v8
  v_sub_f32 v231, v231, v8
  v_sub_f32 v232, v232, v8
  v_sub_f32 v233, v233, v8
  v_sub_f32 v234, v234, v8
  v_sub_f32 v235, v235, v8
  v_sub_f32 v236, v236, v8
  v_sub_f32 v237, v237, v8
  v_sub_f32 v238, v238, v8
  v_sub_f32 v239, v239, v8
  v_cvt_pk_bf16_f32 v230, 0, v230
  v_cvt_pk_bf16_f32 v231, 0, v231
  v_cvt_pk_bf16_f32 v232, 0, v232
  v_cvt_pk_bf16_f32 v233, 0, v233
  v_cvt_pk_bf16_f32 v234, 0, v234
  v_cvt_pk_bf16_f32 v235, 0, v235
  v_cvt_pk_bf16_f32 v236, 0, v236
  v_cvt_pk_bf16_f32 v237, 0, v237
  v_cvt_pk_bf16_f32 v238, 0, v238
  v_cvt_pk_bf16_f32 v239, 0, v239
  v_mul_f32 v230, v230, v5
  v_mul_f32 v231, v231, v5
  v_mul_f32 v232, v232, v5
  v_mul_f32 v233, v233, v5
  v_mul_f32 v234, v234, v5
  v_mul_f32 v235, v235, v5
  v_mul_f32 v236, v236, v5
  v_mul_f32 v237, v237, v5
  v_mul_f32 v238, v238, v5
  v_mul_f32 v239, v239, v5
  v_cvt_pk_bf16_f32 v230, 0, v230
  v_cvt_pk_bf16_f32 v231, 0, v231
  v_cvt_pk_bf16_f32 v232, 0, v232
  v_cvt_pk_bf16_f32 v233, 0, v233
  v_cvt_pk_bf16_f32 v234, 0, v234
  v_cvt_pk_bf16_f32 v235, 0, v235
  v_cvt_pk_bf16_f32 v236, 0, v236
  v_cvt_pk_bf16_f32 v237, 0, v237
  v_cvt_pk_bf16_f32 v238, 0, v238
  v_cvt_pk_bf16_f32 v239, 0, v239
  v_mov_b32 v240, v13
  v_mov_b32 v241, v15
  v_mov_b32 v242, v17
  v_add_f32 v5, v230, v231
  v_add_f32 v6, v232, v233
  v_add_f32 v7, v234, v235
  v_add_f32 v8, v236, v237
  v_add_f32 v5, v5, v6
  v_add_f32 v6, v238, v239
  v_add_f32 v7, v7, v8
  v_add_f32 v5, v5, v6
  v_add_f32 v5, v5, v7
  s_nop 1
  v_add_f32_dpp v5, v5, v5 quad_perm:[1,0,3,2] row_mask:0xf bank_mask:0xf
  s_nop 1
  v_add_f32_dpp v5, v5, v5 quad_perm:[2,3,0,1] row_mask:0xf bank_mask:0xf
  s_nop 1
  v_add_f32_dpp v5, v5, v5 row_half_mirror row_mask:0xf bank_mask:0xf
  s_nop 1
  v_add_f32_dpp v5, v5, v5 row_mirror row_mask:0xf bank_mask:0xf
  v_mov_b32 v6, v5
  s_nop 1
  v_permlane16_swap_b32 v5, v6
  v_add_f32 v5, v5, v6
  v_mov_b32 v6, v5
  s_nop 1
  v_permlane32_swap_b32 v5, v6
  v_add_f32 v5, v5, v6
  v_mul_f32 v7, 0x3acccccd, v5
  v_cvt_pk_bf16_f32 v8, 0, v7
  v_sub_f32 v6, v230, v7
  v_mul_f32 v5, v6, v6
  v_sub_f32 v6, v231, v7
  v_fmac_f32 v5, v6, v6
  v_sub_f32 v6, v232, v7
  v_fmac_f32 v5, v6, v6
  v_sub_f32 v6, v233, v7
  v_fmac_f32 v5, v6, v6
  v_sub_f32 v6, v234, v7
  v_fmac_f32 v5, v6, v6
  v_sub_f32 v6, v235, v7
  v_fmac_f32 v5, v6, v6
  v_sub_f32 v6, v236, v7
  v_fmac_f32 v5, v6, v6
  v_sub_f32 v6, v237, v7
  v_fmac_f32 v5, v6, v6
  v_sub_f32 v6, v238, v7
  v_fmac_f32 v5, v6, v6
  v_sub_f32 v6, v239, v7
  v_fmac_f32 v5, v6, v6
  s_nop 1
  v_add_f32_dpp v5, v5, v5 quad_perm:[1,0,3,2] row_mask:0xf bank_mask:0xf
  s_nop 1
  v_add_f32_dpp v5, v5, v5 quad_perm:[2,3,0,1] row_mask:0xf bank_mask:0xf
  s_nop 1
  v_add_f32_dpp v5, v5, v5 row_half_mirror row_mask:0xf bank_mask:0xf
  s_nop 1
  v_add_f32_dpp v5, v5, v5 row_mirror row_mask:0xf bank_mask:0xf
  v_mov_b32 v6, v5
  s_nop 1
  v_permlane16_swap_b32 v5, v6
  v_add_f32 v5, v5, v6
  v_mov_b32 v6, v5
  s_nop 1
  v_permlane32_swap_b32 v5, v6
  v_add_f32 v5, v5, v6
  v_mul_f32 v5, 0x3acccccd, v5
  v_cvt_pk_bf16_f32 v5, 0, v5
  v_add_f32 v5, 0x3727c5ac, v5
  v_cvt_pk_bf16_f32 v5, 0, v5
  v_sqrt_f32 v5, v5
  s_nop 0
  v_cvt_pk_bf16_f32 v5, 0, v5
  v_rcp_f32 v5, v5
  v_sub_f32 v240, v240, v8
  v_sub_f32 v241, v241, v8
  v_sub_f32 v242, v242, v8
  v_cvt_pk_bf16_f32 v240, 0, v240
  v_cvt_pk_bf16_f32 v241, 0, v241
  v_cvt_pk_bf16_f32 v242, 0, v242
  v_mul_f32 v240, v240, v5
  v_mul_f32 v241, v241, v5
  v_mul_f32 v242, v242, v5
  v_cvt_pk_bf16_f32 v240, 0, v240
  v_cvt_pk_bf16_f32 v241, 0, v241
  v_cvt_pk_bf16_f32 v242, 0, v242
  v_mov_b32 v19, v240
  v_lshrrev_b32 v18, 16, v240
  v_mov_b32 v21, v241
  v_lshrrev_b32 v20, 16, v241
  v_mov_b32 v23, v242
  v_lshrrev_b32 v22, 16, v242
  v_mov_b32 v32, 0
  v_mov_b32 v33, 0
  v_mov_b32 v34, 0
  v_mov_b32 v35, 0
  s_mul_i32 s77, s6, 108
  s_add_u32 s64, s28, s77
  s_addc_u32 s65, s29, 0
  s_and_b32 s65, s65, 0xffff
  s_sub_u32 s66, 2211840, s77
  s_mov_b32 s67, 0x20000
  s_add_u32 s56, s30, s77
  s_addc_u32 s57, s31, 0
  s_and_b32 s57, s57, 0xffff
  s_sub_u32 s58, 3456, s77
  s_mov_b32 s59, 0x20000
  s_mul_i32 s76, s78, 160
  v_add_u32 v5, s76, v3
  s_mov_b32 s7, 3456
  v_mul_lo_u32 v39, v5, s7
  v_lshl_add_u32 v39, v4, 3, v39
  v_lshlrev_b32 v9, 1, v1
  buffer_load_ushort v36, v9, s[56:59], 0 offen
  s_mov_b32 s7, 0
  buffer_load_dwordx2 v[244:245], v39, s[64:67], s7 offen
  s_mov_b32 s7, 13824
  buffer_load_dwordx2 v[246:247], v39, s[64:67], s7 offen
  s_waitcnt vmcnt(1)
  s_mov_b32 s7, 27648
  buffer_load_dwordx2 v[248:249], v39, s[64:67], s7 offen
  v_dot2c_f32_bf16_dpp v32, v18, v244 row_newbcast:0 row_mask:0xf bank_mask:0xf
  v_dot2c_f32_bf16_dpp v33, v19, v244 row_newbcast:0 row_mask:0xf bank_mask:0xf
  v_dot2c_f32_bf16_dpp v34, v18, v245 row_newbcast:0 row_mask:0xf bank_mask:0xf
  v_dot2c_f32_bf16_dpp v35, v19, v245 row_newbcast:0 row_mask:0xf bank_mask:0xf
  s_waitcnt vmcnt(1)
  s_mov_b32 s7, 41472
  buffer_load_dwordx2 v[250:251], v39, s[64:67], s7 offen
  v_dot2c_f32_bf16_dpp v32, v18, v246 row_newbcast:1 row_mask:0xf bank_mask:0xf
  v_dot2c_f32_bf16_dpp v33, v19, v246 row_newbcast:1 row_mask:0xf bank_mask:0xf
  v_dot2c_f32_bf16_dpp v34, v18, v247 row_newbcast:1 row_mask:0xf bank_mask:0xf
  v_dot2c_f32_bf16_dpp v35, v19, v247 row_newbcast:1 row_mask:0xf bank_mask:0xf
  s_waitcnt vmcnt(1)
  s_mov_b32 s7, 55296
  buffer_load_dwordx2 v[252:253], v39, s[64:67], s7 offen
  v_dot2c_f32_bf16_dpp v32, v18, v248 row_newbcast:2 row_mask:0xf bank_mask:0xf
  v_dot2c_f32_bf16_dpp v33, v19, v248 row_newbcast:2 row_mask:0xf bank_mask:0xf
  v_dot2c_f32_bf16_dpp v34, v18, v249 row_newbcast:2 row_mask:0xf bank_mask:0xf
  v_dot2c_f32_bf16_dpp v35, v19, v249 row_newbcast:2 row_mask:0xf bank_mask:0xf
  s_waitcnt vmcnt(1)
  s_mov_b32 s7, 69120
  buffer_load_dwordx2 v[254:255], v39, s[64:67], s7 offen
  v_dot2c_f32_bf16_dpp v32, v18, v250 row_newbcast:3 row_mask:0xf bank_mask:0xf
  v_dot2c_f32_bf16_dpp v33, v19, v250 row_newbcast:3 row_mask:0xf bank_mask:0xf
  v_dot2c_f32_bf16_dpp v34, v18, v251 row_newbcast:3 row_mask:0xf bank_mask:0xf
  v_dot2c_f32_bf16_dpp v35, v19, v251 row_newbcast:3 row_mask:0xf bank_mask:0xf
  s_waitcnt vmcnt(1)
  s_mov_b32 s7, 82944
  buffer_load_dwordx2 v[244:245], v39, s[64:67], s7 offen
  v_dot2c_f32_bf16_dpp v32, v18, v252 row_newbcast:4 row_mask:0xf bank_mask:0xf
  v_dot2c_f32_bf16_dpp v33, v19, v252 row_newbcast:4 row_mask:0xf bank_mask:0xf
  v_dot2c_f32_bf16_dpp v34, v18, v253 row_newbcast:4 row_mask:0xf bank_mask:0xf
  v_dot2c_f32_bf16_dpp v35, v19, v253 row_newbcast:4 row_mask:0xf bank_mask:0xf
  s_waitcnt vmcnt(1)
  s_mov_b32 s7, 96768
  buffer_load_dwordx2 v[246:247], v39, s[64:67], s7 offen
  v_dot2c_f32_bf16_dpp v32, v18, v254 row_newbcast:5 row_mask:0xf bank_mask:0xf
  v_dot2c_f32_bf16_dpp v33, v19, v254 row_newbcast:5 row_mask:0xf bank_mask:0xf
  v_dot2c_f32_bf16_dpp v34, v18, v255 row_newbcast:5 row_mask:0xf bank_mask:0xf
  v_dot2c_f32_bf16_dpp v35, v19, v255 row_newbcast:5 row_mask:0xf bank_mask:0xf
  s_waitcnt vmcnt(1)
  s_mov_b32 s7, 110592
  buffer_load_dwordx2 v[248:249], v39, s[64:67], s7 offen
  v_dot2c_f32_bf16_dpp v32, v18, v244 row_newbcast:6 row_mask:0xf bank_mask:0xf
  v_dot2c_f32_bf16_dpp v33, v19, v244 row_newbcast:6 row_mask:0xf bank_mask:0xf
  v_dot2c_f32_bf16_dpp v34, v18, v245 row_newbcast:6 row_mask:0xf bank_mask:0xf
  v_dot2c_f32_bf16_dpp v35, v19, v245 row_newbcast:6 row_mask:0xf bank_mask:0xf
  s_waitcnt vmcnt(1)
  s_mov_b32 s7, 124416
  buffer_load_dwordx2 v[250:251], v39, s[64:67], s7 offen
  v_dot2c_f32_bf16_dpp v32, v18, v246 row_newbcast:7 row_mask:0xf bank_mask:0xf
  v_dot2c_f32_bf16_dpp v33, v19, v246 row_newbcast:7 row_mask:0xf bank_mask:0xf
  v_dot2c_f32_bf16_dpp v34, v18, v247 row_newbcast:7 row_mask:0xf bank_mask:0xf
  v_dot2c_f32_bf16_dpp v35, v19, v247 row_newbcast:7 row_mask:0xf bank_mask:0xf
  s_waitcnt vmcnt(1)
  s_mov_b32 s7, 138240
  buffer_load_dwordx2 v[252:253], v39, s[64:67], s7 offen
  v_dot2c_f32_bf16_dpp v32, v18, v248 row_newbcast:8 row_mask:0xf bank_mask:0xf
  v_dot2c_f32_bf16_dpp v33, v19, v248 row_newbcast:8 row_mask:0xf bank_mask:0xf
  v_dot2c_f32_bf16_dpp v34, v18, v249 row_newbcast:8 row_mask:0xf bank_mask:0xf
  v_dot2c_f32_bf16_dpp v35, v19, v249 row_newbcast:8 row_mask:0xf bank_mask:0xf
  s_waitcnt vmcnt(1)
  s_mov_b32 s7, 152064
  buffer_load_dwordx2 v[254:255], v39, s[64:67], s7 offen
  v_dot2c_f32_bf16_dpp v32, v18, v250 row_newbcast:9 row_mask:0xf bank_mask:0xf
  v_dot2c_f32_bf16_dpp v33, v19, v250 row_newbcast:9 row_mask:0xf bank_mask:0xf
  v_dot2c_f32_bf16_dpp v34, v18, v251 row_newbcast:9 row_mask:0xf bank_mask:0xf
  v_dot2c_f32_bf16_dpp v35, v19, v251 row_newbcast:9 row_mask:0xf bank_mask:0xf
  s_waitcnt vmcnt(1)
  s_mov_b32 s7, 165888
  buffer_load_dwordx2 v[244:245], v39, s[64:67], s7 offen
  v_dot2c_f32_bf16_dpp v32, v18, v252 row_newbcast:10 row_mask:0xf bank_mask:0xf
  v_dot2c_f32_bf16_dpp v33, v19, v252 row_newbcast:10 row_mask:0xf bank_mask:0xf
  v_dot2c_f32_bf16_dpp v34, v18, v253 row_newbcast:10 row_mask:0xf bank_mask:0xf
  v_dot2c_f32_bf16_dpp v35, v19, v253 row_newbcast:10 row_mask:0xf bank_mask:0xf
  s_waitcnt vmcnt(1)
  s_mov_b32 s7, 179712
  buffer_load_dwordx2 v[246:247], v39, s[64:67], s7 offen
  v_dot2c_f32_bf16_dpp v32, v18, v254 row_newbcast:11 row_mask:0xf bank_mask:0xf
  v_dot2c_f32_bf16_dpp v33, v19, v254 row_newbcast:11 row_mask:0xf bank_mask:0xf
  v_dot2c_f32_bf16_dpp v34, v18, v255 row_newbcast:11 row_mask:0xf bank_mask:0xf
  v_dot2c_f32_bf16_dpp v35, v19, v255 row_newbcast:11 row_mask:0xf bank_mask:0xf
  s_waitcnt vmcnt(1)
  s_mov_b32 s7, 193536
  buffer_load_dwordx2 v[248:249], v39, s[64:67], s7 offen
  v_dot2c_f32_bf16_dpp v32, v18, v244 row_newbcast:12 row_mask:0xf bank_mask:0xf
  v_dot2c_f32_bf16_dpp v33, v19, v244 row_newbcast:12 row_mask:0xf bank_mask:0xf
  v_dot2c_f32_bf16_dpp v34, v18, v245 row_newbcast:12 row_mask:0xf bank_mask:0xf
  v_dot2c_f32_bf16_dpp v35, v19, v245 row_newbcast:12 row_mask:0xf bank_mask:0xf
  s_waitcnt vmcnt(1)
  s_mov_b32 s7, 207360
  buffer_load_dwordx2 v[250:251], v39, s[64:67], s7 offen
  v_dot2c_f32_bf16_dpp v32, v18, v246 row_newbcast:13 row_mask:0xf bank_mask:0xf
  v_dot2c_f32_bf16_dpp v33, v19, v246 row_newbcast:13 row_mask:0xf bank_mask:0xf
  v_dot2c_f32_bf16_dpp v34, v18, v247 row_newbcast:13 row_mask:0xf bank_mask:0xf
  v_dot2c_f32_bf16_dpp v35, v19, v247 row_newbcast:13 row_mask:0xf bank_mask:0xf
  s_waitcnt vmcnt(1)
  s_mov_b32 s7, 221184
  buffer_load_dwordx2 v[252:253], v39, s[64:67], s7 offen
  v_dot2c_f32_bf16_dpp v32, v18, v248 row_newbcast:14 row_mask:0xf bank_mask:0xf
  v_dot2c_f32_bf16_dpp v33, v19, v248 row_newbcast:14 row_mask:0xf bank_mask:0xf
  v_dot2c_f32_bf16_dpp v34, v18, v249 row_newbcast:14 row_mask:0xf bank_mask:0xf
  v_dot2c_f32_bf16_dpp v35, v19, v249 row_newbcast:14 row_mask:0xf bank_mask:0xf
  s_waitcnt vmcnt(1)
  s_mov_b32 s7, 235008
  buffer_load_dwordx2 v[254:255], v39, s[64:67], s7 offen
  v_dot2c_f32_bf16_dpp v32, v18, v250 row_newbcast:15 row_mask:0xf bank_mask:0xf
  v_dot2c_f32_bf16_dpp v33, v19, v250 row_newbcast:15 row_mask:0xf bank_mask:0xf
  v_dot2c_f32_bf16_dpp v34, v18, v251 row_newbcast:15 row_mask:0xf bank_mask:0xf
  v_dot2c_f32_bf16_dpp v35, v19, v251 row_newbcast:15 row_mask:0xf bank_mask:0xf
  s_waitcnt vmcnt(1)
  s_mov_b32 s7, 248832
  buffer_load_dwordx2 v[244:245], v39, s[64:67], s7 offen
  v_dot2c_f32_bf16_dpp v32, v20, v252 row_newbcast:0 row_mask:0xf bank_mask:0xf
  v_dot2c_f32_bf16_dpp v33, v21, v252 row_newbcast:0 row_mask:0xf bank_mask:0xf
  v_dot2c_f32_bf16_dpp v34, v20, v253 row_newbcast:0 row_mask:0xf bank_mask:0xf
  v_dot2c_f32_bf16_dpp v35, v21, v253 row_newbcast:0 row_mask:0xf bank_mask:0xf
  s_waitcnt vmcnt(1)
  s_mov_b32 s7, 262656
  buffer_load_dwordx2 v[246:247], v39, s[64:67], s7 offen
  v_dot2c_f32_bf16_dpp v32, v20, v254 row_newbcast:1 row_mask:0xf bank_mask:0xf
  v_dot2c_f32_bf16_dpp v33, v21, v254 row_newbcast:1 row_mask:0xf bank_mask:0xf
  v_dot2c_f32_bf16_dpp v34, v20, v255 row_newbcast:1 row_mask:0xf bank_mask:0xf
  v_dot2c_f32_bf16_dpp v35, v21, v255 row_newbcast:1 row_mask:0xf bank_mask:0xf
  s_waitcnt vmcnt(1)
  s_mov_b32 s7, 276480
  buffer_load_dwordx2 v[248:249], v39, s[64:67], s7 offen
  v_dot2c_f32_bf16_dpp v32, v20, v244 row_newbcast:2 row_mask:0xf bank_mask:0xf
  v_dot2c_f32_bf16_dpp v33, v21, v244 row_newbcast:2 row_mask:0xf bank_mask:0xf
  v_dot2c_f32_bf16_dpp v34, v20, v245 row_newbcast:2 row_mask:0xf bank_mask:0xf
  v_dot2c_f32_bf16_dpp v35, v21, v245 row_newbcast:2 row_mask:0xf bank_mask:0xf
  s_waitcnt vmcnt(1)
  s_mov_b32 s7, 290304
  buffer_load_dwordx2 v[250:251], v39, s[64:67], s7 offen
  v_dot2c_f32_bf16_dpp v32, v20, v246 row_newbcast:3 row_mask:0xf bank_mask:0xf
  v_dot2c_f32_bf16_dpp v33, v21, v246 row_newbcast:3 row_mask:0xf bank_mask:0xf
  v_dot2c_f32_bf16_dpp v34, v20, v247 row_newbcast:3 row_mask:0xf bank_mask:0xf
  v_dot2c_f32_bf16_dpp v35, v21, v247 row_newbcast:3 row_mask:0xf bank_mask:0xf
  s_waitcnt vmcnt(1)
  s_mov_b32 s7, 304128
  buffer_load_dwordx2 v[252:253], v39, s[64:67], s7 offen
  v_dot2c_f32_bf16_dpp v32, v20, v248 row_newbcast:4 row_mask:0xf bank_mask:0xf
  v_dot2c_f32_bf16_dpp v33, v21, v248 row_newbcast:4 row_mask:0xf bank_mask:0xf
  v_dot2c_f32_bf16_dpp v34, v20, v249 row_newbcast:4 row_mask:0xf bank_mask:0xf
  v_dot2c_f32_bf16_dpp v35, v21, v249 row_newbcast:4 row_mask:0xf bank_mask:0xf
  s_waitcnt vmcnt(1)
  s_mov_b32 s7, 317952
  buffer_load_dwordx2 v[254:255], v39, s[64:67], s7 offen
  v_dot2c_f32_bf16_dpp v32, v20, v250 row_newbcast:5 row_mask:0xf bank_mask:0xf
  v_dot2c_f32_bf16_dpp v33, v21, v250 row_newbcast:5 row_mask:0xf bank_mask:0xf
  v_dot2c_f32_bf16_dpp v34, v20, v251 row_newbcast:5 row_mask:0xf bank_mask:0xf
  v_dot2c_f32_bf16_dpp v35, v21, v251 row_newbcast:5 row_mask:0xf bank_mask:0xf
  s_waitcnt vmcnt(1)
  s_mov_b32 s7, 331776
  buffer_load_dwordx2 v[244:245], v39, s[64:67], s7 offen
  v_dot2c_f32_bf16_dpp v32, v20, v252 row_newbcast:6 row_mask:0xf bank_mask:0xf
  v_dot2c_f32_bf16_dpp v33, v21, v252 row_newbcast:6 row_mask:0xf bank_mask:0xf
  v_dot2c_f32_bf16_dpp v34, v20, v253 row_newbcast:6 row_mask:0xf bank_mask:0xf
  v_dot2c_f32_bf16_dpp v35, v21, v253 row_newbcast:6 row_mask:0xf bank_mask:0xf
  s_waitcnt vmcnt(1)
  s_mov_b32 s7, 345600
  buffer_load_dwordx2 v[246:247], v39, s[64:67], s7 offen
  v_dot2c_f32_bf16_dpp v32, v20, v254 row_newbcast:7 row_mask:0xf bank_mask:0xf
  v_dot2c_f32_bf16_dpp v33, v21, v254 row_newbcast:7 row_mask:0xf bank_mask:0xf
  v_dot2c_f32_bf16_dpp v34, v20, v255 row_newbcast:7 row_mask:0xf bank_mask:0xf
  v_dot2c_f32_bf16_dpp v35, v21, v255 row_newbcast:7 row_mask:0xf bank_mask:0xf
  s_waitcnt vmcnt(1)
  s_mov_b32 s7, 359424
  buffer_load_dwordx2 v[248:249], v39, s[64:67], s7 offen
  v_dot2c_f32_bf16_dpp v32, v20, v244 row_newbcast:8 row_mask:0xf bank_mask:0xf
  v_dot2c_f32_bf16_dpp v33, v21, v244 row_newbcast:8 row_mask:0xf bank_mask:0xf
  v_dot2c_f32_bf16_dpp v34, v20, v245 row_newbcast:8 row_mask:0xf bank_mask:0xf
  v_dot2c_f32_bf16_dpp v35, v21, v245 row_newbcast:8 row_mask:0xf bank_mask:0xf
  s_waitcnt vmcnt(1)
  s_mov_b32 s7, 373248
  buffer_load_dwordx2 v[250:251], v39, s[64:67], s7 offen
  v_dot2c_f32_bf16_dpp v32, v20, v246 row_newbcast:9 row_mask:0xf bank_mask:0xf
  v_dot2c_f32_bf16_dpp v33, v21, v246 row_newbcast:9 row_mask:0xf bank_mask:0xf
  v_dot2c_f32_bf16_dpp v34, v20, v247 row_newbcast:9 row_mask:0xf bank_mask:0xf
  v_dot2c_f32_bf16_dpp v35, v21, v247 row_newbcast:9 row_mask:0xf bank_mask:0xf
  s_waitcnt vmcnt(1)
  s_mov_b32 s7, 387072
  buffer_load_dwordx2 v[252:253], v39, s[64:67], s7 offen
  v_dot2c_f32_bf16_dpp v32, v20, v248 row_newbcast:10 row_mask:0xf bank_mask:0xf
  v_dot2c_f32_bf16_dpp v33, v21, v248 row_newbcast:10 row_mask:0xf bank_mask:0xf
  v_dot2c_f32_bf16_dpp v34, v20, v249 row_newbcast:10 row_mask:0xf bank_mask:0xf
  v_dot2c_f32_bf16_dpp v35, v21, v249 row_newbcast:10 row_mask:0xf bank_mask:0xf
  s_waitcnt vmcnt(1)
  s_mov_b32 s7, 400896
  buffer_load_dwordx2 v[254:255], v39, s[64:67], s7 offen
  v_dot2c_f32_bf16_dpp v32, v20, v250 row_newbcast:11 row_mask:0xf bank_mask:0xf
  v_dot2c_f32_bf16_dpp v33, v21, v250 row_newbcast:11 row_mask:0xf bank_mask:0xf
  v_dot2c_f32_bf16_dpp v34, v20, v251 row_newbcast:11 row_mask:0xf bank_mask:0xf
  v_dot2c_f32_bf16_dpp v35, v21, v251 row_newbcast:11 row_mask:0xf bank_mask:0xf
  s_waitcnt vmcnt(1)
  s_mov_b32 s7, 414720
  buffer_load_dwordx2 v[244:245], v39, s[64:67], s7 offen
  v_dot2c_f32_bf16_dpp v32, v20, v252 row_newbcast:12 row_mask:0xf bank_mask:0xf
  v_dot2c_f32_bf16_dpp v33, v21, v252 row_newbcast:12 row_mask:0xf bank_mask:0xf
  v_dot2c_f32_bf16_dpp v34, v20, v253 row_newbcast:12 row_mask:0xf bank_mask:0xf
  v_dot2c_f32_bf16_dpp v35, v21, v253 row_newbcast:12 row_mask:0xf bank_mask:0xf
  s_waitcnt vmcnt(1)
  s_mov_b32 s7, 428544
  buffer_load_dwordx2 v[246:247], v39, s[64:67], s7 offen
  v_dot2c_f32_bf16_dpp v32, v20, v254 row_newbcast:13 row_mask:0xf bank_mask:0xf
  v_dot2c_f32_bf16_dpp v33, v21, v254 row_newbcast:13 row_mask:0xf bank_mask:0xf
  v_dot2c_f32_bf16_dpp v34, v20, v255 row_newbcast:13 row_mask:0xf bank_mask:0xf
  v_dot2c_f32_bf16_dpp v35, v21, v255 row_newbcast:13 row_mask:0xf bank_mask:0xf
  s_waitcnt vmcnt(1)
  s_mov_b32 s7, 442368
  buffer_load_dwordx2 v[248:249], v39, s[64:67], s7 offen
  v_dot2c_f32_bf16_dpp v32, v20, v244 row_newbcast:14 row_mask:0xf bank_mask:0xf
  v_dot2c_f32_bf16_dpp v33, v21, v244 row_newbcast:14 row_mask:0xf bank_mask:0xf
  v_dot2c_f32_bf16_dpp v34, v20, v245 row_newbcast:14 row_mask:0xf bank_mask:0xf
  v_dot2c_f32_bf16_dpp v35, v21, v245 row_newbcast:14 row_mask:0xf bank_mask:0xf
  s_waitcnt vmcnt(1)
  s_mov_b32 s7, 456192
  buffer_load_dwordx2 v[250:251], v39, s[64:67], s7 offen
  v_dot2c_f32_bf16_dpp v32, v20, v246 row_newbcast:15 row_mask:0xf bank_mask:0xf
  v_dot2c_f32_bf16_dpp v33, v21, v246 row_newbcast:15 row_mask:0xf bank_mask:0xf
  v_dot2c_f32_bf16_dpp v34, v20, v247 row_newbcast:15 row_mask:0xf bank_mask:0xf
  v_dot2c_f32_bf16_dpp v35, v21, v247 row_newbcast:15 row_mask:0xf bank_mask:0xf
  s_waitcnt vmcnt(1)
  s_mov_b32 s7, 470016
  buffer_load_dwordx2 v[252:253], v39, s[64:67], s7 offen
  v_dot2c_f32_bf16_dpp v32, v22, v248 row_newbcast:0 row_mask:0xf bank_mask:0xf
  v_dot2c_f32_bf16_dpp v33, v23, v248 row_newbcast:0 row_mask:0xf bank_mask:0xf
  v_dot2c_f32_bf16_dpp v34, v22, v249 row_newbcast:0 row_mask:0xf bank_mask:0xf
  v_dot2c_f32_bf16_dpp v35, v23, v249 row_newbcast:0 row_mask:0xf bank_mask:0xf
  s_waitcnt vmcnt(1)
  s_mov_b32 s7, 483840
  buffer_load_dwordx2 v[254:255], v39, s[64:67], s7 offen
  v_dot2c_f32_bf16_dpp v32, v22, v250 row_newbcast:1 row_mask:0xf bank_mask:0xf
  v_dot2c_f32_bf16_dpp v33, v23, v250 row_newbcast:1 row_mask:0xf bank_mask:0xf
  v_dot2c_f32_bf16_dpp v34, v22, v251 row_newbcast:1 row_mask:0xf bank_mask:0xf
  v_dot2c_f32_bf16_dpp v35, v23, v251 row_newbcast:1 row_mask:0xf bank_mask:0xf
  s_waitcnt vmcnt(1)
  s_mov_b32 s7, 497664
  buffer_load_dwordx2 v[244:245], v39, s[64:67], s7 offen
  v_dot2c_f32_bf16_dpp v32, v22, v252 row_newbcast:2 row_mask:0xf bank_mask:0xf
  v_dot2c_f32_bf16_dpp v33, v23, v252 row_newbcast:2 row_mask:0xf bank_mask:0xf
  v_dot2c_f32_bf16_dpp v34, v22, v253 row_newbcast:2 row_mask:0xf bank_mask:0xf
  v_dot2c_f32_bf16_dpp v35, v23, v253 row_newbcast:2 row_mask:0xf bank_mask:0xf
  s_waitcnt vmcnt(1)
  s_mov_b32 s7, 511488
  buffer_load_dwordx2 v[246:247], v39, s[64:67], s7 offen
  v_dot2c_f32_bf16_dpp v32, v22, v254 row_newbcast:3 row_mask:0xf bank_mask:0xf
  v_dot2c_f32_bf16_dpp v33, v23, v254 row_newbcast:3 row_mask:0xf bank_mask:0xf
  v_dot2c_f32_bf16_dpp v34, v22, v255 row_newbcast:3 row_mask:0xf bank_mask:0xf
  v_dot2c_f32_bf16_dpp v35, v23, v255 row_newbcast:3 row_mask:0xf bank_mask:0xf
  s_waitcnt vmcnt(1)
  s_mov_b32 s7, 525312
  buffer_load_dwordx2 v[248:249], v39, s[64:67], s7 offen
  v_dot2c_f32_bf16_dpp v32, v22, v244 row_newbcast:4 row_mask:0xf bank_mask:0xf
  v_dot2c_f32_bf16_dpp v33, v23, v244 row_newbcast:4 row_mask:0xf bank_mask:0xf
  v_dot2c_f32_bf16_dpp v34, v22, v245 row_newbcast:4 row_mask:0xf bank_mask:0xf
  v_dot2c_f32_bf16_dpp v35, v23, v245 row_newbcast:4 row_mask:0xf bank_mask:0xf
  s_waitcnt vmcnt(1)
  s_mov_b32 s7, 539136
  buffer_load_dwordx2 v[250:251], v39, s[64:67], s7 offen
  v_dot2c_f32_bf16_dpp v32, v22, v246 row_newbcast:5 row_mask:0xf bank_mask:0xf
  v_dot2c_f32_bf16_dpp v33, v23, v246 row_newbcast:5 row_mask:0xf bank_mask:0xf
  v_dot2c_f32_bf16_dpp v34, v22, v247 row_newbcast:5 row_mask:0xf bank_mask:0xf
  v_dot2c_f32_bf16_dpp v35, v23, v247 row_newbcast:5 row_mask:0xf bank_mask:0xf
  s_waitcnt vmcnt(1)
  v_dot2c_f32_bf16_dpp v32, v22, v248 row_newbcast:6 row_mask:0xf bank_mask:0xf
  v_dot2c_f32_bf16_dpp v33, v23, v248 row_newbcast:6 row_mask:0xf bank_mask:0xf
  v_dot2c_f32_bf16_dpp v34, v22, v249 row_newbcast:6 row_mask:0xf bank_mask:0xf
  v_dot2c_f32_bf16_dpp v35, v23, v249 row_newbcast:6 row_mask:0xf bank_mask:0xf
  s_waitcnt vmcnt(0)
  v_dot2c_f32_bf16_dpp v32, v22, v250 row_newbcast:7 row_mask:0xf bank_mask:0xf
  v_dot2c_f32_bf16_dpp v33, v23, v250 row_newbcast:7 row_mask:0xf bank_mask:0xf
  v_dot2c_f32_bf16_dpp v34, v22, v251 row_newbcast:7 row_mask:0xf bank_mask:0xf
  v_dot2c_f32_bf16_dpp v35, v23, v251 row_newbcast:7 row_mask:0xf bank_mask:0xf
  s_mul_i32 s7, s6, 69120
  s_add_u32 s68, s32, s7
  s_addc_u32 s69, s33, 0
  s_and_b32 s69, s69, 0xffff
  s_sub_u32 s70, 2211840, s7
  s_mov_b32 s71, 0x20000
  s_mul_i32 s76, s79, 14
  v_add_u32 v5, s76, v3
  s_mov_b32 s7, 1280
  v_mul_lo_u32 v39, v5, s7
  v_lshl_add_u32 v39, v4, 4, v39
  s_mov_b32 s7, 0
  buffer_load_dwordx4 v[64:67], v39, s[68:71], s7 offen offset:0
  s_mov_b32 s7, 5120
  buffer_load_dwordx4 v[68:71], v39, s[68:71], s7 offen offset:0
  s_waitcnt vmcnt(1)
  s_mov_b32 s7, 10240
  buffer_load_dwordx4 v[72:75], v39, s[68:71], s7 offen offset:0
  s_waitcnt vmcnt(1)
  s_mov_b32 s7, 15360
  buffer_load_dwordx4 v[76:79], v39, s[68:71], s7 offen offset:0
  s_waitcnt vmcnt(1)
  s_mov_b32 s7, 0
  buffer_load_dwordx4 v[80:83], v39, s[68:71], s7 offen offset:256
  s_waitcnt vmcnt(1)
  s_mov_b32 s7, 5120
  buffer_load_dwordx4 v[84:87], v39, s[68:71], s7 offen offset:256
  s_waitcnt vmcnt(1)
  s_mov_b32 s7, 10240
  buffer_load_dwordx4 v[88:91], v39, s[68:71], s7 offen offset:256
  s_waitcnt vmcnt(1)
  s_mov_b32 s7, 15360
  buffer_load_dwordx4 v[92:95], v39, s[68:71], s7 offen offset:256
  s_waitcnt vmcnt(1)
  s_mov_b32 s7, 0
  buffer_load_dwordx4 v[96:99], v39, s[68:71], s7 offen offset:512
  s_waitcnt vmcnt(1)
  s_mov_b32 s7, 5120
  buffer_load_dwordx4 v[100:103], v39, s[68:71], s7 offen offset:512
  s_waitcnt vmcnt(1)
  s_mov_b32 s7, 10240
  buffer_load_dwordx4 v[104:107], v39, s[68:71], s7 offen offset:512
  s_waitcnt vmcnt(1)
  s_mov_b32 s7, 15360
  buffer_load_dwordx4 v[108:111], v39, s[68:71], s7 offen offset:512
  s_waitcnt vmcnt(1)
  s_mov_b32 s7, 0
  buffer_load_dwordx4 v[112:115], v39, s[68:71], s7 offen offset:768
  s_waitcnt vmcnt(1)
  s_mov_b32 s7, 5120
  buffer_load_dwordx4 v[116:119], v39, s[68:71], s7 offen offset:768
  s_waitcnt vmcnt(1)
  s_mov_b32 s7, 10240
  buffer_load_dwordx4 v[120:123], v39, s[68:71], s7 offen offset:768
  s_waitcnt vmcnt(1)
  s_mov_b32 s7, 15360
  buffer_load_dwordx4 v[124:127], v39, s[68:71], s7 offen offset:768
  s_waitcnt vmcnt(1)
  s_mov_b32 s7, 0
  buffer_load_dwordx4 v[128:131], v39, s[68:71], s7 offen offset:1024
  s_waitcnt vmcnt(1)
  s_mov_b32 s7, 5120
  buffer_load_dwordx4 v[132:135], v39, s[68:71], s7 offen offset:1024
  s_waitcnt vmcnt(1)
  s_mov_b32 s7, 10240
  buffer_load_dwordx4 v[136:139], v39, s[68:71], s7 offen offset:1024
  s_waitcnt vmcnt(1)
  s_mov_b32 s7, 15360
  buffer_load_dwordx4 v[140:143], v39, s[68:71], s7 offen offset:1024
  v_permlane32_swap_b32 v32, v33
  v_permlane32_swap_b32 v34, v35
  v_add_f32 v32, v32, v33
  v_add_f32 v34, v34, v35
  s_nop 1
  v_permlane16_swap_b32 v32, v34
  v_add_f32 v32, v32, v34
  v_and_b32 v9, 1, v3
  v_lshlrev_b32 v9, 1, v9
  v_lshrrev_b32 v6, 1, v3
  v_or_b32 v9, v9, v6
  v_lshl_add_u32 v5, v4, 2, v9
  v_lshlrev_b32 v5, 2, v5
  s_lshl_b32 s7, s79, 8
  v_add_u32 v5, s7, v5
  ds_write_b32 v5, v32 offset:2048
  v_mov_b32 v5, 0
  v_mov_b32 v6, 1
  s_waitcnt lgkmcnt(0)
  s_mov_b64 exec, 1
  ds_add_rtn_u32 v7, v5, v6 offset:3492
  s_waitcnt lgkmcnt(0)
  v_readfirstlane_b32 s7, v7
  s_mov_b64 exec, -1
  s_cmp_lg_u32 s7, 3
  s_cbranch_scc1 L_hwait
  v_lshlrev_b32 v5, 2, v1
  ds_read_b32 v230, v5 offset:2048
  ds_read_b32 v231, v5 offset:2304
  ds_read_b32 v232, v5 offset:2560
  ds_read_b32 v233, v5 offset:2816
  s_waitcnt lgkmcnt(0)
  v_add_f32 v230, v230, v231
  v_add_f32 v232, v232, v233
  v_add_f32 v230, v230, v232
  v_cvt_pk_bf16_f32 v230, 0, v230
  v_lshlrev_b32 v36, 16, v36
  v_add_f32 v230, v230, v36
  v_cvt_pk_bf16_f32 v230, 0, v230
  v_mul_f32 v6, v230, v230
  v_mul_f32 v6, v6, v230
  v_mov_b32 v7, 0x3d372713
  v_fma_f32 v6, v6, v7, v230
  v_mul_f32 v6, 0xc0135761, v6
  v_exp_f32 v6, v6
  s_nop 0
  v_add_f32 v6, 1.0, v6
  v_rcp_f32 v6, v6
  s_nop 0
  v_mul_f32 v230, v230, v6
  v_cvt_pk_bf16_f32 v230, v230, 0
  v_cmp_gt_u32 vcc, 54, v1
  s_nop 1
  v_cndmask_b32 v230, 0, v230, vcc
  v_lshlrev_b32 v5, 1, v1
  ds_write_b16 v5, v230 offset:3328
  v_mov_b32 v5, 0
  v_mov_b32 v6, 1
  s_waitcnt lgkmcnt(0)
  ds_write_b32 v5, v6 offset:3496
  s_waitcnt lgkmcnt(0)
L_hwait:
  v_mov_b32 v5, 0
L_hspin:
  ds_read_b32 v6, v5 offset:3496
  s_waitcnt lgkmcnt(0)
  v_readfirstlane_b32 s7, v6
  s_cmp_eq_u32 s7, 0
  s_cbranch_scc0 L_hgo
  s_branch L_hspin
L_hgo:
  s_mul_i32 s76, s79, 14
  v_lshl_add_u32 v6, v4, 2, v3
  v_add_u32 v7, s76, v6
  v_and_b32 v7, 63, v7
  v_lshlrev_b32 v7, 1, v7
  ds_read_u16 v37, v7 offset:3328
  v_cmp_gt_u32 vcc, 14, v6
  s_waitcnt lgkmcnt(0)
  s_nop 0
  v_cndmask_b32 v37, 0, v37, vcc
  v_lshlrev_b32 v38, 16, v37
  v_mov_b32 v50, 0
  v_mov_b32 v51, 0
  v_mov_b32 v52, 0
  v_mov_b32 v53, 0
  v_mov_b32 v54, 0
  v_mov_b32 v55, 0
  v_mov_b32 v56, 0
  v_mov_b32 v57, 0
  v_dot2c_f32_bf16_dpp v50, v37, v64 row_newbcast:0 row_mask:0xf bank_mask:0xf
  v_dot2c_f32_bf16_dpp v51, v38, v64 row_newbcast:0 row_mask:0xf bank_mask:0xf
  v_dot2c_f32_bf16_dpp v52, v37, v65 row_newbcast:0 row_mask:0xf bank_mask:0xf
  v_dot2c_f32_bf16_dpp v53, v38, v65 row_newbcast:0 row_mask:0xf bank_mask:0xf
  v_dot2c_f32_bf16_dpp v54, v37, v66 row_newbcast:0 row_mask:0xf bank_mask:0xf
  v_dot2c_f32_bf16_dpp v55, v38, v66 row_newbcast:0 row_mask:0xf bank_mask:0xf
  v_dot2c_f32_bf16_dpp v56, v37, v67 row_newbcast:0 row_mask:0xf bank_mask:0xf
  v_dot2c_f32_bf16_dpp v57, v38, v67 row_newbcast:0 row_mask:0xf bank_mask:0xf
  v_dot2c_f32_bf16_dpp v50, v37, v68 row_newbcast:1 row_mask:0xf bank_mask:0xf
  v_dot2c_f32_bf16_dpp v51, v38, v68 row_newbcast:1 row_mask:0xf bank_mask:0xf
  v_dot2c_f32_bf16_dpp v52, v37, v69 row_newbcast:1 row_mask:0xf bank_mask:0xf
  v_dot2c_f32_bf16_dpp v53, v38, v69 row_newbcast:1 row_mask:0xf bank_mask:0xf
  v_dot2c_f32_bf16_dpp v54, v37, v70 row_newbcast:1 row_mask:0xf bank_mask:0xf
  v_dot2c_f32_bf16_dpp v55, v38, v70 row_newbcast:1 row_mask:0xf bank_mask:0xf
  v_dot2c_f32_bf16_dpp v56, v37, v71 row_newbcast:1 row_mask:0xf bank_mask:0xf
  v_dot2c_f32_bf16_dpp v57, v38, v71 row_newbcast:1 row_mask:0xf bank_mask:0xf
  v_dot2c_f32_bf16_dpp v50, v37, v72 row_newbcast:2 row_mask:0xf bank_mask:0xf
  v_dot2c_f32_bf16_dpp v51, v38, v72 row_newbcast:2 row_mask:0xf bank_mask:0xf
  v_dot2c_f32_bf16_dpp v52, v37, v73 row_newbcast:2 row_mask:0xf bank_mask:0xf
  v_dot2c_f32_bf16_dpp v53, v38, v73 row_newbcast:2 row_mask:0xf bank_mask:0xf
  v_dot2c_f32_bf16_dpp v54, v37, v74 row_newbcast:2 row_mask:0xf bank_mask:0xf
  v_dot2c_f32_bf16_dpp v55, v38, v74 row_newbcast:2 row_mask:0xf bank_mask:0xf
  v_dot2c_f32_bf16_dpp v56, v37, v75 row_newbcast:2 row_mask:0xf bank_mask:0xf
  v_dot2c_f32_bf16_dpp v57, v38, v75 row_newbcast:2 row_mask:0xf bank_mask:0xf
  v_dot2c_f32_bf16_dpp v50, v37, v76 row_newbcast:3 row_mask:0xf bank_mask:0xf
  v_dot2c_f32_bf16_dpp v51, v38, v76 row_newbcast:3 row_mask:0xf bank_mask:0xf
  v_dot2c_f32_bf16_dpp v52, v37, v77 row_newbcast:3 row_mask:0xf bank_mask:0xf
  v_dot2c_f32_bf16_dpp v53, v38, v77 row_newbcast:3 row_mask:0xf bank_mask:0xf
  v_dot2c_f32_bf16_dpp v54, v37, v78 row_newbcast:3 row_mask:0xf bank_mask:0xf
  v_dot2c_f32_bf16_dpp v55, v38, v78 row_newbcast:3 row_mask:0xf bank_mask:0xf
  v_dot2c_f32_bf16_dpp v56, v37, v79 row_newbcast:3 row_mask:0xf bank_mask:0xf
  v_dot2c_f32_bf16_dpp v57, v38, v79 row_newbcast:3 row_mask:0xf bank_mask:0xf
  v_permlane32_swap_b32 v50, v51
  v_permlane32_swap_b32 v52, v53
  v_permlane32_swap_b32 v54, v55
  v_permlane32_swap_b32 v56, v57
  v_add_f32 v50, v50, v51
  v_add_f32 v52, v52, v53
  v_add_f32 v54, v54, v55
  v_add_f32 v56, v56, v57
  v_permlane16_swap_b32 v50, v52
  s_nop 0
  v_permlane16_swap_b32 v54, v56
  v_add_f32 v40, v50, v52
  v_add_f32 v41, v54, v56
  v_mov_b32 v50, 0
  v_mov_b32 v51, 0
  v_mov_b32 v52, 0
  v_mov_b32 v53, 0
  v_mov_b32 v54, 0
  v_mov_b32 v55, 0
  v_mov_b32 v56, 0
  v_mov_b32 v57, 0
  v_dot2c_f32_bf16_dpp v50, v37, v80 row_newbcast:0 row_mask:0xf bank_mask:0xf
  v_dot2c_f32_bf16_dpp v51, v38, v80 row_newbcast:0 row_mask:0xf bank_mask:0xf
  v_dot2c_f32_bf16_dpp v52, v37, v81 row_newbcast:0 row_mask:0xf bank_mask:0xf
  v_dot2c_f32_bf16_dpp v53, v38, v81 row_newbcast:0 row_mask:0xf bank_mask:0xf
  v_dot2c_f32_bf16_dpp v54, v37, v82 row_newbcast:0 row_mask:0xf bank_mask:0xf
  v_dot2c_f32_bf16_dpp v55, v38, v82 row_newbcast:0 row_mask:0xf bank_mask:0xf
  v_dot2c_f32_bf16_dpp v56, v37, v83 row_newbcast:0 row_mask:0xf bank_mask:0xf
  v_dot2c_f32_bf16_dpp v57, v38, v83 row_newbcast:0 row_mask:0xf bank_mask:0xf
  v_dot2c_f32_bf16_dpp v50, v37, v84 row_newbcast:1 row_mask:0xf bank_mask:0xf
  v_dot2c_f32_bf16_dpp v51, v38, v84 row_newbcast:1 row_mask:0xf bank_mask:0xf
  v_dot2c_f32_bf16_dpp v52, v37, v85 row_newbcast:1 row_mask:0xf bank_mask:0xf
  v_dot2c_f32_bf16_dpp v53, v38, v85 row_newbcast:1 row_mask:0xf bank_mask:0xf
  v_dot2c_f32_bf16_dpp v54, v37, v86 row_newbcast:1 row_mask:0xf bank_mask:0xf
  v_dot2c_f32_bf16_dpp v55, v38, v86 row_newbcast:1 row_mask:0xf bank_mask:0xf
  v_dot2c_f32_bf16_dpp v56, v37, v87 row_newbcast:1 row_mask:0xf bank_mask:0xf
  v_dot2c_f32_bf16_dpp v57, v38, v87 row_newbcast:1 row_mask:0xf bank_mask:0xf
  v_dot2c_f32_bf16_dpp v50, v37, v88 row_newbcast:2 row_mask:0xf bank_mask:0xf
  v_dot2c_f32_bf16_dpp v51, v38, v88 row_newbcast:2 row_mask:0xf bank_mask:0xf
  v_dot2c_f32_bf16_dpp v52, v37, v89 row_newbcast:2 row_mask:0xf bank_mask:0xf
  v_dot2c_f32_bf16_dpp v53, v38, v89 row_newbcast:2 row_mask:0xf bank_mask:0xf
  v_dot2c_f32_bf16_dpp v54, v37, v90 row_newbcast:2 row_mask:0xf bank_mask:0xf
  v_dot2c_f32_bf16_dpp v55, v38, v90 row_newbcast:2 row_mask:0xf bank_mask:0xf
  v_dot2c_f32_bf16_dpp v56, v37, v91 row_newbcast:2 row_mask:0xf bank_mask:0xf
  v_dot2c_f32_bf16_dpp v57, v38, v91 row_newbcast:2 row_mask:0xf bank_mask:0xf
  v_dot2c_f32_bf16_dpp v50, v37, v92 row_newbcast:3 row_mask:0xf bank_mask:0xf
  v_dot2c_f32_bf16_dpp v51, v38, v92 row_newbcast:3 row_mask:0xf bank_mask:0xf
  v_dot2c_f32_bf16_dpp v52, v37, v93 row_newbcast:3 row_mask:0xf bank_mask:0xf
  v_dot2c_f32_bf16_dpp v53, v38, v93 row_newbcast:3 row_mask:0xf bank_mask:0xf
  v_dot2c_f32_bf16_dpp v54, v37, v94 row_newbcast:3 row_mask:0xf bank_mask:0xf
  v_dot2c_f32_bf16_dpp v55, v38, v94 row_newbcast:3 row_mask:0xf bank_mask:0xf
  v_dot2c_f32_bf16_dpp v56, v37, v95 row_newbcast:3 row_mask:0xf bank_mask:0xf
  v_dot2c_f32_bf16_dpp v57, v38, v95 row_newbcast:3 row_mask:0xf bank_mask:0xf
  v_permlane32_swap_b32 v50, v51
  v_permlane32_swap_b32 v52, v53
  v_permlane32_swap_b32 v54, v55
  v_permlane32_swap_b32 v56, v57
  v_add_f32 v50, v50, v51
  v_add_f32 v52, v52, v53
  v_add_f32 v54, v54, v55
  v_add_f32 v56, v56, v57
  v_permlane16_swap_b32 v50, v52
  s_nop 0
  v_permlane16_swap_b32 v54, v56
  v_add_f32 v42, v50, v52
  v_add_f32 v43, v54, v56
  v_mov_b32 v50, 0
  v_mov_b32 v51, 0
  v_mov_b32 v52, 0
  v_mov_b32 v53, 0
  v_mov_b32 v54, 0
  v_mov_b32 v55, 0
  v_mov_b32 v56, 0
  v_mov_b32 v57, 0
  v_dot2c_f32_bf16_dpp v50, v37, v96 row_newbcast:0 row_mask:0xf bank_mask:0xf
  v_dot2c_f32_bf16_dpp v51, v38, v96 row_newbcast:0 row_mask:0xf bank_mask:0xf
  v_dot2c_f32_bf16_dpp v52, v37, v97 row_newbcast:0 row_mask:0xf bank_mask:0xf
  v_dot2c_f32_bf16_dpp v53, v38, v97 row_newbcast:0 row_mask:0xf bank_mask:0xf
  v_dot2c_f32_bf16_dpp v54, v37, v98 row_newbcast:0 row_mask:0xf bank_mask:0xf
  v_dot2c_f32_bf16_dpp v55, v38, v98 row_newbcast:0 row_mask:0xf bank_mask:0xf
  v_dot2c_f32_bf16_dpp v56, v37, v99 row_newbcast:0 row_mask:0xf bank_mask:0xf
  v_dot2c_f32_bf16_dpp v57, v38, v99 row_newbcast:0 row_mask:0xf bank_mask:0xf
  v_dot2c_f32_bf16_dpp v50, v37, v100 row_newbcast:1 row_mask:0xf bank_mask:0xf
  v_dot2c_f32_bf16_dpp v51, v38, v100 row_newbcast:1 row_mask:0xf bank_mask:0xf
  v_dot2c_f32_bf16_dpp v52, v37, v101 row_newbcast:1 row_mask:0xf bank_mask:0xf
  v_dot2c_f32_bf16_dpp v53, v38, v101 row_newbcast:1 row_mask:0xf bank_mask:0xf
  v_dot2c_f32_bf16_dpp v54, v37, v102 row_newbcast:1 row_mask:0xf bank_mask:0xf
  v_dot2c_f32_bf16_dpp v55, v38, v102 row_newbcast:1 row_mask:0xf bank_mask:0xf
  v_dot2c_f32_bf16_dpp v56, v37, v103 row_newbcast:1 row_mask:0xf bank_mask:0xf
  v_dot2c_f32_bf16_dpp v57, v38, v103 row_newbcast:1 row_mask:0xf bank_mask:0xf
  v_dot2c_f32_bf16_dpp v50, v37, v104 row_newbcast:2 row_mask:0xf bank_mask:0xf
  v_dot2c_f32_bf16_dpp v51, v38, v104 row_newbcast:2 row_mask:0xf bank_mask:0xf
  v_dot2c_f32_bf16_dpp v52, v37, v105 row_newbcast:2 row_mask:0xf bank_mask:0xf
  v_dot2c_f32_bf16_dpp v53, v38, v105 row_newbcast:2 row_mask:0xf bank_mask:0xf
  v_dot2c_f32_bf16_dpp v54, v37, v106 row_newbcast:2 row_mask:0xf bank_mask:0xf
  v_dot2c_f32_bf16_dpp v55, v38, v106 row_newbcast:2 row_mask:0xf bank_mask:0xf
  v_dot2c_f32_bf16_dpp v56, v37, v107 row_newbcast:2 row_mask:0xf bank_mask:0xf
  v_dot2c_f32_bf16_dpp v57, v38, v107 row_newbcast:2 row_mask:0xf bank_mask:0xf
  v_dot2c_f32_bf16_dpp v50, v37, v108 row_newbcast:3 row_mask:0xf bank_mask:0xf
  v_dot2c_f32_bf16_dpp v51, v38, v108 row_newbcast:3 row_mask:0xf bank_mask:0xf
  v_dot2c_f32_bf16_dpp v52, v37, v109 row_newbcast:3 row_mask:0xf bank_mask:0xf
  v_dot2c_f32_bf16_dpp v53, v38, v109 row_newbcast:3 row_mask:0xf bank_mask:0xf
  v_dot2c_f32_bf16_dpp v54, v37, v110 row_newbcast:3 row_mask:0xf bank_mask:0xf
  v_dot2c_f32_bf16_dpp v55, v38, v110 row_newbcast:3 row_mask:0xf bank_mask:0xf
  v_dot2c_f32_bf16_dpp v56, v37, v111 row_newbcast:3 row_mask:0xf bank_mask:0xf
  v_dot2c_f32_bf16_dpp v57, v38, v111 row_newbcast:3 row_mask:0xf bank_mask:0xf
  v_permlane32_swap_b32 v50, v51
  v_permlane32_swap_b32 v52, v53
  v_permlane32_swap_b32 v54, v55
  v_permlane32_swap_b32 v56, v57
  v_add_f32 v50, v50, v51
  v_add_f32 v52, v52, v53
  v_add_f32 v54, v54, v55
  v_add_f32 v56, v56, v57
  v_permlane16_swap_b32 v50, v52
  s_nop 0
  v_permlane16_swap_b32 v54, v56
  v_add_f32 v44, v50, v52
  v_add_f32 v45, v54, v56
  v_mov_b32 v50, 0
  v_mov_b32 v51, 0
  v_mov_b32 v52, 0
  v_mov_b32 v53, 0
  v_mov_b32 v54, 0
  v_mov_b32 v55, 0
  v_mov_b32 v56, 0
  v_mov_b32 v57, 0
  v_dot2c_f32_bf16_dpp v50, v37, v112 row_newbcast:0 row_mask:0xf bank_mask:0xf
  v_dot2c_f32_bf16_dpp v51, v38, v112 row_newbcast:0 row_mask:0xf bank_mask:0xf
  v_dot2c_f32_bf16_dpp v52, v37, v113 row_newbcast:0 row_mask:0xf bank_mask:0xf
  v_dot2c_f32_bf16_dpp v53, v38, v113 row_newbcast:0 row_mask:0xf bank_mask:0xf
  v_dot2c_f32_bf16_dpp v54, v37, v114 row_newbcast:0 row_mask:0xf bank_mask:0xf
  v_dot2c_f32_bf16_dpp v55, v38, v114 row_newbcast:0 row_mask:0xf bank_mask:0xf
  v_dot2c_f32_bf16_dpp v56, v37, v115 row_newbcast:0 row_mask:0xf bank_mask:0xf
  v_dot2c_f32_bf16_dpp v57, v38, v115 row_newbcast:0 row_mask:0xf bank_mask:0xf
  v_dot2c_f32_bf16_dpp v50, v37, v116 row_newbcast:1 row_mask:0xf bank_mask:0xf
  v_dot2c_f32_bf16_dpp v51, v38, v116 row_newbcast:1 row_mask:0xf bank_mask:0xf
  v_dot2c_f32_bf16_dpp v52, v37, v117 row_newbcast:1 row_mask:0xf bank_mask:0xf
  v_dot2c_f32_bf16_dpp v53, v38, v117 row_newbcast:1 row_mask:0xf bank_mask:0xf
  v_dot2c_f32_bf16_dpp v54, v37, v118 row_newbcast:1 row_mask:0xf bank_mask:0xf
  v_dot2c_f32_bf16_dpp v55, v38, v118 row_newbcast:1 row_mask:0xf bank_mask:0xf
  v_dot2c_f32_bf16_dpp v56, v37, v119 row_newbcast:1 row_mask:0xf bank_mask:0xf
  v_dot2c_f32_bf16_dpp v57, v38, v119 row_newbcast:1 row_mask:0xf bank_mask:0xf
  v_dot2c_f32_bf16_dpp v50, v37, v120 row_newbcast:2 row_mask:0xf bank_mask:0xf
  v_dot2c_f32_bf16_dpp v51, v38, v120 row_newbcast:2 row_mask:0xf bank_mask:0xf
  v_dot2c_f32_bf16_dpp v52, v37, v121 row_newbcast:2 row_mask:0xf bank_mask:0xf
  v_dot2c_f32_bf16_dpp v53, v38, v121 row_newbcast:2 row_mask:0xf bank_mask:0xf
  v_dot2c_f32_bf16_dpp v54, v37, v122 row_newbcast:2 row_mask:0xf bank_mask:0xf
  v_dot2c_f32_bf16_dpp v55, v38, v122 row_newbcast:2 row_mask:0xf bank_mask:0xf
  v_dot2c_f32_bf16_dpp v56, v37, v123 row_newbcast:2 row_mask:0xf bank_mask:0xf
  v_dot2c_f32_bf16_dpp v57, v38, v123 row_newbcast:2 row_mask:0xf bank_mask:0xf
  v_dot2c_f32_bf16_dpp v50, v37, v124 row_newbcast:3 row_mask:0xf bank_mask:0xf
  v_dot2c_f32_bf16_dpp v51, v38, v124 row_newbcast:3 row_mask:0xf bank_mask:0xf
  v_dot2c_f32_bf16_dpp v52, v37, v125 row_newbcast:3 row_mask:0xf bank_mask:0xf
  v_dot2c_f32_bf16_dpp v53, v38, v125 row_newbcast:3 row_mask:0xf bank_mask:0xf
  v_dot2c_f32_bf16_dpp v54, v37, v126 row_newbcast:3 row_mask:0xf bank_mask:0xf
  v_dot2c_f32_bf16_dpp v55, v38, v126 row_newbcast:3 row_mask:0xf bank_mask:0xf
  v_dot2c_f32_bf16_dpp v56, v37, v127 row_newbcast:3 row_mask:0xf bank_mask:0xf
  v_dot2c_f32_bf16_dpp v57, v38, v127 row_newbcast:3 row_mask:0xf bank_mask:0xf
  v_permlane32_swap_b32 v50, v51
  v_permlane32_swap_b32 v52, v53
  v_permlane32_swap_b32 v54, v55
  v_permlane32_swap_b32 v56, v57
  v_add_f32 v50, v50, v51
  v_add_f32 v52, v52, v53
  v_add_f32 v54, v54, v55
  v_add_f32 v56, v56, v57
  v_permlane16_swap_b32 v50, v52
  s_nop 0
  v_permlane16_swap_b32 v54, v56
  v_add_f32 v46, v50, v52
  v_add_f32 v47, v54, v56
  v_mov_b32 v50, 0
  v_mov_b32 v51, 0
  v_mov_b32 v52, 0
  v_mov_b32 v53, 0
  v_mov_b32 v54, 0
  v_mov_b32 v55, 0
  v_mov_b32 v56, 0
  v_mov_b32 v57, 0
  s_waitcnt vmcnt(0)
  v_dot2c_f32_bf16_dpp v50, v37, v128 row_newbcast:0 row_mask:0xf bank_mask:0xf
  v_dot2c_f32_bf16_dpp v51, v38, v128 row_newbcast:0 row_mask:0xf bank_mask:0xf
  v_dot2c_f32_bf16_dpp v52, v37, v129 row_newbcast:0 row_mask:0xf bank_mask:0xf
  v_dot2c_f32_bf16_dpp v53, v38, v129 row_newbcast:0 row_mask:0xf bank_mask:0xf
  v_dot2c_f32_bf16_dpp v54, v37, v130 row_newbcast:0 row_mask:0xf bank_mask:0xf
  v_dot2c_f32_bf16_dpp v55, v38, v130 row_newbcast:0 row_mask:0xf bank_mask:0xf
  v_dot2c_f32_bf16_dpp v56, v37, v131 row_newbcast:0 row_mask:0xf bank_mask:0xf
  v_dot2c_f32_bf16_dpp v57, v38, v131 row_newbcast:0 row_mask:0xf bank_mask:0xf
  v_dot2c_f32_bf16_dpp v50, v37, v132 row_newbcast:1 row_mask:0xf bank_mask:0xf
  v_dot2c_f32_bf16_dpp v51, v38, v132 row_newbcast:1 row_mask:0xf bank_mask:0xf
  v_dot2c_f32_bf16_dpp v52, v37, v133 row_newbcast:1 row_mask:0xf bank_mask:0xf
  v_dot2c_f32_bf16_dpp v53, v38, v133 row_newbcast:1 row_mask:0xf bank_mask:0xf
  v_dot2c_f32_bf16_dpp v54, v37, v134 row_newbcast:1 row_mask:0xf bank_mask:0xf
  v_dot2c_f32_bf16_dpp v55, v38, v134 row_newbcast:1 row_mask:0xf bank_mask:0xf
  v_dot2c_f32_bf16_dpp v56, v37, v135 row_newbcast:1 row_mask:0xf bank_mask:0xf
  v_dot2c_f32_bf16_dpp v57, v38, v135 row_newbcast:1 row_mask:0xf bank_mask:0xf
  v_dot2c_f32_bf16_dpp v50, v37, v136 row_newbcast:2 row_mask:0xf bank_mask:0xf
  v_dot2c_f32_bf16_dpp v51, v38, v136 row_newbcast:2 row_mask:0xf bank_mask:0xf
  v_dot2c_f32_bf16_dpp v52, v37, v137 row_newbcast:2 row_mask:0xf bank_mask:0xf
  v_dot2c_f32_bf16_dpp v53, v38, v137 row_newbcast:2 row_mask:0xf bank_mask:0xf
  v_dot2c_f32_bf16_dpp v54, v37, v138 row_newbcast:2 row_mask:0xf bank_mask:0xf
  v_dot2c_f32_bf16_dpp v55, v38, v138 row_newbcast:2 row_mask:0xf bank_mask:0xf
  v_dot2c_f32_bf16_dpp v56, v37, v139 row_newbcast:2 row_mask:0xf bank_mask:0xf
  v_dot2c_f32_bf16_dpp v57, v38, v139 row_newbcast:2 row_mask:0xf bank_mask:0xf
  v_dot2c_f32_bf16_dpp v50, v37, v140 row_newbcast:3 row_mask:0xf bank_mask:0xf
  v_dot2c_f32_bf16_dpp v51, v38, v140 row_newbcast:3 row_mask:0xf bank_mask:0xf
  v_dot2c_f32_bf16_dpp v52, v37, v141 row_newbcast:3 row_mask:0xf bank_mask:0xf
  v_dot2c_f32_bf16_dpp v53, v38, v141 row_newbcast:3 row_mask:0xf bank_mask:0xf
  v_dot2c_f32_bf16_dpp v54, v37, v142 row_newbcast:3 row_mask:0xf bank_mask:0xf
  v_dot2c_f32_bf16_dpp v55, v38, v142 row_newbcast:3 row_mask:0xf bank_mask:0xf
  v_dot2c_f32_bf16_dpp v56, v37, v143 row_newbcast:3 row_mask:0xf bank_mask:0xf
  v_dot2c_f32_bf16_dpp v57, v38, v143 row_newbcast:3 row_mask:0xf bank_mask:0xf
  v_permlane32_swap_b32 v50, v51
  v_permlane32_swap_b32 v52, v53
  v_permlane32_swap_b32 v54, v55
  v_permlane32_swap_b32 v56, v57
  v_add_f32 v50, v50, v51
  v_add_f32 v52, v52, v53
  v_add_f32 v54, v54, v55
  v_add_f32 v56, v56, v57
  v_permlane16_swap_b32 v50, v52
  s_nop 0
  v_permlane16_swap_b32 v54, v56
  v_add_f32 v48, v50, v52
  v_add_f32 v49, v54, v56
  s_mul_i32 s7, s79, 2560
  v_add_u32 v5, s7, v11
  v_add_u32 v5, 147456, v5
  ds_write_b32 v5, v40 offset:0
  ds_write_b32 v5, v41 offset:16
  ds_write_b32 v5, v42 offset:512
  ds_write_b32 v5, v43 offset:528
  ds_write_b32 v5, v44 offset:1024
  ds_write_b32 v5, v45 offset:1040
  ds_write_b32 v5, v46 offset:1536
  ds_write_b32 v5, v47 offset:1552
  ds_write_b32 v5, v48 offset:2048
  ds_write_b32 v5, v49 offset:2064
  s_mul_i32 s7, s5, 163840
  s_add_u32 s60, s24, s7
  s_addc_u32 s61, s25, 0
  s_and_b32 s61, s61, 0xffff
  s_sub_u32 s62, 5242880, s7
  s_mov_b32 s63, 0x20000
  s_lshl_b32 s76, s79, 5
  v_lshlrev_b32 v5, 3, v3
  v_add_u32 v5, s76, v5
  s_mov_b32 s7, 1280
  v_mul_lo_u32 v39, v5, s7
  v_lshl_add_u32 v39, v4, 4, v39
  s_mov_b32 s9, 0x05040100
  s_mov_b32 s10, 0x07060302
  s_and_b32 s7, s2, 7
  s_lshl_b32 s7, s7, 7
  s_add_u32 s7, s7, 3145728
  v_and_b32 v12, 31, v1
  v_lshlrev_b32 v12, 2, v12
  v_add_u32 v12, s7, v12
  s_lshr_b32 s76, s2, 3
  s_lshl_b32 s76, s76, 2
  s_add_u32 s76, s76, s7
  v_mov_b32 v13, s76
  s_add_u32 s11, s11, 1
  s_and_b32 s11, s11, 0xffff
  s_lshl_b32 s12, s11, 16
  s_mov_b32 s13, 0
  s_mov_b32 s14, 0
  v_mov_b32 v18, 0
  v_not_b32 v16, s12
  s_mov_b32 s7, 0
  buffer_load_dwordx4 v[224:227], v39, s[60:63], s7 offen offset:0
  s_mov_b32 s7, 1280
  buffer_load_dwordx4 v[228:231], v39, s[60:63], s7 offen offset:0
  s_waitcnt vmcnt(1)
  s_mov_b32 s7, 2560
  buffer_load_dwordx4 v[232:235], v39, s[60:63], s7 offen offset:0
  s_waitcnt vmcnt(1)
  s_mov_b32 s7, 3840
  buffer_load_dwordx4 v[236:239], v39, s[60:63], s7 offen offset:0
  s_waitcnt vmcnt(1)
  s_mov_b32 s7, 5120
  buffer_load_dwordx4 v[240:243], v39, s[60:63], s7 offen offset:0
  s_waitcnt vmcnt(1)
  s_mov_b32 s7, 6400
  buffer_load_dwordx4 v[244:247], v39, s[60:63], s7 offen offset:0
  s_waitcnt vmcnt(1)
  s_mov_b32 s7, 7680
  buffer_load_dwordx4 v[248:251], v39, s[60:63], s7 offen offset:0
  s_waitcnt vmcnt(1)
  s_mov_b32 s7, 8960
  buffer_load_dwordx4 v[252:255], v39, s[60:63], s7 offen offset:0
  s_waitcnt vmcnt(0)
  v_perm_b32 v64, v228, v224, s9
  v_perm_b32 v68, v228, v224, s10
  v_perm_b32 v65, v236, v232, s9
  v_perm_b32 v69, v236, v232, s10
  v_perm_b32 v66, v244, v240, s9
  v_perm_b32 v70, v244, v240, s10
  v_perm_b32 v67, v252, v248, s9
  v_perm_b32 v71, v252, v248, s10
  v_perm_b32 v72, v229, v225, s9
  v_perm_b32 v76, v229, v225, s10
  v_perm_b32 v73, v237, v233, s9
  v_perm_b32 v77, v237, v233, s10
  v_perm_b32 v74, v245, v241, s9
  v_perm_b32 v78, v245, v241, s10
  v_perm_b32 v75, v253, v249, s9
  v_perm_b32 v79, v253, v249, s10
  v_perm_b32 v80, v230, v226, s9
  v_perm_b32 v84, v230, v226, s10
  v_perm_b32 v81, v238, v234, s9
  v_perm_b32 v85, v238, v234, s10
  v_perm_b32 v82, v246, v242, s9
  v_perm_b32 v86, v246, v242, s10
  v_perm_b32 v83, v254, v250, s9
  v_perm_b32 v87, v254, v250, s10
  v_perm_b32 v88, v231, v227, s9
  v_perm_b32 v92, v231, v227, s10
  v_perm_b32 v89, v239, v235, s9
  v_perm_b32 v93, v239, v235, s10
  v_perm_b32 v90, v247, v243, s9
  v_perm_b32 v94, v247, v243, s10
  v_perm_b32 v91, v255, v251, s9
  v_perm_b32 v95, v255, v251, s10
  s_mov_b32 s7, 0
  buffer_load_dwordx4 v[224:227], v39, s[60:63], s7 offen offset:256
  s_mov_b32 s7, 1280
  buffer_load_dwordx4 v[228:231], v39, s[60:63], s7 offen offset:256
  s_waitcnt vmcnt(1)
  s_mov_b32 s7, 2560
  buffer_load_dwordx4 v[232:235], v39, s[60:63], s7 offen offset:256
  s_waitcnt vmcnt(1)
  s_mov_b32 s7, 3840
  buffer_load_dwordx4 v[236:239], v39, s[60:63], s7 offen offset:256
  s_waitcnt vmcnt(1)
  s_mov_b32 s7, 5120
  buffer_load_dwordx4 v[240:243], v39, s[60:63], s7 offen offset:256
  s_waitcnt vmcnt(1)
  s_mov_b32 s7, 6400
  buffer_load_dwordx4 v[244:247], v39, s[60:63], s7 offen offset:256
  s_waitcnt vmcnt(1)
  s_mov_b32 s7, 7680
  buffer_load_dwordx4 v[248:251], v39, s[60:63], s7 offen offset:256
  s_waitcnt vmcnt(1)
  s_mov_b32 s7, 8960
  buffer_load_dwordx4 v[252:255], v39, s[60:63], s7 offen offset:256
  s_waitcnt vmcnt(0)
  v_perm_b32 v96, v228, v224, s9
  v_perm_b32 v100, v228, v224, s10
  v_perm_b32 v97, v236, v232, s9
  v_perm_b32 v101, v236, v232, s10
  v_perm_b32 v98, v244, v240, s9
  v_perm_b32 v102, v244, v240, s10
  v_perm_b32 v99, v252, v248, s9
  v_perm_b32 v103, v252, v248, s10
  v_perm_b32 v104, v229, v225, s9
  v_perm_b32 v108, v229, v225, s10
  v_perm_b32 v105, v237, v233, s9
  v_perm_b32 v109, v237, v233, s10
  v_perm_b32 v106, v245, v241, s9
  v_perm_b32 v110, v245, v241, s10
  v_perm_b32 v107, v253, v249, s9
  v_perm_b32 v111, v253, v249, s10
  v_perm_b32 v112, v230, v226, s9
  v_perm_b32 v116, v230, v226, s10
  v_perm_b32 v113, v238, v234, s9
  v_perm_b32 v117, v238, v234, s10
  v_perm_b32 v114, v246, v242, s9
  v_perm_b32 v118, v246, v242, s10
  v_perm_b32 v115, v254, v250, s9
  v_perm_b32 v119, v254, v250, s10
  v_perm_b32 v120, v231, v227, s9
  v_perm_b32 v124, v231, v227, s10
  v_perm_b32 v121, v239, v235, s9
  v_perm_b32 v125, v239, v235, s10
  v_perm_b32 v122, v247, v243, s9
  v_perm_b32 v126, v247, v243, s10
  v_perm_b32 v123, v255, v251, s9
  v_perm_b32 v127, v255, v251, s10
  s_mov_b32 s7, 0
  buffer_load_dwordx4 v[224:227], v39, s[60:63], s7 offen offset:512
  s_mov_b32 s7, 1280
  buffer_load_dwordx4 v[228:231], v39, s[60:63], s7 offen offset:512
  s_waitcnt vmcnt(1)
  s_mov_b32 s7, 2560
  buffer_load_dwordx4 v[232:235], v39, s[60:63], s7 offen offset:512
  s_waitcnt vmcnt(1)
  s_mov_b32 s7, 3840
  buffer_load_dwordx4 v[236:239], v39, s[60:63], s7 offen offset:512
  s_waitcnt vmcnt(1)
  s_mov_b32 s7, 5120
  buffer_load_dwordx4 v[240:243], v39, s[60:63], s7 offen offset:512
  s_waitcnt vmcnt(1)
  s_mov_b32 s7, 6400
  buffer_load_dwordx4 v[244:247], v39, s[60:63], s7 offen offset:512
  s_waitcnt vmcnt(1)
  s_mov_b32 s7, 7680
  buffer_load_dwordx4 v[248:251], v39, s[60:63], s7 offen offset:512
  s_waitcnt vmcnt(1)
  s_mov_b32 s7, 8960
  buffer_load_dwordx4 v[252:255], v39, s[60:63], s7 offen offset:512
  s_waitcnt vmcnt(0)
  v_perm_b32 v128, v228, v224, s9
  v_perm_b32 v132, v228, v224, s10
  v_perm_b32 v129, v236, v232, s9
  v_perm_b32 v133, v236, v232, s10
  v_perm_b32 v130, v244, v240, s9
  v_perm_b32 v134, v244, v240, s10
  v_perm_b32 v131, v252, v248, s9
  v_perm_b32 v135, v252, v248, s10
  v_perm_b32 v136, v229, v225, s9
  v_perm_b32 v140, v229, v225, s10
  v_perm_b32 v137, v237, v233, s9
  v_perm_b32 v141, v237, v233, s10
  v_perm_b32 v138, v245, v241, s9
  v_perm_b32 v142, v245, v241, s10
  v_perm_b32 v139, v253, v249, s9
  v_perm_b32 v143, v253, v249, s10
  v_perm_b32 v144, v230, v226, s9
  v_perm_b32 v148, v230, v226, s10
  v_perm_b32 v145, v238, v234, s9
  v_perm_b32 v149, v238, v234, s10
  v_perm_b32 v146, v246, v242, s9
  v_perm_b32 v150, v246, v242, s10
  v_perm_b32 v147, v254, v250, s9
  v_perm_b32 v151, v254, v250, s10
  v_perm_b32 v152, v231, v227, s9
  v_perm_b32 v156, v231, v227, s10
  v_perm_b32 v153, v239, v235, s9
  v_perm_b32 v157, v239, v235, s10
  v_perm_b32 v154, v247, v243, s9
  v_perm_b32 v158, v247, v243, s10
  v_perm_b32 v155, v255, v251, s9
  v_perm_b32 v159, v255, v251, s10
  s_mov_b32 s7, 0
  buffer_load_dwordx4 v[224:227], v39, s[60:63], s7 offen offset:768
  s_mov_b32 s7, 1280
  buffer_load_dwordx4 v[228:231], v39, s[60:63], s7 offen offset:768
  s_waitcnt vmcnt(1)
  s_mov_b32 s7, 2560
  buffer_load_dwordx4 v[232:235], v39, s[60:63], s7 offen offset:768
  s_waitcnt vmcnt(1)
  s_mov_b32 s7, 3840
  buffer_load_dwordx4 v[236:239], v39, s[60:63], s7 offen offset:768
  s_waitcnt vmcnt(1)
  s_mov_b32 s7, 5120
  buffer_load_dwordx4 v[240:243], v39, s[60:63], s7 offen offset:768
  s_waitcnt vmcnt(1)
  s_mov_b32 s7, 6400
  buffer_load_dwordx4 v[244:247], v39, s[60:63], s7 offen offset:768
  s_waitcnt vmcnt(1)
  s_mov_b32 s7, 7680
  buffer_load_dwordx4 v[248:251], v39, s[60:63], s7 offen offset:768
  s_waitcnt vmcnt(1)
  s_mov_b32 s7, 8960
  buffer_load_dwordx4 v[252:255], v39, s[60:63], s7 offen offset:768
  s_waitcnt vmcnt(0)
  v_perm_b32 v160, v228, v224, s9
  v_perm_b32 v164, v228, v224, s10
  v_perm_b32 v161, v236, v232, s9
  v_perm_b32 v165, v236, v232, s10
  v_perm_b32 v162, v244, v240, s9
  v_perm_b32 v166, v244, v240, s10
  v_perm_b32 v163, v252, v248, s9
  v_perm_b32 v167, v252, v248, s10
  v_perm_b32 v168, v229, v225, s9
  v_perm_b32 v172, v229, v225, s10
  v_perm_b32 v169, v237, v233, s9
  v_perm_b32 v173, v237, v233, s10
  v_perm_b32 v170, v245, v241, s9
  v_perm_b32 v174, v245, v241, s10
  v_perm_b32 v171, v253, v249, s9
  v_perm_b32 v175, v253, v249, s10
  v_perm_b32 v176, v230, v226, s9
  v_perm_b32 v180, v230, v226, s10
  v_perm_b32 v177, v238, v234, s9
  v_perm_b32 v181, v238, v234, s10
  v_perm_b32 v178, v246, v242, s9
  v_perm_b32 v182, v246, v242, s10
  v_perm_b32 v179, v254, v250, s9
  v_perm_b32 v183, v254, v250, s10
  v_perm_b32 v184, v231, v227, s9
  v_perm_b32 v188, v231, v227, s10
  v_perm_b32 v185, v239, v235, s9
  v_perm_b32 v189, v239, v235, s10
  v_perm_b32 v186, v247, v243, s9
  v_perm_b32 v190, v247, v243, s10
  v_perm_b32 v187, v255, v251, s9
  v_perm_b32 v191, v255, v251, s10
  s_mov_b32 s7, 0
  buffer_load_dwordx4 v[224:227], v39, s[60:63], s7 offen offset:1024
  s_mov_b32 s7, 1280
  buffer_load_dwordx4 v[228:231], v39, s[60:63], s7 offen offset:1024
  s_waitcnt vmcnt(1)
  s_mov_b32 s7, 2560
  buffer_load_dwordx4 v[232:235], v39, s[60:63], s7 offen offset:1024
  s_waitcnt vmcnt(1)
  s_mov_b32 s7, 3840
  buffer_load_dwordx4 v[236:239], v39, s[60:63], s7 offen offset:1024
  s_waitcnt vmcnt(1)
  s_mov_b32 s7, 5120
  buffer_load_dwordx4 v[240:243], v39, s[60:63], s7 offen offset:1024
  s_waitcnt vmcnt(1)
  s_mov_b32 s7, 6400
  buffer_load_dwordx4 v[244:247], v39, s[60:63], s7 offen offset:1024
  s_waitcnt vmcnt(1)
  s_mov_b32 s7, 7680
  buffer_load_dwordx4 v[248:251], v39, s[60:63], s7 offen offset:1024
  s_waitcnt vmcnt(1)
  s_mov_b32 s7, 8960
  buffer_load_dwordx4 v[252:255], v39, s[60:63], s7 offen offset:1024
  s_waitcnt vmcnt(0)
  v_perm_b32 v192, v228, v224, s9
  v_perm_b32 v196, v228, v224, s10
  v_perm_b32 v193, v236, v232, s9
  v_perm_b32 v197, v236, v232, s10
  v_perm_b32 v194, v244, v240, s9
  v_perm_b32 v198, v244, v240, s10
  v_perm_b32 v195, v252, v248, s9
  v_perm_b32 v199, v252, v248, s10
  v_perm_b32 v200, v229, v225, s9
  v_perm_b32 v204, v229, v225, s10
  v_perm_b32 v201, v237, v233, s9
  v_perm_b32 v205, v237, v233, s10
  v_perm_b32 v202, v245, v241, s9
  v_perm_b32 v206, v245, v241, s10
  v_perm_b32 v203, v253, v249, s9
  v_perm_b32 v207, v253, v249, s10
  v_perm_b32 v208, v230, v226, s9
  v_perm_b32 v212, v230, v226, s10
  v_perm_b32 v209, v238, v234, s9
  v_perm_b32 v213, v238, v234, s10
  v_perm_b32 v210, v246, v242, s9
  v_perm_b32 v214, v246, v242, s10
  v_perm_b32 v211, v254, v250, s9
  v_perm_b32 v215, v254, v250, s10
  v_perm_b32 v216, v231, v227, s9
  v_perm_b32 v220, v231, v227, s10
  v_perm_b32 v217, v239, v235, s9
  v_perm_b32 v221, v239, v235, s10
  v_perm_b32 v218, v247, v243, s9
  v_perm_b32 v222, v247, v243, s10
  v_perm_b32 v219, v255, v251, s9
  v_perm_b32 v223, v255, v251, s10
  s_mul_i32 s7, s4, 1280
  s_mul_i32 s76, s5, 40
  s_add_u32 s7, s7, s76
  s_add_u32 s56, s16, s7
  s_addc_u32 s57, s17, 0
  s_and_b32 s57, s57, 0xffff
  s_mov_b32 s58, 40
  s_mov_b32 s59, 0x20000
  s_add_u32 s64, s34, s76
  s_addc_u32 s65, s35, 0
  s_and_b32 s65, s65, 0xffff
  s_mov_b32 s66, 40
  s_mov_b32 s67, 0x20000
  v_and_b32 v5, 7, v1
  v_lshlrev_b32 v5, 3, v5
  buffer_load_dwordx2 v[58:59], v5, s[56:59], 0 offen
  buffer_load_dwordx2 v[60:61], v5, s[64:67], 0 offen
  s_lshl_b32 s7, s79, 5
  v_lshlrev_b32 v6, 3, v3
  v_add_u32 v6, s7, v6
  v_lshlrev_b32 v6, 2, v6
  v_mov_b32 v5, 0
  s_mul_i32 s7, s79, 2560
  v_lshlrev_b32 v10, 5, v4
  v_lshl_add_u32 v10, v3, 4, v10
  v_add_u32 v10, s7, v10
  v_add_u32 v10, 5632, v10
  s_cmp_lg_u32 s79, 3
  s_cbranch_scc1 L_noctrl
L_ctrl:
  s_waitcnt vmcnt(0)
  s_call_b64 s[94:95], L_probe
  s_cmp_lt_u32 s14, 106
  s_cbranch_scc1 L_ctrl
  ds_write_b32 v18, v18 offset:3536
L_noctrl:
  s_waitcnt vmcnt(0)
  s_waitcnt lgkmcnt(0)
  s_barrier
  ds_read_b128 v[12:15], v5 offset:3456
  ds_read_b128 v[16:19], v5 offset:3472
  ds_read_b128 v[224:227], v6 offset:3584
  ds_read_b128 v[228:231], v6 offset:3600
  ds_read_b128 v[232:235], v6 offset:4096
  ds_read_b128 v[236:239], v6 offset:4112
  ds_read_b128 v[240:243], v6 offset:4608
  ds_read_b128 v[244:247], v6 offset:4624
  ds_read_b128 v[248:251], v6 offset:5120
  ds_read_b128 v[252:255], v6 offset:5136
  s_waitcnt lgkmcnt(8)
  v_max3_f32 v52, v12, v14, v16
  v_max_f32 v52, v52, v18
  v_sub_f32 v12, v12, v52
  v_sub_f32 v14, v14, v52
  v_sub_f32 v16, v16, v52
  v_sub_f32 v18, v18, v52
  v_mul_f32 v12, s75, v12
  v_mul_f32 v14, s75, v14
  v_mul_f32 v16, s75, v16
  v_mul_f32 v18, s75, v18
  v_exp_f32 v12, v12
  v_exp_f32 v14, v14
  v_exp_f32 v16, v16
  v_exp_f32 v18, v18
  v_mul_f32 v53, v12, v13
  v_fmac_f32 v53, v14, v15
  v_fmac_f32 v53, v16, v17
  v_fmac_f32 v53, v18, v19
  v_rcp_f32 v53, v53
  s_nop 0
  v_mul_f32 v12, v12, v53
  v_mul_f32 v14, v14, v53
  v_mul_f32 v16, v16, v53
  v_mul_f32 v18, v18, v53
  s_waitcnt lgkmcnt(0)
  v_mul_f32 v224, v12, v224
  v_mul_f32 v225, v12, v225
  v_mul_f32 v226, v12, v226
  v_mul_f32 v227, v12, v227
  v_mul_f32 v228, v12, v228
  v_mul_f32 v229, v12, v229
  v_mul_f32 v230, v12, v230
  v_mul_f32 v231, v12, v231
  v_fmac_f32 v224, v14, v232
  v_fmac_f32 v225, v14, v233
  v_fmac_f32 v226, v14, v234
  v_fmac_f32 v227, v14, v235
  v_fmac_f32 v228, v14, v236
  v_fmac_f32 v229, v14, v237
  v_fmac_f32 v230, v14, v238
  v_fmac_f32 v231, v14, v239
  v_fmac_f32 v224, v16, v240
  v_fmac_f32 v225, v16, v241
  v_fmac_f32 v226, v16, v242
  v_fmac_f32 v227, v16, v243
  v_fmac_f32 v228, v16, v244
  v_fmac_f32 v229, v16, v245
  v_fmac_f32 v230, v16, v246
  v_fmac_f32 v231, v16, v247
  v_fmac_f32 v224, v18, v248
  v_fmac_f32 v225, v18, v249
  v_fmac_f32 v226, v18, v250
  v_fmac_f32 v227, v18, v251
  v_fmac_f32 v228, v18, v252
  v_fmac_f32 v229, v18, v253
  v_fmac_f32 v230, v18, v254
  v_fmac_f32 v231, v18, v255
  v_cvt_pk_bf16_f32 v20, v224, v225
  v_cvt_pk_bf16_f32 v21, v226, v227
  v_cvt_pk_bf16_f32 v22, v228, v229
  v_cvt_pk_bf16_f32 v23, v230, v231
  s_mov_b32 s12, 65537
  s_mov_b32 s13, s12
  v_cndmask_b32 v24, 0, v20, s[12:13]
  v_cndmask_b32 v25, 0, v21, s[12:13]
  v_cndmask_b32 v26, 0, v22, s[12:13]
  v_cndmask_b32 v27, 0, v23, s[12:13]
  s_mov_b32 s12, 131074
  s_mov_b32 s13, s12
  v_cndmask_b32 v28, 0, v20, s[12:13]
  v_cndmask_b32 v29, 0, v21, s[12:13]
  v_cndmask_b32 v30, 0, v22, s[12:13]
  v_cndmask_b32 v31, 0, v23, s[12:13]
  v_mfma_f32_16x16x32_bf16 v[32:35], v[24:27], v[64:67], 0
  v_mfma_f32_16x16x32_bf16 v[36:39], v[24:27], v[96:99], 0
  v_mfma_f32_16x16x32_bf16 v[40:43], v[24:27], v[128:131], 0
  v_mfma_f32_16x16x32_bf16 v[44:47], v[24:27], v[160:163], 0
  v_mfma_f32_16x16x32_bf16 v[48:51], v[24:27], v[192:195], 0
  s_mov_b32 s12, 262148
  s_mov_b32 s13, s12
  v_cndmask_b32 v24, 0, v20, s[12:13]
  v_cndmask_b32 v25, 0, v21, s[12:13]
  v_cndmask_b32 v26, 0, v22, s[12:13]
  v_cndmask_b32 v27, 0, v23, s[12:13]
  v_mfma_f32_16x16x32_bf16 v[32:35], v[28:31], v[68:71], v[32:35]
  v_mfma_f32_16x16x32_bf16 v[36:39], v[28:31], v[100:103], v[36:39]
  v_mfma_f32_16x16x32_bf16 v[40:43], v[28:31], v[132:135], v[40:43]
  v_mfma_f32_16x16x32_bf16 v[44:47], v[28:31], v[164:167], v[44:47]
  v_mfma_f32_16x16x32_bf16 v[48:51], v[28:31], v[196:199], v[48:51]
  s_mov_b32 s12, 524296
  s_mov_b32 s13, s12
  v_cndmask_b32 v28, 0, v20, s[12:13]
  v_cndmask_b32 v29, 0, v21, s[12:13]
  v_cndmask_b32 v30, 0, v22, s[12:13]
  v_cndmask_b32 v31, 0, v23, s[12:13]
  v_mfma_f32_16x16x32_bf16 v[32:35], v[24:27], v[72:75], v[32:35]
  v_mfma_f32_16x16x32_bf16 v[36:39], v[24:27], v[104:107], v[36:39]
  v_mfma_f32_16x16x32_bf16 v[40:43], v[24:27], v[136:139], v[40:43]
  v_mfma_f32_16x16x32_bf16 v[44:47], v[24:27], v[168:171], v[44:47]
  v_mfma_f32_16x16x32_bf16 v[48:51], v[24:27], v[200:203], v[48:51]
  s_mov_b32 s12, 1048592
  s_mov_b32 s13, s12
  v_cndmask_b32 v24, 0, v20, s[12:13]
  v_cndmask_b32 v25, 0, v21, s[12:13]
  v_cndmask_b32 v26, 0, v22, s[12:13]
  v_cndmask_b32 v27, 0, v23, s[12:13]
  v_mfma_f32_16x16x32_bf16 v[32:35], v[28:31], v[76:79], v[32:35]
  v_mfma_f32_16x16x32_bf16 v[36:39], v[28:31], v[108:111], v[36:39]
  v_mfma_f32_16x16x32_bf16 v[40:43], v[28:31], v[140:143], v[40:43]
  v_mfma_f32_16x16x32_bf16 v[44:47], v[28:31], v[172:175], v[44:47]
  v_mfma_f32_16x16x32_bf16 v[48:51], v[28:31], v[204:207], v[48:51]
  s_mov_b32 s12, 2097184
  s_mov_b32 s13, s12
  v_cndmask_b32 v28, 0, v20, s[12:13]
  v_cndmask_b32 v29, 0, v21, s[12:13]
  v_cndmask_b32 v30, 0, v22, s[12:13]
  v_cndmask_b32 v31, 0, v23, s[12:13]
  v_mfma_f32_16x16x32_bf16 v[32:35], v[24:27], v[80:83], v[32:35]
  v_mfma_f32_16x16x32_bf16 v[36:39], v[24:27], v[112:115], v[36:39]
  v_mfma_f32_16x16x32_bf16 v[40:43], v[24:27], v[144:147], v[40:43]
  v_mfma_f32_16x16x32_bf16 v[44:47], v[24:27], v[176:179], v[44:47]
  v_mfma_f32_16x16x32_bf16 v[48:51], v[24:27], v[208:211], v[48:51]
  s_mov_b32 s12, 4194368
  s_mov_b32 s13, s12
  v_cndmask_b32 v24, 0, v20, s[12:13]
  v_cndmask_b32 v25, 0, v21, s[12:13]
  v_cndmask_b32 v26, 0, v22, s[12:13]
  v_cndmask_b32 v27, 0, v23, s[12:13]
  v_mfma_f32_16x16x32_bf16 v[32:35], v[28:31], v[84:87], v[32:35]
  v_mfma_f32_16x16x32_bf16 v[36:39], v[28:31], v[116:119], v[36:39]
  v_mfma_f32_16x16x32_bf16 v[40:43], v[28:31], v[148:151], v[40:43]
  v_mfma_f32_16x16x32_bf16 v[44:47], v[28:31], v[180:183], v[44:47]
  v_mfma_f32_16x16x32_bf16 v[48:51], v[28:31], v[212:215], v[48:51]
  s_mov_b32 s12, 8388736
  s_mov_b32 s13, s12
  v_cndmask_b32 v28, 0, v20, s[12:13]
  v_cndmask_b32 v29, 0, v21, s[12:13]
  v_cndmask_b32 v30, 0, v22, s[12:13]
  v_cndmask_b32 v31, 0, v23, s[12:13]
  v_mfma_f32_16x16x32_bf16 v[32:35], v[24:27], v[88:91], v[32:35]
  v_mfma_f32_16x16x32_bf16 v[36:39], v[24:27], v[120:123], v[36:39]
  v_mfma_f32_16x16x32_bf16 v[40:43], v[24:27], v[152:155], v[40:43]
  v_mfma_f32_16x16x32_bf16 v[44:47], v[24:27], v[184:187], v[44:47]
  v_mfma_f32_16x16x32_bf16 v[48:51], v[24:27], v[216:219], v[48:51]
  v_mfma_f32_16x16x32_bf16 v[32:35], v[28:31], v[92:95], v[32:35]
  v_mfma_f32_16x16x32_bf16 v[36:39], v[28:31], v[124:127], v[36:39]
  v_mfma_f32_16x16x32_bf16 v[40:43], v[28:31], v[156:159], v[40:43]
  v_mfma_f32_16x16x32_bf16 v[44:47], v[28:31], v[188:191], v[44:47]
  v_mfma_f32_16x16x32_bf16 v[48:51], v[28:31], v[220:223], v[48:51]
  s_mov_b32 exec_hi, 0
  s_nop 2
  ds_write_b128 v10, v[32:35] offset:0
  ds_write_b128 v10, v[36:39] offset:512
  ds_write_b128 v10, v[40:43] offset:1024
  ds_write_b128 v10, v[44:47] offset:1536
  ds_write_b128 v10, v[48:51] offset:2048
  s_mov_b32 exec_hi, -1
  s_waitcnt lgkmcnt(0)
  s_barrier
  s_and_b32 s77, s100, 0xff
  s_cmp_eq_u32 s3, 3
  s_cbranch_scc1 L_cons
  v_cmp_gt_u32 vcc, 160, v0
  s_nop 3
  s_and_saveexec_b64 s[96:97], vcc
  v_lshlrev_b32 v5, 4, v0
  ds_read_b128 v[64:67], v5 offset:5632
  ds_read_b128 v[68:71], v5 offset:8192
  ds_read_b128 v[72:75], v5 offset:10752
  ds_read_b128 v[76:79], v5 offset:13312
  v_add_u32 v10, 147456, v5
  ds_read_b128 v[80:83], v10 offset:0
  ds_read_b128 v[84:87], v10 offset:2560
  ds_read_b128 v[88:91], v10 offset:5120
  ds_read_b128 v[92:95], v10 offset:7680
  s_mul_i32 s7, s4, 81920
  s_add_u32 s7, s7, 4096
  s_add_u32 s52, s40, s7
  s_addc_u32 s53, s41, 0
  s_and_b32 s53, s53, 0xffff
  s_mov_b32 s54, 81920
  s_mov_b32 s55, 0x20000
  v_mul_u32_u24 v6, 205, v0
  v_lshrrev_b32 v6, 10, v6
  v_mul_u32_u24 v7, 5, v6
  v_sub_u32 v7, v0, v7
  v_mul_u32_u24 v6, 2560, v6
  v_lshl_add_u32 v6, v7, 4, v6
  s_mul_i32 s7, s5, 80
  v_mov_b32 v8, 0xffffff00
  v_mov_b32 v9, s77
  s_waitcnt lgkmcnt(0)
  v_add_f32 v64, v64, v80
  v_add_f32 v65, v65, v81
  v_add_f32 v66, v66, v82
  v_add_f32 v67, v67, v83
  v_add_f32 v68, v68, v84
  v_add_f32 v69, v69, v85
  v_add_f32 v70, v70, v86
  v_add_f32 v71, v71, v87
  v_add_f32 v72, v72, v88
  v_add_f32 v73, v73, v89
  v_add_f32 v74, v74, v90
  v_add_f32 v75, v75, v91
  v_add_f32 v76, v76, v92
  v_add_f32 v77, v77, v93
  v_add_f32 v78, v78, v94
  v_add_f32 v79, v79, v95
  v_add_f32 v64, v64, v68
  v_add_f32 v72, v72, v76
  v_add_f32 v65, v65, v69
  v_add_f32 v73, v73, v77
  v_add_f32 v66, v66, v70
  v_add_f32 v74, v74, v78
  v_add_f32 v67, v67, v71
  v_add_f32 v75, v75, v79
  v_add_f32 v64, v64, v72
  v_add_f32 v65, v65, v73
  v_add_f32 v66, v66, v74
  v_add_f32 v67, v67, v75
  v_add_u32 v64, 0x80, v64
  v_add_u32 v65, 0x80, v65
  v_add_u32 v66, 0x80, v66
  v_add_u32 v67, 0x80, v67
  v_and_or_b32 v64, v64, v8, v9
  v_and_or_b32 v65, v65, v8, v9
  v_and_or_b32 v66, v66, v8, v9
  v_and_or_b32 v67, v67, v8, v9
  buffer_store_dwordx4 v[64:67], v6, s[52:55], s7 offen sc0 sc1
  s_branch L_fin
L_cons:
  s_mul_i32 s7, s2, 2560
  s_add_u32 s7, s7, 4096
  s_add_u32 s52, s40, s7
  s_addc_u32 s53, s41, 0
  s_and_b32 s53, s53, 0xffff
  s_mov_b32 s54, 2560
  s_mov_b32 s55, 0x20000
  v_lshrrev_b32 v5, 3, v1
  v_and_b32 v9, 7, v1
  v_mul_u32_u24 v6, 80, v5
  v_lshl_add_u32 v6, v9, 4, v6
  s_mov_b32 s101, 0
  v_mov_b32 v10, s77
L_poll2:
  buffer_load_dwordx4 v[64:67], v6, s[52:55], 0 offen offset:0 sc0 sc1
  buffer_load_dwordx4 v[68:71], v6, s[52:55], 0 offen offset:640 sc0 sc1
  buffer_load_dwordx4 v[72:75], v6, s[52:55], 0 offen offset:1280 sc0 sc1
  buffer_load_dwordx4 v[76:79], v6, s[52:55], 0 offen offset:1920 sc0 sc1
  s_add_u32 s101, s101, 1
  s_waitcnt vmcnt(0)
  v_xor_b32 v84, v10, v64
  v_xor_b32 v85, v10, v65
  v_xor_b32 v86, v10, v66
  v_xor_b32 v87, v10, v67
  v_xor_b32 v88, v10, v68
  v_xor_b32 v89, v10, v69
  v_xor_b32 v90, v10, v70
  v_xor_b32 v91, v10, v71
  v_xor_b32 v92, v10, v72
  v_xor_b32 v93, v10, v73
  v_xor_b32 v94, v10, v74
  v_xor_b32 v95, v10, v75
  v_xor_b32 v96, v10, v76
  v_xor_b32 v97, v10, v77
  v_xor_b32 v98, v10, v78
  v_xor_b32 v99, v10, v79
  v_or3_b32 v84, v84, v85, v86
  v_or3_b32 v87, v87, v88, v89
  v_or3_b32 v90, v90, v91, v92
  v_or3_b32 v93, v93, v94, v95
  v_or3_b32 v96, v96, v97, v98
  v_or3_b32 v84, v84, v87, v90
  v_or3_b32 v93, v93, v96, v99
  v_or_b32 v84, v84, v93
  v_and_b32 v84, 0xff, v84
  v_cmp_gt_u32 vcc, 5, v9
  s_nop 1
  v_cndmask_b32 v84, 0, v84, vcc
  v_cmp_ne_u32 vcc, 0, v84
  s_cmp_gt_u32 s101, 200000
  s_cbranch_scc1 L_fin
  s_cmp_eq_u64 vcc, 0
  s_cbranch_scc0 L_poll2
  v_and_b32 v64, 0xffffff00, v64
  v_and_b32 v65, 0xffffff00, v65
  v_and_b32 v66, 0xffffff00, v66
  v_and_b32 v67, 0xffffff00, v67
  v_and_b32 v68, 0xffffff00, v68
  v_and_b32 v69, 0xffffff00, v69
  v_and_b32 v70, 0xffffff00, v70
  v_and_b32 v71, 0xffffff00, v71
  v_and_b32 v72, 0xffffff00, v72
  v_and_b32 v73, 0xffffff00, v73
  v_and_b32 v74, 0xffffff00, v74
  v_and_b32 v75, 0xffffff00, v75
  v_and_b32 v76, 0xffffff00, v76
  v_and_b32 v77, 0xffffff00, v77
  v_and_b32 v78, 0xffffff00, v78
  v_and_b32 v79, 0xffffff00, v79
  v_add_f32 v64, v64, v68
  v_add_f32 v72, v72, v76
  v_add_f32 v65, v65, v69
  v_add_f32 v73, v73, v77
  v_add_f32 v66, v66, v70
  v_add_f32 v74, v74, v78
  v_add_f32 v67, v67, v71
  v_add_f32 v75, v75, v79
  v_add_f32 v64, v64, v72
  v_add_f32 v65, v65, v73
  v_add_f32 v66, v66, v74
  v_add_f32 v67, v67, v75
  v_add_f32_dpp v64, v64, v64 row_ror:8 row_mask:0xf bank_mask:0xf
  v_add_f32_dpp v65, v65, v65 row_ror:8 row_mask:0xf bank_mask:0xf
  v_add_f32_dpp v66, v66, v66 row_ror:8 row_mask:0xf bank_mask:0xf
  v_add_f32_dpp v67, v67, v67 row_ror:8 row_mask:0xf bank_mask:0xf
  v_mov_b32 v68, v64
  v_mov_b32 v69, v65
  v_mov_b32 v70, v66
  v_mov_b32 v71, v67
  v_permlane16_swap_b32 v64, v68
  v_permlane16_swap_b32 v65, v69
  v_permlane16_swap_b32 v66, v70
  v_permlane16_swap_b32 v67, v71
  v_add_f32 v64, v64, v68
  v_add_f32 v65, v65, v69
  v_add_f32 v66, v66, v70
  v_add_f32 v67, v67, v71
  v_mov_b32 v68, v64
  v_mov_b32 v69, v65
  v_mov_b32 v70, v66
  v_mov_b32 v71, v67
  v_permlane32_swap_b32 v64, v68
  v_permlane32_swap_b32 v65, v69
  v_permlane32_swap_b32 v66, v70
  v_permlane32_swap_b32 v67, v71
  v_add_f32 v64, v64, v68
  v_add_f32 v65, v65, v69
  v_add_f32 v66, v66, v70
  v_add_f32 v67, v67, v71
  v_lshlrev_b32 v7, 16, v60
  v_add_f32 v64, v64, v7
  v_lshlrev_b32 v7, 16, v58
  v_add_f32 v64, v64, v7
  v_and_b32 v7, 0xffff0000, v60
  v_add_f32 v65, v65, v7
  v_and_b32 v7, 0xffff0000, v58
  v_add_f32 v65, v65, v7
  v_lshlrev_b32 v7, 16, v61
  v_add_f32 v66, v66, v7
  v_lshlrev_b32 v7, 16, v59
  v_add_f32 v66, v66, v7
  v_and_b32 v7, 0xffff0000, v61
  v_add_f32 v67, v67, v7
  v_and_b32 v7, 0xffff0000, v59
  v_add_f32 v67, v67, v7
  v_cvt_pk_bf16_f32 v68, v64, v65
  v_cvt_pk_bf16_f32 v69, v66, v67
  s_mul_i32 s7, s4, 1280
  s_mul_i32 s76, s5, 40
  s_add_u32 s7, s7, s76
  s_add_u32 s64, s36, s7
  s_addc_u32 s65, s37, 0
  s_and_b32 s65, s65, 0xffff
  s_mov_b32 s66, 40
  s_mov_b32 s67, 0x20000
  v_lshlrev_b32 v5, 3, v1
  buffer_store_dwordx2 v[68:69], v5, s[64:67], 0 offen
  s_cmp_lg_u32 s5, 0
  s_cbranch_scc1 L_fin
  s_lshl_b32 s7, s4, 8
  s_add_u32 s60, s40, s7
  s_addc_u32 s61, s41, 0
  s_and_b32 s61, s61, 0xffff
  s_mov_b32 s62, 4
  s_mov_b32 s63, 0x20000
  v_mov_b32 v7, s100
  buffer_store_dword v7, v5, s[60:63], 0 offen sc0 sc1
  s_branch L_fin
L_stream:
  s_mov_b32 s74, 0x3db504f3
  s_lshl_b32 s9, s79, 12
  s_mov_b32 s72, s9
  v_lshrrev_b32 v5, 2, v4
  v_lshl_add_u32 v5, v3, 2, v5
  s_lshl_b32 s7, s79, 9
  v_add_u32 v5, s7, v5
  v_lshlrev_b32 v25, 3, v5
  v_add_u32 v25, 15872, v25
  s_waitcnt lgkmcnt(0)
  s_lshl_b32 s7, s2, 20
  s_add_u32 s44, s18, s7
  s_addc_u32 s45, s19, 0
  s_and_b32 s45, s45, 0xffff
  s_mov_b32 s46, 1048576
  s_mov_b32 s47, 0x20000
  s_add_u32 s48, s20, s7
  s_addc_u32 s49, s21, 0
  s_and_b32 s49, s49, 0xffff
  s_mov_b32 s50, 1048576
  s_mov_b32 s51, 0x20000
  s_mul_i32 s8, s79, 28672
  s_add_u32 s8, s8, 32768
  v_add_u32 v42, s8, v2
  buffer_load_dwordx4 v[76:79], v2, s[44:47], s72 offen offset:0 nt
  buffer_load_dwordx4 v[80:83], v2, s[44:47], s72 offen offset:1024 nt
  buffer_load_dwordx4 v[84:87], v2, s[44:47], s72 offen offset:2048 nt
  buffer_load_dwordx4 v[88:91], v2, s[44:47], s72 offen offset:3072 nt
  s_add_u32 s72, s72, 16384
  buffer_load_dwordx4 v[92:95], v2, s[44:47], s72 offen offset:0 nt
  s_barrier
  s_waitcnt vmcnt(4)
  buffer_load_dwordx4 v[96:99], v2, s[44:47], s72 offen offset:1024 nt
  s_waitcnt vmcnt(4)
  buffer_load_dwordx4 v[100:103], v2, s[44:47], s72 offen offset:2048 nt
  s_waitcnt vmcnt(4)
  buffer_load_dwordx4 v[104:107], v2, s[44:47], s72 offen offset:3072 nt
  s_add_u32 s72, s72, 16384
  s_waitcnt vmcnt(4)
  buffer_load_dwordx4 v[108:111], v2, s[44:47], s72 offen offset:0 nt
  s_waitcnt vmcnt(4)
  buffer_load_dwordx4 v[112:115], v2, s[44:47], s72 offen offset:1024 nt
  s_waitcnt vmcnt(4)
  buffer_load_dwordx4 v[116:119], v2, s[44:47], s72 offen offset:2048 nt
  s_waitcnt vmcnt(4)
  buffer_load_dwordx4 v[120:123], v2, s[44:47], s72 offen offset:3072 nt
  s_add_u32 s72, s72, 16384
  s_waitcnt vmcnt(4)
  buffer_load_dwordx4 v[124:127], v2, s[44:47], s72 offen offset:0 nt
  s_waitcnt vmcnt(4)
  buffer_load_dwordx4 v[128:131], v2, s[44:47], s72 offen offset:1024 nt
  s_waitcnt vmcnt(4)
  buffer_load_dwordx4 v[132:135], v2, s[44:47], s72 offen offset:2048 nt
  s_waitcnt vmcnt(4)
  buffer_load_dwordx4 v[136:139], v2, s[44:47], s72 offen offset:3072 nt
  s_add_u32 s72, s72, 16384
  s_waitcnt vmcnt(4)
  buffer_load_dwordx4 v[140:143], v2, s[44:47], s72 offen offset:0 nt
  s_waitcnt vmcnt(4)
  buffer_load_dwordx4 v[144:147], v2, s[44:47], s72 offen offset:1024 nt
  s_waitcnt vmcnt(4)
  buffer_load_dwordx4 v[148:151], v2, s[44:47], s72 offen offset:2048 nt
  s_waitcnt vmcnt(4)
  buffer_load_dwordx4 v[152:155], v2, s[44:47], s72 offen offset:3072 nt
  s_add_u32 s72, s72, 16384
  s_waitcnt vmcnt(4)
  buffer_load_dwordx4 v[156:159], v2, s[44:47], s72 offen offset:0 nt
  s_waitcnt vmcnt(4)
  buffer_load_dwordx4 v[160:163], v2, s[44:47], s72 offen offset:1024 nt
  s_waitcnt vmcnt(4)
  buffer_load_dwordx4 v[164:167], v2, s[44:47], s72 offen offset:2048 nt
  s_waitcnt vmcnt(4)
  buffer_load_dwordx4 v[168:171], v2, s[44:47], s72 offen offset:3072 nt
  s_add_u32 s72, s72, 16384
  s_waitcnt vmcnt(4)
  buffer_load_dwordx4 v[172:175], v2, s[44:47], s72 offen offset:0 nt
  s_waitcnt vmcnt(4)
  buffer_load_dwordx4 v[176:179], v2, s[44:47], s72 offen offset:1024 nt
  s_waitcnt vmcnt(4)
  buffer_load_dwordx4 v[180:183], v2, s[44:47], s72 offen offset:2048 nt
  s_waitcnt vmcnt(4)
  buffer_load_dwordx4 v[184:187], v2, s[44:47], s72 offen offset:3072 nt
  s_add_u32 s72, s72, 16384
  s_waitcnt vmcnt(4)
  buffer_load_dwordx4 v[188:191], v2, s[44:47], s72 offen offset:0 nt
  s_waitcnt vmcnt(4)
  buffer_load_dwordx4 v[192:195], v2, s[44:47], s72 offen offset:1024 nt
  s_waitcnt vmcnt(4)
  buffer_load_dwordx4 v[196:199], v2, s[44:47], s72 offen offset:2048 nt
  s_waitcnt vmcnt(4)
  buffer_load_dwordx4 v[200:203], v2, s[44:47], s72 offen offset:3072 nt
  s_add_u32 s72, s72, 16384
  s_waitcnt vmcnt(4)
  buffer_load_dwordx4 v[204:207], v2, s[44:47], s72 offen offset:0 nt
  s_waitcnt vmcnt(4)
  buffer_load_dwordx4 v[208:211], v2, s[44:47], s72 offen offset:1024 nt
  s_waitcnt vmcnt(4)
  buffer_load_dwordx4 v[212:215], v2, s[44:47], s72 offen offset:2048 nt
  s_waitcnt vmcnt(4)
  buffer_load_dwordx4 v[216:219], v2, s[44:47], s72 offen offset:3072 nt
  s_add_u32 s72, s72, 16384
  s_waitcnt vmcnt(4)
  buffer_load_dwordx4 v[220:223], v2, s[44:47], s72 offen offset:0 nt
  s_waitcnt vmcnt(4)
  buffer_load_dwordx4 v[224:227], v2, s[44:47], s72 offen offset:1024 nt
  s_waitcnt vmcnt(4)
  buffer_load_dwordx4 v[228:231], v2, s[44:47], s72 offen offset:2048 nt
  s_waitcnt vmcnt(4)
  buffer_load_dwordx4 v[232:235], v2, s[44:47], s72 offen offset:3072 nt
  s_add_u32 s72, s72, 16384
  s_waitcnt vmcnt(4)
  s_add_u32 m0, s8, 0
  s_nop 0
  buffer_load_dwordx4 v2, s[44:47], s72 offen offset:0 nt lds
  s_waitcnt vmcnt(4)
  s_add_u32 m0, s8, 0
  s_nop 0
  buffer_load_dwordx4 v2, s[44:47], s72 offen offset:1024 nt lds
  s_waitcnt vmcnt(4)
  s_add_u32 m0, s8, 0
  s_nop 0
  buffer_load_dwordx4 v2, s[44:47], s72 offen offset:2048 nt lds
  s_waitcnt vmcnt(4)
  s_add_u32 m0, s8, 0
  s_nop 0
  buffer_load_dwordx4 v2, s[44:47], s72 offen offset:3072 nt lds
  s_add_u32 s72, s72, 16384
  s_waitcnt vmcnt(4)
  s_add_u32 m0, s8, 4096
  s_nop 0
  buffer_load_dwordx4 v2, s[44:47], s72 offen offset:0 nt lds
  s_waitcnt vmcnt(4)
  s_add_u32 m0, s8, 4096
  s_nop 0
  buffer_load_dwordx4 v2, s[44:47], s72 offen offset:1024 nt lds
  s_waitcnt vmcnt(4)
  s_add_u32 m0, s8, 4096
  s_nop 0
  buffer_load_dwordx4 v2, s[44:47], s72 offen offset:2048 nt lds
  s_waitcnt vmcnt(4)
  s_add_u32 m0, s8, 4096
  s_nop 0
  buffer_load_dwordx4 v2, s[44:47], s72 offen offset:3072 nt lds
  s_add_u32 s72, s72, 16384
  s_waitcnt vmcnt(4)
  s_add_u32 m0, s8, 8192
  s_nop 0
  buffer_load_dwordx4 v2, s[44:47], s72 offen offset:0 nt lds
  s_waitcnt vmcnt(4)
  s_add_u32 m0, s8, 8192
  s_nop 0
  buffer_load_dwordx4 v2, s[44:47], s72 offen offset:1024 nt lds
  s_waitcnt vmcnt(4)
  s_add_u32 m0, s8, 8192
  s_nop 0
  buffer_load_dwordx4 v2, s[44:47], s72 offen offset:2048 nt lds
  s_waitcnt vmcnt(4)
  s_add_u32 m0, s8, 8192
  s_nop 0
  buffer_load_dwordx4 v2, s[44:47], s72 offen offset:3072 nt lds
  s_add_u32 s72, s72, 16384
  s_waitcnt vmcnt(4)
  s_add_u32 m0, s8, 12288
  s_nop 0
  buffer_load_dwordx4 v2, s[44:47], s72 offen offset:0 nt lds
  s_waitcnt vmcnt(4)
  s_add_u32 m0, s8, 12288
  s_nop 0
  buffer_load_dwordx4 v2, s[44:47], s72 offen offset:1024 nt lds
  s_waitcnt vmcnt(4)
  s_add_u32 m0, s8, 12288
  s_nop 0
  buffer_load_dwordx4 v2, s[44:47], s72 offen offset:2048 nt lds
  s_waitcnt vmcnt(4)
  s_add_u32 m0, s8, 12288
  s_nop 0
  buffer_load_dwordx4 v2, s[44:47], s72 offen offset:3072 nt lds
  s_add_u32 s72, s72, 16384
  s_waitcnt vmcnt(4)
  s_add_u32 m0, s8, 16384
  s_nop 0
  buffer_load_dwordx4 v2, s[44:47], s72 offen offset:0 nt lds
  s_waitcnt vmcnt(4)
  s_add_u32 m0, s8, 16384
  s_nop 0
  buffer_load_dwordx4 v2, s[44:47], s72 offen offset:1024 nt lds
  s_waitcnt vmcnt(4)
  s_add_u32 m0, s8, 16384
  s_nop 0
  buffer_load_dwordx4 v2, s[44:47], s72 offen offset:2048 nt lds
  s_waitcnt vmcnt(4)
  s_add_u32 m0, s8, 16384
  s_nop 0
  buffer_load_dwordx4 v2, s[44:47], s72 offen offset:3072 nt lds
  s_add_u32 s72, s72, 16384
  s_waitcnt vmcnt(4)
  s_add_u32 m0, s8, 20480
  s_nop 0
  buffer_load_dwordx4 v2, s[44:47], s72 offen offset:0 nt lds
  s_waitcnt vmcnt(4)
  s_add_u32 m0, s8, 20480
  s_nop 0
  buffer_load_dwordx4 v2, s[44:47], s72 offen offset:1024 nt lds
  s_waitcnt vmcnt(4)
  s_add_u32 m0, s8, 20480
  s_nop 0
  buffer_load_dwordx4 v2, s[44:47], s72 offen offset:2048 nt lds
  s_waitcnt vmcnt(4)
  s_add_u32 m0, s8, 20480
  s_nop 0
  buffer_load_dwordx4 v2, s[44:47], s72 offen offset:3072 nt lds
  s_add_u32 s72, s72, 16384
  s_waitcnt vmcnt(4)
  s_add_u32 m0, s8, 24576
  s_nop 0
  buffer_load_dwordx4 v2, s[44:47], s72 offen offset:0 nt lds
  s_waitcnt vmcnt(4)
  s_add_u32 m0, s8, 24576
  s_nop 0
  buffer_load_dwordx4 v2, s[44:47], s72 offen offset:1024 nt lds
  s_waitcnt vmcnt(4)
  s_add_u32 m0, s8, 24576
  s_nop 0
  buffer_load_dwordx4 v2, s[44:47], s72 offen offset:2048 nt lds
  s_waitcnt vmcnt(4)
  s_add_u32 m0, s8, 24576
  s_nop 0
  buffer_load_dwordx4 v2, s[44:47], s72 offen offset:3072 nt lds
  s_add_u32 s72, s72, 16384
  s_barrier
  v_lshlrev_b32 v5, 4, v4
  ds_read_b128 v[12:15], v5 offset:3072
  v_mov_b32 v16, 0
  v_mov_b32 v17, 0
  v_mov_b32 v18, 0
  v_mov_b32 v19, 0
  v_mov_b32 v20, 0
  v_mov_b32 v21, 0
  v_mov_b32 v22, 0
  v_mov_b32 v23, 0
  v_mov_b32 v24, 0xff800000
  v_mov_b32 v33, 0
  s_waitcnt lgkmcnt(0)
  s_waitcnt vmcnt(4)
  buffer_load_dwordx4 v[44:47], v2, s[44:47], s72 offen offset:0 nt
  v_dot2_f32_bf16 v26, v76, v12, 0
  v_dot2_f32_bf16 v26, v77, v13, v26
  v_dot2_f32_bf16 v26, v78, v14, v26
  v_dot2_f32_bf16 v26, v79, v15, v26
  v_dot2_f32_bf16 v27, v80, v12, 0
  v_dot2_f32_bf16 v27, v81, v13, v27
  v_dot2_f32_bf16 v27, v82, v14, v27
  v_dot2_f32_bf16 v27, v83, v15, v27
  s_waitcnt vmcnt(4)
  buffer_load_dwordx4 v[76:79], v2, s[44:47], s72 offen offset:1024 nt
  v_dot2_f32_bf16 v28, v84, v12, 0
  v_dot2_f32_bf16 v28, v85, v13, v28
  v_dot2_f32_bf16 v28, v86, v14, v28
  v_dot2_f32_bf16 v28, v87, v15, v28
  v_dot2_f32_bf16 v29, v88, v12, 0
  v_dot2_f32_bf16 v29, v89, v13, v29
  v_dot2_f32_bf16 v29, v90, v14, v29
  v_dot2_f32_bf16 v29, v91, v15, v29
  v_add_f32_dpp v30, v26, v26 row_mirror row_mask:0xf bank_mask:0x3
  v_add_f32_dpp v31, v27, v27 row_mirror row_mask:0xf bank_mask:0x3
  v_add_f32_dpp v30, v28, v28 row_mirror row_mask:0xf bank_mask:0xc
  v_add_f32_dpp v31, v29, v29 row_mirror row_mask:0xf bank_mask:0xc
  s_nop 0
  v_add_f32_dpp v32, v30, v30 row_half_mirror row_mask:0xf bank_mask:0x5
  v_add_f32_dpp v32, v31, v31 row_half_mirror row_mask:0xf bank_mask:0xa
  s_nop 1
  v_add_f32_dpp v32, v32, v32 quad_perm:[1,0,3,2] row_mask:0xf bank_mask:0xf
  s_nop 1
  v_add_f32_dpp v32, v32, v32 quad_perm:[2,3,0,1] row_mask:0xf bank_mask:0xf
  v_cvt_pk_bf16_f32 v32, 0, v32
  v_mul_f32 v32, s74, v32
  v_cvt_pk_bf16_f32 v32, 0, v32
  ds_write_b32 v25, v32 offset:0
  v_max_f32 v24, v24, v32
  s_waitcnt vmcnt(4)
  buffer_load_dwordx4 v[80:83], v2, s[44:47], s72 offen offset:2048 nt
  v_dot2_f32_bf16 v26, v92, v12, 0
  v_dot2_f32_bf16 v26, v93, v13, v26
  v_dot2_f32_bf16 v26, v94, v14, v26
  v_dot2_f32_bf16 v26, v95, v15, v26
  v_dot2_f32_bf16 v27, v96, v12, 0
  v_dot2_f32_bf16 v27, v97, v13, v27
  v_dot2_f32_bf16 v27, v98, v14, v27
  v_dot2_f32_bf16 v27, v99, v15, v27
  s_waitcnt vmcnt(4)
  buffer_load_dwordx4 v[84:87], v2, s[44:47], s72 offen offset:3072 nt
  s_add_u32 s72, s72, 16384
  v_dot2_f32_bf16 v28, v100, v12, 0
  v_dot2_f32_bf16 v28, v101, v13, v28
  v_dot2_f32_bf16 v28, v102, v14, v28
  v_dot2_f32_bf16 v28, v103, v15, v28
  v_dot2_f32_bf16 v29, v104, v12, 0
  v_dot2_f32_bf16 v29, v105, v13, v29
  v_dot2_f32_bf16 v29, v106, v14, v29
  v_dot2_f32_bf16 v29, v107, v15, v29
  v_add_f32_dpp v30, v26, v26 row_mirror row_mask:0xf bank_mask:0x3
  v_add_f32_dpp v31, v27, v27 row_mirror row_mask:0xf bank_mask:0x3
  v_add_f32_dpp v30, v28, v28 row_mirror row_mask:0xf bank_mask:0xc
  v_add_f32_dpp v31, v29, v29 row_mirror row_mask:0xf bank_mask:0xc
  s_nop 0
  v_add_f32_dpp v32, v30, v30 row_half_mirror row_mask:0xf bank_mask:0x5
  v_add_f32_dpp v32, v31, v31 row_half_mirror row_mask:0xf bank_mask:0xa
  s_nop 1
  v_add_f32_dpp v32, v32, v32 quad_perm:[1,0,3,2] row_mask:0xf bank_mask:0xf
  s_nop 1
  v_add_f32_dpp v32, v32, v32 quad_perm:[2,3,0,1] row_mask:0xf bank_mask:0xf
  v_cvt_pk_bf16_f32 v32, 0, v32
  v_mul_f32 v32, s74, v32
  v_cvt_pk_bf16_f32 v32, 0, v32
  ds_write_b32 v25, v32 offset:4
  v_max_f32 v24, v24, v32
  v_add_u32 v25, 128, v25
  s_waitcnt vmcnt(4)
  buffer_load_dwordx4 v[88:91], v2, s[44:47], s72 offen offset:0 nt
  v_dot2_f32_bf16 v26, v108, v12, 0
  v_dot2_f32_bf16 v26, v109, v13, v26
  v_dot2_f32_bf16 v26, v110, v14, v26
  v_dot2_f32_bf16 v26, v111, v15, v26
  v_dot2_f32_bf16 v27, v112, v12, 0
  v_dot2_f32_bf16 v27, v113, v13, v27
  v_dot2_f32_bf16 v27, v114, v14, v27
  v_dot2_f32_bf16 v27, v115, v15, v27
  s_waitcnt vmcnt(4)
  buffer_load_dwordx4 v[92:95], v2, s[44:47], s72 offen offset:1024 nt
  v_dot2_f32_bf16 v28, v116, v12, 0
  v_dot2_f32_bf16 v28, v117, v13, v28
  v_dot2_f32_bf16 v28, v118, v14, v28
  v_dot2_f32_bf16 v28, v119, v15, v28
  v_dot2_f32_bf16 v29, v120, v12, 0
  v_dot2_f32_bf16 v29, v121, v13, v29
  v_dot2_f32_bf16 v29, v122, v14, v29
  v_dot2_f32_bf16 v29, v123, v15, v29
  v_add_f32_dpp v30, v26, v26 row_mirror row_mask:0xf bank_mask:0x3
  v_add_f32_dpp v31, v27, v27 row_mirror row_mask:0xf bank_mask:0x3
  v_add_f32_dpp v30, v28, v28 row_mirror row_mask:0xf bank_mask:0xc
  v_add_f32_dpp v31, v29, v29 row_mirror row_mask:0xf bank_mask:0xc
  s_nop 0
  v_add_f32_dpp v32, v30, v30 row_half_mirror row_mask:0xf bank_mask:0x5
  v_add_f32_dpp v32, v31, v31 row_half_mirror row_mask:0xf bank_mask:0xa
  s_nop 1
  v_add_f32_dpp v32, v32, v32 quad_perm:[1,0,3,2] row_mask:0xf bank_mask:0xf
  s_nop 1
  v_add_f32_dpp v32, v32, v32 quad_perm:[2,3,0,1] row_mask:0xf bank_mask:0xf
  v_cvt_pk_bf16_f32 v32, 0, v32
  v_mul_f32 v32, s74, v32
  v_cvt_pk_bf16_f32 v32, 0, v32
  ds_write_b32 v25, v32 offset:0
  v_max_f32 v24, v24, v32
  s_waitcnt vmcnt(4)
  buffer_load_dwordx4 v[96:99], v2, s[44:47], s72 offen offset:2048 nt
  v_dot2_f32_bf16 v26, v124, v12, 0
  v_dot2_f32_bf16 v26, v125, v13, v26
  v_dot2_f32_bf16 v26, v126, v14, v26
  v_dot2_f32_bf16 v26, v127, v15, v26
  v_dot2_f32_bf16 v27, v128, v12, 0
  v_dot2_f32_bf16 v27, v129, v13, v27
  v_dot2_f32_bf16 v27, v130, v14, v27
  v_dot2_f32_bf16 v27, v131, v15, v27
  s_waitcnt vmcnt(4)
  buffer_load_dwordx4 v[100:103], v2, s[44:47], s72 offen offset:3072 nt
  s_add_u32 s72, s72, 16384
  v_dot2_f32_bf16 v28, v132, v12, 0
  v_dot2_f32_bf16 v28, v133, v13, v28
  v_dot2_f32_bf16 v28, v134, v14, v28
  v_dot2_f32_bf16 v28, v135, v15, v28
  v_dot2_f32_bf16 v29, v136, v12, 0
  v_dot2_f32_bf16 v29, v137, v13, v29
  v_dot2_f32_bf16 v29, v138, v14, v29
  v_dot2_f32_bf16 v29, v139, v15, v29
  v_add_f32_dpp v30, v26, v26 row_mirror row_mask:0xf bank_mask:0x3
  v_add_f32_dpp v31, v27, v27 row_mirror row_mask:0xf bank_mask:0x3
  v_add_f32_dpp v30, v28, v28 row_mirror row_mask:0xf bank_mask:0xc
  v_add_f32_dpp v31, v29, v29 row_mirror row_mask:0xf bank_mask:0xc
  s_nop 0
  v_add_f32_dpp v32, v30, v30 row_half_mirror row_mask:0xf bank_mask:0x5
  v_add_f32_dpp v32, v31, v31 row_half_mirror row_mask:0xf bank_mask:0xa
  s_nop 1
  v_add_f32_dpp v32, v32, v32 quad_perm:[1,0,3,2] row_mask:0xf bank_mask:0xf
  s_nop 1
  v_add_f32_dpp v32, v32, v32 quad_perm:[2,3,0,1] row_mask:0xf bank_mask:0xf
  v_cvt_pk_bf16_f32 v32, 0, v32
  v_mul_f32 v32, s74, v32
  v_cvt_pk_bf16_f32 v32, 0, v32
  ds_write_b32 v25, v32 offset:4
  v_max_f32 v24, v24, v32
  v_add_u32 v25, 128, v25
  s_waitcnt vmcnt(4)
  buffer_load_dwordx4 v[104:107], v2, s[44:47], s72 offen offset:0 nt
  v_dot2_f32_bf16 v26, v140, v12, 0
  v_dot2_f32_bf16 v26, v141, v13, v26
  v_dot2_f32_bf16 v26, v142, v14, v26
  v_dot2_f32_bf16 v26, v143, v15, v26
  v_dot2_f32_bf16 v27, v144, v12, 0
  v_dot2_f32_bf16 v27, v145, v13, v27
  v_dot2_f32_bf16 v27, v146, v14, v27
  v_dot2_f32_bf16 v27, v147, v15, v27
  s_waitcnt vmcnt(4)
  buffer_load_dwordx4 v[108:111], v2, s[44:47], s72 offen offset:1024 nt
  v_dot2_f32_bf16 v28, v148, v12, 0
  v_dot2_f32_bf16 v28, v149, v13, v28
  v_dot2_f32_bf16 v28, v150, v14, v28
  v_dot2_f32_bf16 v28, v151, v15, v28
  v_dot2_f32_bf16 v29, v152, v12, 0
  v_dot2_f32_bf16 v29, v153, v13, v29
  v_dot2_f32_bf16 v29, v154, v14, v29
  v_dot2_f32_bf16 v29, v155, v15, v29
  v_add_f32_dpp v30, v26, v26 row_mirror row_mask:0xf bank_mask:0x3
  v_add_f32_dpp v31, v27, v27 row_mirror row_mask:0xf bank_mask:0x3
  v_add_f32_dpp v30, v28, v28 row_mirror row_mask:0xf bank_mask:0xc
  v_add_f32_dpp v31, v29, v29 row_mirror row_mask:0xf bank_mask:0xc
  s_nop 0
  v_add_f32_dpp v32, v30, v30 row_half_mirror row_mask:0xf bank_mask:0x5
  v_add_f32_dpp v32, v31, v31 row_half_mirror row_mask:0xf bank_mask:0xa
  s_nop 1
  v_add_f32_dpp v32, v32, v32 quad_perm:[1,0,3,2] row_mask:0xf bank_mask:0xf
  s_nop 1
  v_add_f32_dpp v32, v32, v32 quad_perm:[2,3,0,1] row_mask:0xf bank_mask:0xf
  v_cvt_pk_bf16_f32 v32, 0, v32
  v_mul_f32 v32, s74, v32
  v_cvt_pk_bf16_f32 v32, 0, v32
  ds_write_b32 v25, v32 offset:0
  v_max_f32 v24, v24, v32
  s_waitcnt vmcnt(4)
  buffer_load_dwordx4 v[112:115], v2, s[44:47], s72 offen offset:2048 nt
  v_dot2_f32_bf16 v26, v156, v12, 0
  v_dot2_f32_bf16 v26, v157, v13, v26
  v_dot2_f32_bf16 v26, v158, v14, v26
  v_dot2_f32_bf16 v26, v159, v15, v26
  v_dot2_f32_bf16 v27, v160, v12, 0
  v_dot2_f32_bf16 v27, v161, v13, v27
  v_dot2_f32_bf16 v27, v162, v14, v27
  v_dot2_f32_bf16 v27, v163, v15, v27
  s_waitcnt vmcnt(4)
  buffer_load_dwordx4 v[116:119], v2, s[44:47], s72 offen offset:3072 nt
  s_add_u32 s72, s72, 16384
  v_dot2_f32_bf16 v28, v164, v12, 0
  v_dot2_f32_bf16 v28, v165, v13, v28
  v_dot2_f32_bf16 v28, v166, v14, v28
  v_dot2_f32_bf16 v28, v167, v15, v28
  v_dot2_f32_bf16 v29, v168, v12, 0
  v_dot2_f32_bf16 v29, v169, v13, v29
  v_dot2_f32_bf16 v29, v170, v14, v29
  v_dot2_f32_bf16 v29, v171, v15, v29
  v_add_f32_dpp v30, v26, v26 row_mirror row_mask:0xf bank_mask:0x3
  v_add_f32_dpp v31, v27, v27 row_mirror row_mask:0xf bank_mask:0x3
  v_add_f32_dpp v30, v28, v28 row_mirror row_mask:0xf bank_mask:0xc
  v_add_f32_dpp v31, v29, v29 row_mirror row_mask:0xf bank_mask:0xc
  s_nop 0
  v_add_f32_dpp v32, v30, v30 row_half_mirror row_mask:0xf bank_mask:0x5
  v_add_f32_dpp v32, v31, v31 row_half_mirror row_mask:0xf bank_mask:0xa
  s_nop 1
  v_add_f32_dpp v32, v32, v32 quad_perm:[1,0,3,2] row_mask:0xf bank_mask:0xf
  s_nop 1
  v_add_f32_dpp v32, v32, v32 quad_perm:[2,3,0,1] row_mask:0xf bank_mask:0xf
  v_cvt_pk_bf16_f32 v32, 0, v32
  v_mul_f32 v32, s74, v32
  v_cvt_pk_bf16_f32 v32, 0, v32
  ds_write_b32 v25, v32 offset:4
  v_max_f32 v24, v24, v32
  v_add_u32 v25, 128, v25
  s_waitcnt vmcnt(4)
  buffer_load_dwordx4 v[120:123], v2, s[44:47], s72 offen offset:0 nt
  v_dot2_f32_bf16 v26, v172, v12, 0
  v_dot2_f32_bf16 v26, v173, v13, v26
  v_dot2_f32_bf16 v26, v174, v14, v26
  v_dot2_f32_bf16 v26, v175, v15, v26
  v_dot2_f32_bf16 v27, v176, v12, 0
  v_dot2_f32_bf16 v27, v177, v13, v27
  v_dot2_f32_bf16 v27, v178, v14, v27
  v_dot2_f32_bf16 v27, v179, v15, v27
  s_waitcnt vmcnt(4)
  buffer_load_dwordx4 v[124:127], v2, s[44:47], s72 offen offset:1024 nt
  v_dot2_f32_bf16 v28, v180, v12, 0
  v_dot2_f32_bf16 v28, v181, v13, v28
  v_dot2_f32_bf16 v28, v182, v14, v28
  v_dot2_f32_bf16 v28, v183, v15, v28
  v_dot2_f32_bf16 v29, v184, v12, 0
  v_dot2_f32_bf16 v29, v185, v13, v29
  v_dot2_f32_bf16 v29, v186, v14, v29
  v_dot2_f32_bf16 v29, v187, v15, v29
  v_add_f32_dpp v30, v26, v26 row_mirror row_mask:0xf bank_mask:0x3
  v_add_f32_dpp v31, v27, v27 row_mirror row_mask:0xf bank_mask:0x3
  v_add_f32_dpp v30, v28, v28 row_mirror row_mask:0xf bank_mask:0xc
  v_add_f32_dpp v31, v29, v29 row_mirror row_mask:0xf bank_mask:0xc
  s_nop 0
  v_add_f32_dpp v32, v30, v30 row_half_mirror row_mask:0xf bank_mask:0x5
  v_add_f32_dpp v32, v31, v31 row_half_mirror row_mask:0xf bank_mask:0xa
  s_nop 1
  v_add_f32_dpp v32, v32, v32 quad_perm:[1,0,3,2] row_mask:0xf bank_mask:0xf
  s_nop 1
  v_add_f32_dpp v32, v32, v32 quad_perm:[2,3,0,1] row_mask:0xf bank_mask:0xf
  v_cvt_pk_bf16_f32 v32, 0, v32
  v_mul_f32 v32, s74, v32
  v_cvt_pk_bf16_f32 v32, 0, v32
  ds_write_b32 v25, v32 offset:0
  v_max_f32 v24, v24, v32
  s_waitcnt vmcnt(4)
  buffer_load_dwordx4 v[128:131], v2, s[44:47], s72 offen offset:2048 nt
  v_dot2_f32_bf16 v26, v188, v12, 0
  v_dot2_f32_bf16 v26, v189, v13, v26
  v_dot2_f32_bf16 v26, v190, v14, v26
  v_dot2_f32_bf16 v26, v191, v15, v26
  v_dot2_f32_bf16 v27, v192, v12, 0
  v_dot2_f32_bf16 v27, v193, v13, v27
  v_dot2_f32_bf16 v27, v194, v14, v27
  v_dot2_f32_bf16 v27, v195, v15, v27
  s_waitcnt vmcnt(4)
  buffer_load_dwordx4 v[132:135], v2, s[44:47], s72 offen offset:3072 nt
  s_add_u32 s72, s72, 16384
  v_dot2_f32_bf16 v28, v196, v12, 0
  v_dot2_f32_bf16 v28, v197, v13, v28
  v_dot2_f32_bf16 v28, v198, v14, v28
  v_dot2_f32_bf16 v28, v199, v15, v28
  v_dot2_f32_bf16 v29, v200, v12, 0
  v_dot2_f32_bf16 v29, v201, v13, v29
  v_dot2_f32_bf16 v29, v202, v14, v29
  v_dot2_f32_bf16 v29, v203, v15, v29
  v_add_f32_dpp v30, v26, v26 row_mirror row_mask:0xf bank_mask:0x3
  v_add_f32_dpp v31, v27, v27 row_mirror row_mask:0xf bank_mask:0x3
  v_add_f32_dpp v30, v28, v28 row_mirror row_mask:0xf bank_mask:0xc
  v_add_f32_dpp v31, v29, v29 row_mirror row_mask:0xf bank_mask:0xc
  s_nop 0
  v_add_f32_dpp v32, v30, v30 row_half_mirror row_mask:0xf bank_mask:0x5
  v_add_f32_dpp v32, v31, v31 row_half_mirror row_mask:0xf bank_mask:0xa
  s_nop 1
  v_add_f32_dpp v32, v32, v32 quad_perm:[1,0,3,2] row_mask:0xf bank_mask:0xf
  s_nop 1
  v_add_f32_dpp v32, v32, v32 quad_perm:[2,3,0,1] row_mask:0xf bank_mask:0xf
  v_cvt_pk_bf16_f32 v32, 0, v32
  v_mul_f32 v32, s74, v32
  v_cvt_pk_bf16_f32 v32, 0, v32
  ds_write_b32 v25, v32 offset:4
  v_max_f32 v24, v24, v32
  v_add_u32 v25, 128, v25
  s_waitcnt vmcnt(4)
  buffer_load_dwordx4 v[136:139], v2, s[44:47], s72 offen offset:0 nt
  v_dot2_f32_bf16 v26, v204, v12, 0
  v_dot2_f32_bf16 v26, v205, v13, v26
  v_dot2_f32_bf16 v26, v206, v14, v26
  v_dot2_f32_bf16 v26, v207, v15, v26
  v_dot2_f32_bf16 v27, v208, v12, 0
  v_dot2_f32_bf16 v27, v209, v13, v27
  v_dot2_f32_bf16 v27, v210, v14, v27
  v_dot2_f32_bf16 v27, v211, v15, v27
  s_waitcnt vmcnt(4)
  buffer_load_dwordx4 v[140:143], v2, s[44:47], s72 offen offset:1024 nt
  v_dot2_f32_bf16 v28, v212, v12, 0
  v_dot2_f32_bf16 v28, v213, v13, v28
  v_dot2_f32_bf16 v28, v214, v14, v28
  v_dot2_f32_bf16 v28, v215, v15, v28
  v_dot2_f32_bf16 v29, v216, v12, 0
  v_dot2_f32_bf16 v29, v217, v13, v29
  v_dot2_f32_bf16 v29, v218, v14, v29
  v_dot2_f32_bf16 v29, v219, v15, v29
  v_add_f32_dpp v30, v26, v26 row_mirror row_mask:0xf bank_mask:0x3
  v_add_f32_dpp v31, v27, v27 row_mirror row_mask:0xf bank_mask:0x3
  v_add_f32_dpp v30, v28, v28 row_mirror row_mask:0xf bank_mask:0xc
  v_add_f32_dpp v31, v29, v29 row_mirror row_mask:0xf bank_mask:0xc
  s_nop 0
  v_add_f32_dpp v32, v30, v30 row_half_mirror row_mask:0xf bank_mask:0x5
  v_add_f32_dpp v32, v31, v31 row_half_mirror row_mask:0xf bank_mask:0xa
  s_nop 1
  v_add_f32_dpp v32, v32, v32 quad_perm:[1,0,3,2] row_mask:0xf bank_mask:0xf
  s_nop 1
  v_add_f32_dpp v32, v32, v32 quad_perm:[2,3,0,1] row_mask:0xf bank_mask:0xf
  v_cvt_pk_bf16_f32 v32, 0, v32
  v_mul_f32 v32, s74, v32
  v_cvt_pk_bf16_f32 v32, 0, v32
  ds_write_b32 v25, v32 offset:0
  v_max_f32 v24, v24, v32
  s_waitcnt vmcnt(4)
  buffer_load_dwordx4 v[144:147], v2, s[44:47], s72 offen offset:2048 nt
  v_dot2_f32_bf16 v26, v220, v12, 0
  v_dot2_f32_bf16 v26, v221, v13, v26
  v_dot2_f32_bf16 v26, v222, v14, v26
  v_dot2_f32_bf16 v26, v223, v15, v26
  v_dot2_f32_bf16 v27, v224, v12, 0
  v_dot2_f32_bf16 v27, v225, v13, v27
  v_dot2_f32_bf16 v27, v226, v14, v27
  v_dot2_f32_bf16 v27, v227, v15, v27
  s_waitcnt vmcnt(4)
  buffer_load_dwordx4 v[148:151], v2, s[44:47], s72 offen offset:3072 nt
  s_add_u32 s72, s72, 16384
  v_dot2_f32_bf16 v28, v228, v12, 0
  v_dot2_f32_bf16 v28, v229, v13, v28
  v_dot2_f32_bf16 v28, v230, v14, v28
  v_dot2_f32_bf16 v28, v231, v15, v28
  v_dot2_f32_bf16 v29, v232, v12, 0
  v_dot2_f32_bf16 v29, v233, v13, v29
  v_dot2_f32_bf16 v29, v234, v14, v29
  v_dot2_f32_bf16 v29, v235, v15, v29
  v_add_f32_dpp v30, v26, v26 row_mirror row_mask:0xf bank_mask:0x3
  v_add_f32_dpp v31, v27, v27 row_mirror row_mask:0xf bank_mask:0x3
  v_add_f32_dpp v30, v28, v28 row_mirror row_mask:0xf bank_mask:0xc
  v_add_f32_dpp v31, v29, v29 row_mirror row_mask:0xf bank_mask:0xc
  s_nop 0
  v_add_f32_dpp v32, v30, v30 row_half_mirror row_mask:0xf bank_mask:0x5
  v_add_f32_dpp v32, v31, v31 row_half_mirror row_mask:0xf bank_mask:0xa
  s_nop 1
  v_add_f32_dpp v32, v32, v32 quad_perm:[1,0,3,2] row_mask:0xf bank_mask:0xf
  s_nop 1
  v_add_f32_dpp v32, v32, v32 quad_perm:[2,3,0,1] row_mask:0xf bank_mask:0xf
  v_cvt_pk_bf16_f32 v32, 0, v32
  v_mul_f32 v32, s74, v32
  v_cvt_pk_bf16_f32 v32, 0, v32
  ds_write_b32 v25, v32 offset:4
  v_max_f32 v24, v24, v32
  v_add_u32 v25, 128, v25
  s_waitcnt vmcnt(4)
  buffer_load_dwordx4 v[152:155], v2, s[44:47], s72 offen offset:0 nt
  ds_read_b128 v[236:239], v42 offset:0
  ds_read_b128 v[240:243], v42 offset:1024
  ds_read_b128 v[244:247], v42 offset:2048
  ds_read_b128 v[248:251], v42 offset:3072
  s_waitcnt lgkmcnt(0)
  v_dot2_f32_bf16 v26, v236, v12, 0
  v_dot2_f32_bf16 v26, v237, v13, v26
  v_dot2_f32_bf16 v26, v238, v14, v26
  v_dot2_f32_bf16 v26, v239, v15, v26
  v_dot2_f32_bf16 v27, v240, v12, 0
  v_dot2_f32_bf16 v27, v241, v13, v27
  v_dot2_f32_bf16 v27, v242, v14, v27
  v_dot2_f32_bf16 v27, v243, v15, v27
  s_waitcnt vmcnt(4)
  buffer_load_dwordx4 v[156:159], v2, s[44:47], s72 offen offset:1024 nt
  v_dot2_f32_bf16 v28, v244, v12, 0
  v_dot2_f32_bf16 v28, v245, v13, v28
  v_dot2_f32_bf16 v28, v246, v14, v28
  v_dot2_f32_bf16 v28, v247, v15, v28
  v_dot2_f32_bf16 v29, v248, v12, 0
  v_dot2_f32_bf16 v29, v249, v13, v29
  v_dot2_f32_bf16 v29, v250, v14, v29
  v_dot2_f32_bf16 v29, v251, v15, v29
  v_add_f32_dpp v30, v26, v26 row_mirror row_mask:0xf bank_mask:0x3
  v_add_f32_dpp v31, v27, v27 row_mirror row_mask:0xf bank_mask:0x3
  v_add_f32_dpp v30, v28, v28 row_mirror row_mask:0xf bank_mask:0xc
  v_add_f32_dpp v31, v29, v29 row_mirror row_mask:0xf bank_mask:0xc
  s_nop 0
  v_add_f32_dpp v32, v30, v30 row_half_mirror row_mask:0xf bank_mask:0x5
  v_add_f32_dpp v32, v31, v31 row_half_mirror row_mask:0xf bank_mask:0xa
  s_nop 1
  v_add_f32_dpp v32, v32, v32 quad_perm:[1,0,3,2] row_mask:0xf bank_mask:0xf
  s_nop 1
  v_add_f32_dpp v32, v32, v32 quad_perm:[2,3,0,1] row_mask:0xf bank_mask:0xf
  v_cvt_pk_bf16_f32 v32, 0, v32
  v_mul_f32 v32, s74, v32
  v_cvt_pk_bf16_f32 v32, 0, v32
  ds_write_b32 v25, v32 offset:0
  v_max_f32 v24, v24, v32
  s_waitcnt vmcnt(4)
  buffer_load_dwordx4 v[160:163], v2, s[44:47], s72 offen offset:2048 nt
  ds_read_b128 v[236:239], v42 offset:4096
  ds_read_b128 v[240:243], v42 offset:5120
  ds_read_b128 v[244:247], v42 offset:6144
  ds_read_b128 v[248:251], v42 offset:7168
  s_waitcnt lgkmcnt(0)
  v_dot2_f32_bf16 v26, v236, v12, 0
  v_dot2_f32_bf16 v26, v237, v13, v26
  v_dot2_f32_bf16 v26, v238, v14, v26
  v_dot2_f32_bf16 v26, v239, v15, v26
  v_dot2_f32_bf16 v27, v240, v12, 0
  v_dot2_f32_bf16 v27, v241, v13, v27
  v_dot2_f32_bf16 v27, v242, v14, v27
  v_dot2_f32_bf16 v27, v243, v15, v27
  s_waitcnt vmcnt(4)
  buffer_load_dwordx4 v[164:167], v2, s[44:47], s72 offen offset:3072 nt
  s_add_u32 s72, s72, 16384
  v_dot2_f32_bf16 v28, v244, v12, 0
  v_dot2_f32_bf16 v28, v245, v13, v28
  v_dot2_f32_bf16 v28, v246, v14, v28
  v_dot2_f32_bf16 v28, v247, v15, v28
  v_dot2_f32_bf16 v29, v248, v12, 0
  v_dot2_f32_bf16 v29, v249, v13, v29
  v_dot2_f32_bf16 v29, v250, v14, v29
  v_dot2_f32_bf16 v29, v251, v15, v29
  v_add_f32_dpp v30, v26, v26 row_mirror row_mask:0xf bank_mask:0x3
  v_add_f32_dpp v31, v27, v27 row_mirror row_mask:0xf bank_mask:0x3
  v_add_f32_dpp v30, v28, v28 row_mirror row_mask:0xf bank_mask:0xc
  v_add_f32_dpp v31, v29, v29 row_mirror row_mask:0xf bank_mask:0xc
  s_nop 0
  v_add_f32_dpp v32, v30, v30 row_half_mirror row_mask:0xf bank_mask:0x5
  v_add_f32_dpp v32, v31, v31 row_half_mirror row_mask:0xf bank_mask:0xa
  s_nop 1
  v_add_f32_dpp v32, v32, v32 quad_perm:[1,0,3,2] row_mask:0xf bank_mask:0xf
  s_nop 1
  v_add_f32_dpp v32, v32, v32 quad_perm:[2,3,0,1] row_mask:0xf bank_mask:0xf
  v_cvt_pk_bf16_f32 v32, 0, v32
  v_mul_f32 v32, s74, v32
  v_cvt_pk_bf16_f32 v32, 0, v32
  ds_write_b32 v25, v32 offset:4
  v_max_f32 v24, v24, v32
  v_add_u32 v25, 128, v25
  s_waitcnt vmcnt(4)
  buffer_load_dwordx4 v[168:171], v2, s[44:47], s72 offen offset:0 nt
  ds_read_b128 v[236:239], v42 offset:8192
  ds_read_b128 v[240:243], v42 offset:9216
  ds_read_b128 v[244:247], v42 offset:10240
  ds_read_b128 v[248:251], v42 offset:11264
  s_waitcnt lgkmcnt(0)
  v_dot2_f32_bf16 v26, v236, v12, 0
  v_dot2_f32_bf16 v26, v237, v13, v26
  v_dot2_f32_bf16 v26, v238, v14, v26
  v_dot2_f32_bf16 v26, v239, v15, v26
  v_dot2_f32_bf16 v27, v240, v12, 0
  v_dot2_f32_bf16 v27, v241, v13, v27
  v_dot2_f32_bf16 v27, v242, v14, v27
  v_dot2_f32_bf16 v27, v243, v15, v27
  s_waitcnt vmcnt(4)
  buffer_load_dwordx4 v[172:175], v2, s[44:47], s72 offen offset:1024 nt
  v_dot2_f32_bf16 v28, v244, v12, 0
  v_dot2_f32_bf16 v28, v245, v13, v28
  v_dot2_f32_bf16 v28, v246, v14, v28
  v_dot2_f32_bf16 v28, v247, v15, v28
  v_dot2_f32_bf16 v29, v248, v12, 0
  v_dot2_f32_bf16 v29, v249, v13, v29
  v_dot2_f32_bf16 v29, v250, v14, v29
  v_dot2_f32_bf16 v29, v251, v15, v29
  v_add_f32_dpp v30, v26, v26 row_mirror row_mask:0xf bank_mask:0x3
  v_add_f32_dpp v31, v27, v27 row_mirror row_mask:0xf bank_mask:0x3
  v_add_f32_dpp v30, v28, v28 row_mirror row_mask:0xf bank_mask:0xc
  v_add_f32_dpp v31, v29, v29 row_mirror row_mask:0xf bank_mask:0xc
  s_nop 0
  v_add_f32_dpp v32, v30, v30 row_half_mirror row_mask:0xf bank_mask:0x5
  v_add_f32_dpp v32, v31, v31 row_half_mirror row_mask:0xf bank_mask:0xa
  s_nop 1
  v_add_f32_dpp v32, v32, v32 quad_perm:[1,0,3,2] row_mask:0xf bank_mask:0xf
  s_nop 1
  v_add_f32_dpp v32, v32, v32 quad_perm:[2,3,0,1] row_mask:0xf bank_mask:0xf
  v_cvt_pk_bf16_f32 v32, 0, v32
  v_mul_f32 v32, s74, v32
  v_cvt_pk_bf16_f32 v32, 0, v32
  ds_write_b32 v25, v32 offset:0
  v_max_f32 v24, v24, v32
  s_waitcnt vmcnt(4)
  buffer_load_dwordx4 v[176:179], v2, s[44:47], s72 offen offset:2048 nt
  ds_read_b128 v[236:239], v42 offset:12288
  ds_read_b128 v[240:243], v42 offset:13312
  ds_read_b128 v[244:247], v42 offset:14336
  ds_read_b128 v[248:251], v42 offset:15360
  s_waitcnt lgkmcnt(0)
  v_dot2_f32_bf16 v26, v236, v12, 0
  v_dot2_f32_bf16 v26, v237, v13, v26
  v_dot2_f32_bf16 v26, v238, v14, v26
  v_dot2_f32_bf16 v26, v239, v15, v26
  v_dot2_f32_bf16 v27, v240, v12, 0
  v_dot2_f32_bf16 v27, v241, v13, v27
  v_dot2_f32_bf16 v27, v242, v14, v27
  v_dot2_f32_bf16 v27, v243, v15, v27
  s_waitcnt vmcnt(4)
  buffer_load_dwordx4 v[180:183], v2, s[44:47], s72 offen offset:3072 nt
  s_add_u32 s72, s72, 16384
  v_dot2_f32_bf16 v28, v244, v12, 0
  v_dot2_f32_bf16 v28, v245, v13, v28
  v_dot2_f32_bf16 v28, v246, v14, v28
  v_dot2_f32_bf16 v28, v247, v15, v28
  v_dot2_f32_bf16 v29, v248, v12, 0
  v_dot2_f32_bf16 v29, v249, v13, v29
  v_dot2_f32_bf16 v29, v250, v14, v29
  v_dot2_f32_bf16 v29, v251, v15, v29
  v_add_f32_dpp v30, v26, v26 row_mirror row_mask:0xf bank_mask:0x3
  v_add_f32_dpp v31, v27, v27 row_mirror row_mask:0xf bank_mask:0x3
  v_add_f32_dpp v30, v28, v28 row_mirror row_mask:0xf bank_mask:0xc
  v_add_f32_dpp v31, v29, v29 row_mirror row_mask:0xf bank_mask:0xc
  s_nop 0
  v_add_f32_dpp v32, v30, v30 row_half_mirror row_mask:0xf bank_mask:0x5
  v_add_f32_dpp v32, v31, v31 row_half_mirror row_mask:0xf bank_mask:0xa
  s_nop 1
  v_add_f32_dpp v32, v32, v32 quad_perm:[1,0,3,2] row_mask:0xf bank_mask:0xf
  s_nop 1
  v_add_f32_dpp v32, v32, v32 quad_perm:[2,3,0,1] row_mask:0xf bank_mask:0xf
  v_cvt_pk_bf16_f32 v32, 0, v32
  v_mul_f32 v32, s74, v32
  v_cvt_pk_bf16_f32 v32, 0, v32
  ds_write_b32 v25, v32 offset:4
  v_max_f32 v24, v24, v32
  v_add_u32 v25, 128, v25
  s_waitcnt vmcnt(4)
  buffer_load_dwordx4 v[184:187], v2, s[44:47], s72 offen offset:0 nt
  ds_read_b128 v[236:239], v42 offset:16384
  ds_read_b128 v[240:243], v42 offset:17408
  ds_read_b128 v[244:247], v42 offset:18432
  ds_read_b128 v[248:251], v42 offset:19456
  s_waitcnt lgkmcnt(0)
  v_dot2_f32_bf16 v26, v236, v12, 0
  v_dot2_f32_bf16 v26, v237, v13, v26
  v_dot2_f32_bf16 v26, v238, v14, v26
  v_dot2_f32_bf16 v26, v239, v15, v26
  v_dot2_f32_bf16 v27, v240, v12, 0
  v_dot2_f32_bf16 v27, v241, v13, v27
  v_dot2_f32_bf16 v27, v242, v14, v27
  v_dot2_f32_bf16 v27, v243, v15, v27
  s_waitcnt vmcnt(4)
  buffer_load_dwordx4 v[188:191], v2, s[44:47], s72 offen offset:1024 nt
  v_dot2_f32_bf16 v28, v244, v12, 0
  v_dot2_f32_bf16 v28, v245, v13, v28
  v_dot2_f32_bf16 v28, v246, v14, v28
  v_dot2_f32_bf16 v28, v247, v15, v28
  v_dot2_f32_bf16 v29, v248, v12, 0
  v_dot2_f32_bf16 v29, v249, v13, v29
  v_dot2_f32_bf16 v29, v250, v14, v29
  v_dot2_f32_bf16 v29, v251, v15, v29
  v_add_f32_dpp v30, v26, v26 row_mirror row_mask:0xf bank_mask:0x3
  v_add_f32_dpp v31, v27, v27 row_mirror row_mask:0xf bank_mask:0x3
  v_add_f32_dpp v30, v28, v28 row_mirror row_mask:0xf bank_mask:0xc
  v_add_f32_dpp v31, v29, v29 row_mirror row_mask:0xf bank_mask:0xc
  s_nop 0
  v_add_f32_dpp v32, v30, v30 row_half_mirror row_mask:0xf bank_mask:0x5
  v_add_f32_dpp v32, v31, v31 row_half_mirror row_mask:0xf bank_mask:0xa
  s_nop 1
  v_add_f32_dpp v32, v32, v32 quad_perm:[1,0,3,2] row_mask:0xf bank_mask:0xf
  s_nop 1
  v_add_f32_dpp v32, v32, v32 quad_perm:[2,3,0,1] row_mask:0xf bank_mask:0xf
  v_cvt_pk_bf16_f32 v32, 0, v32
  v_mul_f32 v32, s74, v32
  v_cvt_pk_bf16_f32 v32, 0, v32
  ds_write_b32 v25, v32 offset:0
  v_max_f32 v24, v24, v32
  s_waitcnt vmcnt(4)
  buffer_load_dwordx4 v[192:195], v2, s[44:47], s72 offen offset:2048 nt
  ds_read_b128 v[236:239], v42 offset:20480
  ds_read_b128 v[240:243], v42 offset:21504
  ds_read_b128 v[244:247], v42 offset:22528
  ds_read_b128 v[248:251], v42 offset:23552
  s_waitcnt lgkmcnt(0)
  v_dot2_f32_bf16 v26, v236, v12, 0
  v_dot2_f32_bf16 v26, v237, v13, v26
  v_dot2_f32_bf16 v26, v238, v14, v26
  v_dot2_f32_bf16 v26, v239, v15, v26
  v_dot2_f32_bf16 v27, v240, v12, 0
  v_dot2_f32_bf16 v27, v241, v13, v27
  v_dot2_f32_bf16 v27, v242, v14, v27
  v_dot2_f32_bf16 v27, v243, v15, v27
  s_waitcnt vmcnt(4)
  buffer_load_dwordx4 v[196:199], v2, s[44:47], s72 offen offset:3072 nt
  s_add_u32 s72, s72, 16384
  v_dot2_f32_bf16 v28, v244, v12, 0
  v_dot2_f32_bf16 v28, v245, v13, v28
  v_dot2_f32_bf16 v28, v246, v14, v28
  v_dot2_f32_bf16 v28, v247, v15, v28
  v_dot2_f32_bf16 v29, v248, v12, 0
  v_dot2_f32_bf16 v29, v249, v13, v29
  v_dot2_f32_bf16 v29, v250, v14, v29
  v_dot2_f32_bf16 v29, v251, v15, v29
  v_add_f32_dpp v30, v26, v26 row_mirror row_mask:0xf bank_mask:0x3
  v_add_f32_dpp v31, v27, v27 row_mirror row_mask:0xf bank_mask:0x3
  v_add_f32_dpp v30, v28, v28 row_mirror row_mask:0xf bank_mask:0xc
  v_add_f32_dpp v31, v29, v29 row_mirror row_mask:0xf bank_mask:0xc
  s_nop 0
  v_add_f32_dpp v32, v30, v30 row_half_mirror row_mask:0xf bank_mask:0x5
  v_add_f32_dpp v32, v31, v31 row_half_mirror row_mask:0xf bank_mask:0xa
  s_nop 1
  v_add_f32_dpp v32, v32, v32 quad_perm:[1,0,3,2] row_mask:0xf bank_mask:0xf
  s_nop 1
  v_add_f32_dpp v32, v32, v32 quad_perm:[2,3,0,1] row_mask:0xf bank_mask:0xf
  v_cvt_pk_bf16_f32 v32, 0, v32
  v_mul_f32 v32, s74, v32
  v_cvt_pk_bf16_f32 v32, 0, v32
  ds_write_b32 v25, v32 offset:4
  v_max_f32 v24, v24, v32
  v_add_u32 v25, 128, v25
  s_waitcnt vmcnt(4)
  buffer_load_dwordx4 v[200:203], v2, s[44:47], s72 offen offset:0 nt
  ds_read_b128 v[236:239], v42 offset:24576
  ds_read_b128 v[240:243], v42 offset:25600
  ds_read_b128 v[244:247], v42 offset:26624
  ds_read_b128 v[248:251], v42 offset:27648
  s_waitcnt lgkmcnt(0)
  v_dot2_f32_bf16 v26, v236, v12, 0
  v_dot2_f32_bf16 v26, v237, v13, v26
  v_dot2_f32_bf16 v26, v238, v14, v26
  v_dot2_f32_bf16 v26, v239, v15, v26
  v_dot2_f32_bf16 v27, v240, v12, 0
  v_dot2_f32_bf16 v27, v241, v13, v27
  v_dot2_f32_bf16 v27, v242, v14, v27
  v_dot2_f32_bf16 v27, v243, v15, v27
  s_waitcnt vmcnt(4)
  buffer_load_dwordx4 v[204:207], v2, s[44:47], s72 offen offset:1024 nt
  v_dot2_f32_bf16 v28, v244, v12, 0
  v_dot2_f32_bf16 v28, v245, v13, v28
  v_dot2_f32_bf16 v28, v246, v14, v28
  v_dot2_f32_bf16 v28, v247, v15, v28
  v_dot2_f32_bf16 v29, v248, v12, 0
  v_dot2_f32_bf16 v29, v249, v13, v29
  v_dot2_f32_bf16 v29, v250, v14, v29
  v_dot2_f32_bf16 v29, v251, v15, v29
  v_add_f32_dpp v30, v26, v26 row_mirror row_mask:0xf bank_mask:0x3
  v_add_f32_dpp v31, v27, v27 row_mirror row_mask:0xf bank_mask:0x3
  v_add_f32_dpp v30, v28, v28 row_mirror row_mask:0xf bank_mask:0xc
  v_add_f32_dpp v31, v29, v29 row_mirror row_mask:0xf bank_mask:0xc
  s_nop 0
  v_add_f32_dpp v32, v30, v30 row_half_mirror row_mask:0xf bank_mask:0x5
  v_add_f32_dpp v32, v31, v31 row_half_mirror row_mask:0xf bank_mask:0xa
  s_nop 1
  v_add_f32_dpp v32, v32, v32 quad_perm:[1,0,3,2] row_mask:0xf bank_mask:0xf
  s_nop 1
  v_add_f32_dpp v32, v32, v32 quad_perm:[2,3,0,1] row_mask:0xf bank_mask:0xf
  v_cvt_pk_bf16_f32 v32, 0, v32
  v_mul_f32 v32, s74, v32
  v_cvt_pk_bf16_f32 v32, 0, v32
  ds_write_b32 v25, v32 offset:0
  v_max_f32 v24, v24, v32
  s_waitcnt vmcnt(4)
  buffer_load_dwordx4 v[208:211], v2, s[44:47], s72 offen offset:2048 nt
  v_dot2_f32_bf16 v26, v44, v12, 0
  v_dot2_f32_bf16 v26, v45, v13, v26
  v_dot2_f32_bf16 v26, v46, v14, v26
  v_dot2_f32_bf16 v26, v47, v15, v26
  v_dot2_f32_bf16 v27, v76, v12, 0
  v_dot2_f32_bf16 v27, v77, v13, v27
  v_dot2_f32_bf16 v27, v78, v14, v27
  v_dot2_f32_bf16 v27, v79, v15, v27
  s_waitcnt vmcnt(4)
  buffer_load_dwordx4 v[212:215], v2, s[44:47], s72 offen offset:3072 nt
  s_add_u32 s72, s72, 16384
  v_dot2_f32_bf16 v28, v80, v12, 0
  v_dot2_f32_bf16 v28, v81, v13, v28
  v_dot2_f32_bf16 v28, v82, v14, v28
  v_dot2_f32_bf16 v28, v83, v15, v28
  v_dot2_f32_bf16 v29, v84, v12, 0
  v_dot2_f32_bf16 v29, v85, v13, v29
  v_dot2_f32_bf16 v29, v86, v14, v29
  v_dot2_f32_bf16 v29, v87, v15, v29
  v_add_f32_dpp v30, v26, v26 row_mirror row_mask:0xf bank_mask:0x3
  v_add_f32_dpp v31, v27, v27 row_mirror row_mask:0xf bank_mask:0x3
  v_add_f32_dpp v30, v28, v28 row_mirror row_mask:0xf bank_mask:0xc
  v_add_f32_dpp v31, v29, v29 row_mirror row_mask:0xf bank_mask:0xc
  s_nop 0
  v_add_f32_dpp v32, v30, v30 row_half_mirror row_mask:0xf bank_mask:0x5
  v_add_f32_dpp v32, v31, v31 row_half_mirror row_mask:0xf bank_mask:0xa
  s_nop 1
  v_add_f32_dpp v32, v32, v32 quad_perm:[1,0,3,2] row_mask:0xf bank_mask:0xf
  s_nop 1
  v_add_f32_dpp v32, v32, v32 quad_perm:[2,3,0,1] row_mask:0xf bank_mask:0xf
  v_cvt_pk_bf16_f32 v32, 0, v32
  v_mul_f32 v32, s74, v32
  v_cvt_pk_bf16_f32 v32, 0, v32
  ds_write_b32 v25, v32 offset:4
  v_max_f32 v24, v24, v32
  v_add_u32 v25, 128, v25
  s_waitcnt vmcnt(4)
  buffer_load_dwordx4 v[216:219], v2, s[44:47], s72 offen offset:0 nt
  v_dot2_f32_bf16 v26, v88, v12, 0
  v_dot2_f32_bf16 v26, v89, v13, v26
  v_dot2_f32_bf16 v26, v90, v14, v26
  v_dot2_f32_bf16 v26, v91, v15, v26
  v_dot2_f32_bf16 v27, v92, v12, 0
  v_dot2_f32_bf16 v27, v93, v13, v27
  v_dot2_f32_bf16 v27, v94, v14, v27
  v_dot2_f32_bf16 v27, v95, v15, v27
  s_waitcnt vmcnt(4)
  buffer_load_dwordx4 v[220:223], v2, s[44:47], s72 offen offset:1024 nt
  v_dot2_f32_bf16 v28, v96, v12, 0
  v_dot2_f32_bf16 v28, v97, v13, v28
  v_dot2_f32_bf16 v28, v98, v14, v28
  v_dot2_f32_bf16 v28, v99, v15, v28
  v_dot2_f32_bf16 v29, v100, v12, 0
  v_dot2_f32_bf16 v29, v101, v13, v29
  v_dot2_f32_bf16 v29, v102, v14, v29
  v_dot2_f32_bf16 v29, v103, v15, v29
  v_add_f32_dpp v30, v26, v26 row_mirror row_mask:0xf bank_mask:0x3
  v_add_f32_dpp v31, v27, v27 row_mirror row_mask:0xf bank_mask:0x3
  v_add_f32_dpp v30, v28, v28 row_mirror row_mask:0xf bank_mask:0xc
  v_add_f32_dpp v31, v29, v29 row_mirror row_mask:0xf bank_mask:0xc
  s_nop 0
  v_add_f32_dpp v32, v30, v30 row_half_mirror row_mask:0xf bank_mask:0x5
  v_add_f32_dpp v32, v31, v31 row_half_mirror row_mask:0xf bank_mask:0xa
  s_nop 1
  v_add_f32_dpp v32, v32, v32 quad_perm:[1,0,3,2] row_mask:0xf bank_mask:0xf
  s_nop 1
  v_add_f32_dpp v32, v32, v32 quad_perm:[2,3,0,1] row_mask:0xf bank_mask:0xf
  v_cvt_pk_bf16_f32 v32, 0, v32
  v_mul_f32 v32, s74, v32
  v_cvt_pk_bf16_f32 v32, 0, v32
  ds_write_b32 v25, v32 offset:0
  v_max_f32 v24, v24, v32
  s_waitcnt vmcnt(4)
  buffer_load_dwordx4 v[224:227], v2, s[44:47], s72 offen offset:2048 nt
  v_dot2_f32_bf16 v26, v104, v12, 0
  v_dot2_f32_bf16 v26, v105, v13, v26
  v_dot2_f32_bf16 v26, v106, v14, v26
  v_dot2_f32_bf16 v26, v107, v15, v26
  v_dot2_f32_bf16 v27, v108, v12, 0
  v_dot2_f32_bf16 v27, v109, v13, v27
  v_dot2_f32_bf16 v27, v110, v14, v27
  v_dot2_f32_bf16 v27, v111, v15, v27
  s_waitcnt vmcnt(4)
  buffer_load_dwordx4 v[228:231], v2, s[44:47], s72 offen offset:3072 nt
  s_add_u32 s72, s72, 16384
  v_dot2_f32_bf16 v28, v112, v12, 0
  v_dot2_f32_bf16 v28, v113, v13, v28
  v_dot2_f32_bf16 v28, v114, v14, v28
  v_dot2_f32_bf16 v28, v115, v15, v28
  v_dot2_f32_bf16 v29, v116, v12, 0
  v_dot2_f32_bf16 v29, v117, v13, v29
  v_dot2_f32_bf16 v29, v118, v14, v29
  v_dot2_f32_bf16 v29, v119, v15, v29
  v_add_f32_dpp v30, v26, v26 row_mirror row_mask:0xf bank_mask:0x3
  v_add_f32_dpp v31, v27, v27 row_mirror row_mask:0xf bank_mask:0x3
  v_add_f32_dpp v30, v28, v28 row_mirror row_mask:0xf bank_mask:0xc
  v_add_f32_dpp v31, v29, v29 row_mirror row_mask:0xf bank_mask:0xc
  s_nop 0
  v_add_f32_dpp v32, v30, v30 row_half_mirror row_mask:0xf bank_mask:0x5
  v_add_f32_dpp v32, v31, v31 row_half_mirror row_mask:0xf bank_mask:0xa
  s_nop 1
  v_add_f32_dpp v32, v32, v32 quad_perm:[1,0,3,2] row_mask:0xf bank_mask:0xf
  s_nop 1
  v_add_f32_dpp v32, v32, v32 quad_perm:[2,3,0,1] row_mask:0xf bank_mask:0xf
  v_cvt_pk_bf16_f32 v32, 0, v32
  v_mul_f32 v32, s74, v32
  v_cvt_pk_bf16_f32 v32, 0, v32
  ds_write_b32 v25, v32 offset:4
  v_max_f32 v24, v24, v32
  v_add_u32 v25, 128, v25
  s_waitcnt vmcnt(4)
  buffer_load_dwordx4 v[232:235], v2, s[44:47], s72 offen offset:0 nt
  v_dot2_f32_bf16 v26, v120, v12, 0
  v_dot2_f32_bf16 v26, v121, v13, v26
  v_dot2_f32_bf16 v26, v122, v14, v26
  v_dot2_f32_bf16 v26, v123, v15, v26
  v_dot2_f32_bf16 v27, v124, v12, 0
  v_dot2_f32_bf16 v27, v125, v13, v27
  v_dot2_f32_bf16 v27, v126, v14, v27
  v_dot2_f32_bf16 v27, v127, v15, v27
  s_waitcnt vmcnt(4)
  buffer_load_dwordx4 v[76:79], v2, s[44:47], s72 offen offset:1024 nt
  v_dot2_f32_bf16 v28, v128, v12, 0
  v_dot2_f32_bf16 v28, v129, v13, v28
  v_dot2_f32_bf16 v28, v130, v14, v28
  v_dot2_f32_bf16 v28, v131, v15, v28
  v_dot2_f32_bf16 v29, v132, v12, 0
  v_dot2_f32_bf16 v29, v133, v13, v29
  v_dot2_f32_bf16 v29, v134, v14, v29
  v_dot2_f32_bf16 v29, v135, v15, v29
  v_add_f32_dpp v30, v26, v26 row_mirror row_mask:0xf bank_mask:0x3
  v_add_f32_dpp v31, v27, v27 row_mirror row_mask:0xf bank_mask:0x3
  v_add_f32_dpp v30, v28, v28 row_mirror row_mask:0xf bank_mask:0xc
  v_add_f32_dpp v31, v29, v29 row_mirror row_mask:0xf bank_mask:0xc
  s_nop 0
  v_add_f32_dpp v32, v30, v30 row_half_mirror row_mask:0xf bank_mask:0x5
  v_add_f32_dpp v32, v31, v31 row_half_mirror row_mask:0xf bank_mask:0xa
  s_nop 1
  v_add_f32_dpp v32, v32, v32 quad_perm:[1,0,3,2] row_mask:0xf bank_mask:0xf
  s_nop 1
  v_add_f32_dpp v32, v32, v32 quad_perm:[2,3,0,1] row_mask:0xf bank_mask:0xf
  v_cvt_pk_bf16_f32 v32, 0, v32
  v_mul_f32 v32, s74, v32
  v_cvt_pk_bf16_f32 v32, 0, v32
  ds_write_b32 v25, v32 offset:0
  v_max_f32 v24, v24, v32
  s_waitcnt vmcnt(4)
  buffer_load_dwordx4 v[80:83], v2, s[44:47], s72 offen offset:2048 nt
  v_dot2_f32_bf16 v26, v136, v12, 0
  v_dot2_f32_bf16 v26, v137, v13, v26
  v_dot2_f32_bf16 v26, v138, v14, v26
  v_dot2_f32_bf16 v26, v139, v15, v26
  v_dot2_f32_bf16 v27, v140, v12, 0
  v_dot2_f32_bf16 v27, v141, v13, v27
  v_dot2_f32_bf16 v27, v142, v14, v27
  v_dot2_f32_bf16 v27, v143, v15, v27
  s_waitcnt vmcnt(4)
  buffer_load_dwordx4 v[84:87], v2, s[44:47], s72 offen offset:3072 nt
  s_add_u32 s72, s72, 16384
  v_dot2_f32_bf16 v28, v144, v12, 0
  v_dot2_f32_bf16 v28, v145, v13, v28
  v_dot2_f32_bf16 v28, v146, v14, v28
  v_dot2_f32_bf16 v28, v147, v15, v28
  v_dot2_f32_bf16 v29, v148, v12, 0
  v_dot2_f32_bf16 v29, v149, v13, v29
  v_dot2_f32_bf16 v29, v150, v14, v29
  v_dot2_f32_bf16 v29, v151, v15, v29
  v_add_f32_dpp v30, v26, v26 row_mirror row_mask:0xf bank_mask:0x3
  v_add_f32_dpp v31, v27, v27 row_mirror row_mask:0xf bank_mask:0x3
  v_add_f32_dpp v30, v28, v28 row_mirror row_mask:0xf bank_mask:0xc
  v_add_f32_dpp v31, v29, v29 row_mirror row_mask:0xf bank_mask:0xc
  s_nop 0
  v_add_f32_dpp v32, v30, v30 row_half_mirror row_mask:0xf bank_mask:0x5
  v_add_f32_dpp v32, v31, v31 row_half_mirror row_mask:0xf bank_mask:0xa
  s_nop 1
  v_add_f32_dpp v32, v32, v32 quad_perm:[1,0,3,2] row_mask:0xf bank_mask:0xf
  s_nop 1
  v_add_f32_dpp v32, v32, v32 quad_perm:[2,3,0,1] row_mask:0xf bank_mask:0xf
  v_cvt_pk_bf16_f32 v32, 0, v32
  v_mul_f32 v32, s74, v32
  v_cvt_pk_bf16_f32 v32, 0, v32
  ds_write_b32 v25, v32 offset:4
  v_max_f32 v24, v24, v32
  v_add_u32 v25, 128, v25
  s_waitcnt vmcnt(4)
  buffer_load_dwordx4 v[88:91], v2, s[44:47], s72 offen offset:0 nt
  v_dot2_f32_bf16 v26, v152, v12, 0
  v_dot2_f32_bf16 v26, v153, v13, v26
  v_dot2_f32_bf16 v26, v154, v14, v26
  v_dot2_f32_bf16 v26, v155, v15, v26
  v_dot2_f32_bf16 v27, v156, v12, 0
  v_dot2_f32_bf16 v27, v157, v13, v27
  v_dot2_f32_bf16 v27, v158, v14, v27
  v_dot2_f32_bf16 v27, v159, v15, v27
  s_waitcnt vmcnt(4)
  buffer_load_dwordx4 v[92:95], v2, s[44:47], s72 offen offset:1024 nt
  v_dot2_f32_bf16 v28, v160, v12, 0
  v_dot2_f32_bf16 v28, v161, v13, v28
  v_dot2_f32_bf16 v28, v162, v14, v28
  v_dot2_f32_bf16 v28, v163, v15, v28
  v_dot2_f32_bf16 v29, v164, v12, 0
  v_dot2_f32_bf16 v29, v165, v13, v29
  v_dot2_f32_bf16 v29, v166, v14, v29
  v_dot2_f32_bf16 v29, v167, v15, v29
  v_add_f32_dpp v30, v26, v26 row_mirror row_mask:0xf bank_mask:0x3
  v_add_f32_dpp v31, v27, v27 row_mirror row_mask:0xf bank_mask:0x3
  v_add_f32_dpp v30, v28, v28 row_mirror row_mask:0xf bank_mask:0xc
  v_add_f32_dpp v31, v29, v29 row_mirror row_mask:0xf bank_mask:0xc
  s_nop 0
  v_add_f32_dpp v32, v30, v30 row_half_mirror row_mask:0xf bank_mask:0x5
  v_add_f32_dpp v32, v31, v31 row_half_mirror row_mask:0xf bank_mask:0xa
  s_nop 1
  v_add_f32_dpp v32, v32, v32 quad_perm:[1,0,3,2] row_mask:0xf bank_mask:0xf
  s_nop 1
  v_add_f32_dpp v32, v32, v32 quad_perm:[2,3,0,1] row_mask:0xf bank_mask:0xf
  v_cvt_pk_bf16_f32 v32, 0, v32
  v_mul_f32 v32, s74, v32
  v_cvt_pk_bf16_f32 v32, 0, v32
  ds_write_b32 v25, v32 offset:0
  v_max_f32 v24, v24, v32
  s_waitcnt vmcnt(4)
  buffer_load_dwordx4 v[96:99], v2, s[44:47], s72 offen offset:2048 nt
  v_dot2_f32_bf16 v26, v168, v12, 0
  v_dot2_f32_bf16 v26, v169, v13, v26
  v_dot2_f32_bf16 v26, v170, v14, v26
  v_dot2_f32_bf16 v26, v171, v15, v26
  v_dot2_f32_bf16 v27, v172, v12, 0
  v_dot2_f32_bf16 v27, v173, v13, v27
  v_dot2_f32_bf16 v27, v174, v14, v27
  v_dot2_f32_bf16 v27, v175, v15, v27
  s_waitcnt vmcnt(4)
  buffer_load_dwordx4 v[100:103], v2, s[44:47], s72 offen offset:3072 nt
  s_add_u32 s72, s72, 16384
  v_dot2_f32_bf16 v28, v176, v12, 0
  v_dot2_f32_bf16 v28, v177, v13, v28
  v_dot2_f32_bf16 v28, v178, v14, v28
  v_dot2_f32_bf16 v28, v179, v15, v28
  v_dot2_f32_bf16 v29, v180, v12, 0
  v_dot2_f32_bf16 v29, v181, v13, v29
  v_dot2_f32_bf16 v29, v182, v14, v29
  v_dot2_f32_bf16 v29, v183, v15, v29
  v_add_f32_dpp v30, v26, v26 row_mirror row_mask:0xf bank_mask:0x3
  v_add_f32_dpp v31, v27, v27 row_mirror row_mask:0xf bank_mask:0x3
  v_add_f32_dpp v30, v28, v28 row_mirror row_mask:0xf bank_mask:0xc
  v_add_f32_dpp v31, v29, v29 row_mirror row_mask:0xf bank_mask:0xc
  s_nop 0
  v_add_f32_dpp v32, v30, v30 row_half_mirror row_mask:0xf bank_mask:0x5
  v_add_f32_dpp v32, v31, v31 row_half_mirror row_mask:0xf bank_mask:0xa
  s_nop 1
  v_add_f32_dpp v32, v32, v32 quad_perm:[1,0,3,2] row_mask:0xf bank_mask:0xf
  s_nop 1
  v_add_f32_dpp v32, v32, v32 quad_perm:[2,3,0,1] row_mask:0xf bank_mask:0xf
  v_cvt_pk_bf16_f32 v32, 0, v32
  v_mul_f32 v32, s74, v32
  v_cvt_pk_bf16_f32 v32, 0, v32
  ds_write_b32 v25, v32 offset:4
  v_max_f32 v24, v24, v32
  v_add_u32 v25, 128, v25
  s_waitcnt vmcnt(4)
  buffer_load_dwordx4 v[104:107], v2, s[44:47], s72 offen offset:0 nt
  v_dot2_f32_bf16 v26, v184, v12, 0
  v_dot2_f32_bf16 v26, v185, v13, v26
  v_dot2_f32_bf16 v26, v186, v14, v26
  v_dot2_f32_bf16 v26, v187, v15, v26
  v_dot2_f32_bf16 v27, v188, v12, 0
  v_dot2_f32_bf16 v27, v189, v13, v27
  v_dot2_f32_bf16 v27, v190, v14, v27
  v_dot2_f32_bf16 v27, v191, v15, v27
  s_waitcnt vmcnt(4)
  buffer_load_dwordx4 v[108:111], v2, s[44:47], s72 offen offset:1024 nt
  v_dot2_f32_bf16 v28, v192, v12, 0
  v_dot2_f32_bf16 v28, v193, v13, v28
  v_dot2_f32_bf16 v28, v194, v14, v28
  v_dot2_f32_bf16 v28, v195, v15, v28
  v_dot2_f32_bf16 v29, v196, v12, 0
  v_dot2_f32_bf16 v29, v197, v13, v29
  v_dot2_f32_bf16 v29, v198, v14, v29
  v_dot2_f32_bf16 v29, v199, v15, v29
  v_add_f32_dpp v30, v26, v26 row_mirror row_mask:0xf bank_mask:0x3
  v_add_f32_dpp v31, v27, v27 row_mirror row_mask:0xf bank_mask:0x3
  v_add_f32_dpp v30, v28, v28 row_mirror row_mask:0xf bank_mask:0xc
  v_add_f32_dpp v31, v29, v29 row_mirror row_mask:0xf bank_mask:0xc
  s_nop 0
  v_add_f32_dpp v32, v30, v30 row_half_mirror row_mask:0xf bank_mask:0x5
  v_add_f32_dpp v32, v31, v31 row_half_mirror row_mask:0xf bank_mask:0xa
  s_nop 1
  v_add_f32_dpp v32, v32, v32 quad_perm:[1,0,3,2] row_mask:0xf bank_mask:0xf
  s_nop 1
  v_add_f32_dpp v32, v32, v32 quad_perm:[2,3,0,1] row_mask:0xf bank_mask:0xf
  v_cvt_pk_bf16_f32 v32, 0, v32
  v_mul_f32 v32, s74, v32
  v_cvt_pk_bf16_f32 v32, 0, v32
  ds_write_b32 v25, v32 offset:0
  v_max_f32 v24, v24, v32
  s_waitcnt vmcnt(4)
  buffer_load_dwordx4 v[112:115], v2, s[44:47], s72 offen offset:2048 nt
  v_dot2_f32_bf16 v26, v200, v12, 0
  v_dot2_f32_bf16 v26, v201, v13, v26
  v_dot2_f32_bf16 v26, v202, v14, v26
  v_dot2_f32_bf16 v26, v203, v15, v26
  v_dot2_f32_bf16 v27, v204, v12, 0
  v_dot2_f32_bf16 v27, v205, v13, v27
  v_dot2_f32_bf16 v27, v206, v14, v27
  v_dot2_f32_bf16 v27, v207, v15, v27
  s_waitcnt vmcnt(4)
  buffer_load_dwordx4 v[116:119], v2, s[44:47], s72 offen offset:3072 nt
  s_add_u32 s72, s72, 16384
  v_dot2_f32_bf16 v28, v208, v12, 0
  v_dot2_f32_bf16 v28, v209, v13, v28
  v_dot2_f32_bf16 v28, v210, v14, v28
  v_dot2_f32_bf16 v28, v211, v15, v28
  v_dot2_f32_bf16 v29, v212, v12, 0
  v_dot2_f32_bf16 v29, v213, v13, v29
  v_dot2_f32_bf16 v29, v214, v14, v29
  v_dot2_f32_bf16 v29, v215, v15, v29
  v_add_f32_dpp v30, v26, v26 row_mirror row_mask:0xf bank_mask:0x3
  v_add_f32_dpp v31, v27, v27 row_mirror row_mask:0xf bank_mask:0x3
  v_add_f32_dpp v30, v28, v28 row_mirror row_mask:0xf bank_mask:0xc
  v_add_f32_dpp v31, v29, v29 row_mirror row_mask:0xf bank_mask:0xc
  s_nop 0
  v_add_f32_dpp v32, v30, v30 row_half_mirror row_mask:0xf bank_mask:0x5
  v_add_f32_dpp v32, v31, v31 row_half_mirror row_mask:0xf bank_mask:0xa
  s_nop 1
  v_add_f32_dpp v32, v32, v32 quad_perm:[1,0,3,2] row_mask:0xf bank_mask:0xf
  s_nop 1
  v_add_f32_dpp v32, v32, v32 quad_perm:[2,3,0,1] row_mask:0xf bank_mask:0xf
  v_cvt_pk_bf16_f32 v32, 0, v32
  v_mul_f32 v32, s74, v32
  v_cvt_pk_bf16_f32 v32, 0, v32
  ds_write_b32 v25, v32 offset:4
  v_max_f32 v24, v24, v32
  v_add_u32 v25, 128, v25
  s_waitcnt vmcnt(4)
  buffer_load_dwordx4 v[44:47], v2, s[44:47], s72 offen offset:0 nt
  v_dot2_f32_bf16 v26, v216, v12, 0
  v_dot2_f32_bf16 v26, v217, v13, v26
  v_dot2_f32_bf16 v26, v218, v14, v26
  v_dot2_f32_bf16 v26, v219, v15, v26
  v_dot2_f32_bf16 v27, v220, v12, 0
  v_dot2_f32_bf16 v27, v221, v13, v27
  v_dot2_f32_bf16 v27, v222, v14, v27
  v_dot2_f32_bf16 v27, v223, v15, v27
  s_waitcnt vmcnt(4)
  buffer_load_dwordx4 v[48:51], v2, s[44:47], s72 offen offset:1024 nt
  v_dot2_f32_bf16 v28, v224, v12, 0
  v_dot2_f32_bf16 v28, v225, v13, v28
  v_dot2_f32_bf16 v28, v226, v14, v28
  v_dot2_f32_bf16 v28, v227, v15, v28
  v_dot2_f32_bf16 v29, v228, v12, 0
  v_dot2_f32_bf16 v29, v229, v13, v29
  v_dot2_f32_bf16 v29, v230, v14, v29
  v_dot2_f32_bf16 v29, v231, v15, v29
  v_add_f32_dpp v30, v26, v26 row_mirror row_mask:0xf bank_mask:0x3
  v_add_f32_dpp v31, v27, v27 row_mirror row_mask:0xf bank_mask:0x3
  v_add_f32_dpp v30, v28, v28 row_mirror row_mask:0xf bank_mask:0xc
  v_add_f32_dpp v31, v29, v29 row_mirror row_mask:0xf bank_mask:0xc
  s_nop 0
  v_add_f32_dpp v32, v30, v30 row_half_mirror row_mask:0xf bank_mask:0x5
  v_add_f32_dpp v32, v31, v31 row_half_mirror row_mask:0xf bank_mask:0xa
  s_nop 1
  v_add_f32_dpp v32, v32, v32 quad_perm:[1,0,3,2] row_mask:0xf bank_mask:0xf
  s_nop 1
  v_add_f32_dpp v32, v32, v32 quad_perm:[2,3,0,1] row_mask:0xf bank_mask:0xf
  v_cvt_pk_bf16_f32 v32, 0, v32
  v_mul_f32 v32, s74, v32
  v_cvt_pk_bf16_f32 v32, 0, v32
  ds_write_b32 v25, v32 offset:0
  v_max_f32 v24, v24, v32
  s_waitcnt vmcnt(4)
  buffer_load_dwordx4 v[52:55], v2, s[44:47], s72 offen offset:2048 nt
  v_dot2_f32_bf16 v26, v232, v12, 0
  v_dot2_f32_bf16 v26, v233, v13, v26
  v_dot2_f32_bf16 v26, v234, v14, v26
  v_dot2_f32_bf16 v26, v235, v15, v26
  v_dot2_f32_bf16 v27, v76, v12, 0
  v_dot2_f32_bf16 v27, v77, v13, v27
  v_dot2_f32_bf16 v27, v78, v14, v27
  v_dot2_f32_bf16 v27, v79, v15, v27
  s_waitcnt vmcnt(4)
  buffer_load_dwordx4 v[56:59], v2, s[44:47], s72 offen offset:3072 nt
  s_add_u32 s72, s72, 16384
  v_dot2_f32_bf16 v28, v80, v12, 0
  v_dot2_f32_bf16 v28, v81, v13, v28
  v_dot2_f32_bf16 v28, v82, v14, v28
  v_dot2_f32_bf16 v28, v83, v15, v28
  v_dot2_f32_bf16 v29, v84, v12, 0
  v_dot2_f32_bf16 v29, v85, v13, v29
  v_dot2_f32_bf16 v29, v86, v14, v29
  v_dot2_f32_bf16 v29, v87, v15, v29
  v_add_f32_dpp v30, v26, v26 row_mirror row_mask:0xf bank_mask:0x3
  v_add_f32_dpp v31, v27, v27 row_mirror row_mask:0xf bank_mask:0x3
  v_add_f32_dpp v30, v28, v28 row_mirror row_mask:0xf bank_mask:0xc
  v_add_f32_dpp v31, v29, v29 row_mirror row_mask:0xf bank_mask:0xc
  s_nop 0
  v_add_f32_dpp v32, v30, v30 row_half_mirror row_mask:0xf bank_mask:0x5
  v_add_f32_dpp v32, v31, v31 row_half_mirror row_mask:0xf bank_mask:0xa
  s_nop 1
  v_add_f32_dpp v32, v32, v32 quad_perm:[1,0,3,2] row_mask:0xf bank_mask:0xf
  s_nop 1
  v_add_f32_dpp v32, v32, v32 quad_perm:[2,3,0,1] row_mask:0xf bank_mask:0xf
  v_cvt_pk_bf16_f32 v32, 0, v32
  v_mul_f32 v32, s74, v32
  v_cvt_pk_bf16_f32 v32, 0, v32
  ds_write_b32 v25, v32 offset:4
  v_max_f32 v24, v24, v32
  v_add_u32 v25, 128, v25
  s_waitcnt vmcnt(4)
  buffer_load_dwordx4 v[60:63], v2, s[44:47], s72 offen offset:0 nt
  v_dot2_f32_bf16 v26, v88, v12, 0
  v_dot2_f32_bf16 v26, v89, v13, v26
  v_dot2_f32_bf16 v26, v90, v14, v26
  v_dot2_f32_bf16 v26, v91, v15, v26
  v_dot2_f32_bf16 v27, v92, v12, 0
  v_dot2_f32_bf16 v27, v93, v13, v27
  v_dot2_f32_bf16 v27, v94, v14, v27
  v_dot2_f32_bf16 v27, v95, v15, v27
  s_waitcnt vmcnt(4)
  buffer_load_dwordx4 v[64:67], v2, s[44:47], s72 offen offset:1024 nt
  v_dot2_f32_bf16 v28, v96, v12, 0
  v_dot2_f32_bf16 v28, v97, v13, v28
  v_dot2_f32_bf16 v28, v98, v14, v28
  v_dot2_f32_bf16 v28, v99, v15, v28
  v_dot2_f32_bf16 v29, v100, v12, 0
  v_dot2_f32_bf16 v29, v101, v13, v29
  v_dot2_f32_bf16 v29, v102, v14, v29
  v_dot2_f32_bf16 v29, v103, v15, v29
  v_add_f32_dpp v30, v26, v26 row_mirror row_mask:0xf bank_mask:0x3
  v_add_f32_dpp v31, v27, v27 row_mirror row_mask:0xf bank_mask:0x3
  v_add_f32_dpp v30, v28, v28 row_mirror row_mask:0xf bank_mask:0xc
  v_add_f32_dpp v31, v29, v29 row_mirror row_mask:0xf bank_mask:0xc
  s_nop 0
  v_add_f32_dpp v32, v30, v30 row_half_mirror row_mask:0xf bank_mask:0x5
  v_add_f32_dpp v32, v31, v31 row_half_mirror row_mask:0xf bank_mask:0xa
  s_nop 1
  v_add_f32_dpp v32, v32, v32 quad_perm:[1,0,3,2] row_mask:0xf bank_mask:0xf
  s_nop 1
  v_add_f32_dpp v32, v32, v32 quad_perm:[2,3,0,1] row_mask:0xf bank_mask:0xf
  v_cvt_pk_bf16_f32 v32, 0, v32
  v_mul_f32 v32, s74, v32
  v_cvt_pk_bf16_f32 v32, 0, v32
  ds_write_b32 v25, v32 offset:0
  v_max_f32 v24, v24, v32
  s_waitcnt vmcnt(4)
  buffer_load_dwordx4 v[68:71], v2, s[44:47], s72 offen offset:2048 nt
  v_dot2_f32_bf16 v26, v104, v12, 0
  v_dot2_f32_bf16 v26, v105, v13, v26
  v_dot2_f32_bf16 v26, v106, v14, v26
  v_dot2_f32_bf16 v26, v107, v15, v26
  v_dot2_f32_bf16 v27, v108, v12, 0
  v_dot2_f32_bf16 v27, v109, v13, v27
  v_dot2_f32_bf16 v27, v110, v14, v27
  v_dot2_f32_bf16 v27, v111, v15, v27
  s_waitcnt vmcnt(4)
  buffer_load_dwordx4 v[72:75], v2, s[44:47], s72 offen offset:3072 nt
  s_add_u32 s72, s72, 16384
  v_dot2_f32_bf16 v28, v112, v12, 0
  v_dot2_f32_bf16 v28, v113, v13, v28
  v_dot2_f32_bf16 v28, v114, v14, v28
  v_dot2_f32_bf16 v28, v115, v15, v28
  v_dot2_f32_bf16 v29, v116, v12, 0
  v_dot2_f32_bf16 v29, v117, v13, v29
  v_dot2_f32_bf16 v29, v118, v14, v29
  v_dot2_f32_bf16 v29, v119, v15, v29
  v_add_f32_dpp v30, v26, v26 row_mirror row_mask:0xf bank_mask:0x3
  v_add_f32_dpp v31, v27, v27 row_mirror row_mask:0xf bank_mask:0x3
  v_add_f32_dpp v30, v28, v28 row_mirror row_mask:0xf bank_mask:0xc
  v_add_f32_dpp v31, v29, v29 row_mirror row_mask:0xf bank_mask:0xc
  s_nop 0
  v_add_f32_dpp v32, v30, v30 row_half_mirror row_mask:0xf bank_mask:0x5
  v_add_f32_dpp v32, v31, v31 row_half_mirror row_mask:0xf bank_mask:0xa
  s_nop 1
  v_add_f32_dpp v32, v32, v32 quad_perm:[1,0,3,2] row_mask:0xf bank_mask:0xf
  s_nop 1
  v_add_f32_dpp v32, v32, v32 quad_perm:[2,3,0,1] row_mask:0xf bank_mask:0xf
  v_cvt_pk_bf16_f32 v32, 0, v32
  v_mul_f32 v32, s74, v32
  v_cvt_pk_bf16_f32 v32, 0, v32
  ds_write_b32 v25, v32 offset:4
  v_max_f32 v24, v24, v32
  v_add_u32 v25, 128, v25
  s_waitcnt vmcnt(4)
  buffer_load_dwordx4 v[120:123], v2, s[44:47], s72 offen offset:0 nt
  v_dot2_f32_bf16 v26, v44, v12, 0
  v_dot2_f32_bf16 v26, v45, v13, v26
  v_dot2_f32_bf16 v26, v46, v14, v26
  v_dot2_f32_bf16 v26, v47, v15, v26
  v_dot2_f32_bf16 v27, v48, v12, 0
  v_dot2_f32_bf16 v27, v49, v13, v27
  v_dot2_f32_bf16 v27, v50, v14, v27
  v_dot2_f32_bf16 v27, v51, v15, v27
  s_waitcnt vmcnt(4)
  buffer_load_dwordx4 v[48:51], v2, s[44:47], s72 offen offset:1024 nt
  v_dot2_f32_bf16 v28, v52, v12, 0
  v_dot2_f32_bf16 v28, v53, v13, v28
  v_dot2_f32_bf16 v28, v54, v14, v28
  v_dot2_f32_bf16 v28, v55, v15, v28
  v_dot2_f32_bf16 v29, v56, v12, 0
  v_dot2_f32_bf16 v29, v57, v13, v29
  v_dot2_f32_bf16 v29, v58, v14, v29
  v_dot2_f32_bf16 v29, v59, v15, v29
  v_add_f32_dpp v30, v26, v26 row_mirror row_mask:0xf bank_mask:0x3
  v_add_f32_dpp v31, v27, v27 row_mirror row_mask:0xf bank_mask:0x3
  v_add_f32_dpp v30, v28, v28 row_mirror row_mask:0xf bank_mask:0xc
  v_add_f32_dpp v31, v29, v29 row_mirror row_mask:0xf bank_mask:0xc
  s_nop 0
  v_add_f32_dpp v32, v30, v30 row_half_mirror row_mask:0xf bank_mask:0x5
  v_add_f32_dpp v32, v31, v31 row_half_mirror row_mask:0xf bank_mask:0xa
  s_nop 1
  v_add_f32_dpp v32, v32, v32 quad_perm:[1,0,3,2] row_mask:0xf bank_mask:0xf
  s_nop 1
  v_add_f32_dpp v32, v32, v32 quad_perm:[2,3,0,1] row_mask:0xf bank_mask:0xf
  v_cvt_pk_bf16_f32 v32, 0, v32
  v_mul_f32 v32, s74, v32
  v_cvt_pk_bf16_f32 v32, 0, v32
  ds_write_b32 v25, v32 offset:0
  v_max_f32 v24, v24, v32
  s_waitcnt vmcnt(4)
  buffer_load_dwordx4 v[52:55], v2, s[44:47], s72 offen offset:2048 nt
  v_dot2_f32_bf16 v26, v60, v12, 0
  v_dot2_f32_bf16 v26, v61, v13, v26
  v_dot2_f32_bf16 v26, v62, v14, v26
  v_dot2_f32_bf16 v26, v63, v15, v26
  v_dot2_f32_bf16 v27, v64, v12, 0
  v_dot2_f32_bf16 v27, v65, v13, v27
  v_dot2_f32_bf16 v27, v66, v14, v27
  v_dot2_f32_bf16 v27, v67, v15, v27
  s_waitcnt vmcnt(4)
  buffer_load_dwordx4 v[56:59], v2, s[44:47], s72 offen offset:3072 nt
  s_add_u32 s72, s72, 16384
  buffer_load_dwordx4 v[60:63], v2, s[44:47], s72 offen offset:0 nt
  v_dot2_f32_bf16 v28, v68, v12, 0
  v_dot2_f32_bf16 v28, v69, v13, v28
  v_dot2_f32_bf16 v28, v70, v14, v28
  v_dot2_f32_bf16 v28, v71, v15, v28
  s_waitcnt vmcnt(5)
  v_dot2_f32_bf16 v29, v72, v12, 0
  v_dot2_f32_bf16 v29, v73, v13, v29
  v_dot2_f32_bf16 v29, v74, v14, v29
  v_dot2_f32_bf16 v29, v75, v15, v29
  v_add_f32_dpp v30, v26, v26 row_mirror row_mask:0xf bank_mask:0x3
  v_add_f32_dpp v31, v27, v27 row_mirror row_mask:0xf bank_mask:0x3
  v_add_f32_dpp v30, v28, v28 row_mirror row_mask:0xf bank_mask:0xc
  v_add_f32_dpp v31, v29, v29 row_mirror row_mask:0xf bank_mask:0xc
  s_nop 0
  v_add_f32_dpp v32, v30, v30 row_half_mirror row_mask:0xf bank_mask:0x5
  v_add_f32_dpp v32, v31, v31 row_half_mirror row_mask:0xf bank_mask:0xa
  s_nop 1
  v_add_f32_dpp v32, v32, v32 quad_perm:[1,0,3,2] row_mask:0xf bank_mask:0xf
  s_nop 1
  v_add_f32_dpp v32, v32, v32 quad_perm:[2,3,0,1] row_mask:0xf bank_mask:0xf
  v_cvt_pk_bf16_f32 v32, 0, v32
  v_mul_f32 v32, s74, v32
  v_cvt_pk_bf16_f32 v32, 0, v32
  ds_write_b32 v25, v32 offset:4
  v_max_f32 v24, v24, v32
  v_add_u32 v25, 128, v25
  s_waitcnt vmcnt(4)
  buffer_load_dwordx4 v[64:67], v2, s[44:47], s72 offen offset:1024 nt
  v_dot2_f32_bf16 v26, v120, v12, 0
  v_dot2_f32_bf16 v26, v121, v13, v26
  v_dot2_f32_bf16 v26, v122, v14, v26
  v_dot2_f32_bf16 v26, v123, v15, v26
  s_waitcnt vmcnt(4)
  buffer_load_dwordx4 v[68:71], v2, s[44:47], s72 offen offset:2048 nt
  buffer_load_dwordx4 v[72:75], v2, s[44:47], s72 offen offset:3072 nt
  s_add_u32 s72, s72, 16384
  v_dot2_f32_bf16 v27, v48, v12, 0
  v_dot2_f32_bf16 v27, v49, v13, v27
  v_dot2_f32_bf16 v27, v50, v14, v27
  v_dot2_f32_bf16 v27, v51, v15, v27
  s_waitcnt vmcnt(5)
  v_dot2_f32_bf16 v28, v52, v12, 0
  v_dot2_f32_bf16 v28, v53, v13, v28
  v_dot2_f32_bf16 v28, v54, v14, v28
  v_dot2_f32_bf16 v28, v55, v15, v28
  s_waitcnt vmcnt(4)
  buffer_load_dwordx4 v[44:47], v2, s[44:47], s72 offen offset:0 nt
  v_dot2_f32_bf16 v29, v56, v12, 0
  v_dot2_f32_bf16 v29, v57, v13, v29
  v_dot2_f32_bf16 v29, v58, v14, v29
  v_dot2_f32_bf16 v29, v59, v15, v29
  v_add_f32_dpp v30, v26, v26 row_mirror row_mask:0xf bank_mask:0x3
  v_add_f32_dpp v31, v27, v27 row_mirror row_mask:0xf bank_mask:0x3
  v_add_f32_dpp v30, v28, v28 row_mirror row_mask:0xf bank_mask:0xc
  v_add_f32_dpp v31, v29, v29 row_mirror row_mask:0xf bank_mask:0xc
  s_nop 0
  v_add_f32_dpp v32, v30, v30 row_half_mirror row_mask:0xf bank_mask:0x5
  v_add_f32_dpp v32, v31, v31 row_half_mirror row_mask:0xf bank_mask:0xa
  s_nop 1
  v_add_f32_dpp v32, v32, v32 quad_perm:[1,0,3,2] row_mask:0xf bank_mask:0xf
  s_nop 1
  v_add_f32_dpp v32, v32, v32 quad_perm:[2,3,0,1] row_mask:0xf bank_mask:0xf
  v_cvt_pk_bf16_f32 v32, 0, v32
  v_mul_f32 v32, s74, v32
  v_cvt_pk_bf16_f32 v32, 0, v32
  ds_write_b32 v25, v32 offset:0
  v_max_f32 v24, v24, v32
  s_waitcnt vmcnt(4)
  buffer_load_dwordx4 v[48:51], v2, s[44:47], s72 offen offset:1024 nt
  buffer_load_dwordx4 v[52:55], v2, s[44:47], s72 offen offset:2048 nt
  v_dot2_f32_bf16 v26, v60, v12, 0
  v_dot2_f32_bf16 v26, v61, v13, v26
  v_dot2_f32_bf16 v26, v62, v14, v26
  v_dot2_f32_bf16 v26, v63, v15, v26
  s_waitcnt vmcnt(5)
  v_dot2_f32_bf16 v27, v64, v12, 0
  v_dot2_f32_bf16 v27, v65, v13, v27
  v_dot2_f32_bf16 v27, v66, v14, v27
  v_dot2_f32_bf16 v27, v67, v15, v27
  s_waitcnt vmcnt(4)
  buffer_load_dwordx4 v[56:59], v2, s[44:47], s72 offen offset:3072 nt
  s_add_u32 s72, s72, 16384
  buffer_load_dwordx4 v[60:63], v2, s[44:47], s72 offen offset:0 nt
  v_dot2_f32_bf16 v28, v68, v12, 0
  v_dot2_f32_bf16 v28, v69, v13, v28
  v_dot2_f32_bf16 v28, v70, v14, v28
  v_dot2_f32_bf16 v28, v71, v15, v28
  s_waitcnt vmcnt(5)
  v_dot2_f32_bf16 v29, v72, v12, 0
  v_dot2_f32_bf16 v29, v73, v13, v29
  v_dot2_f32_bf16 v29, v74, v14, v29
  v_dot2_f32_bf16 v29, v75, v15, v29
  v_add_f32_dpp v30, v26, v26 row_mirror row_mask:0xf bank_mask:0x3
  v_add_f32_dpp v31, v27, v27 row_mirror row_mask:0xf bank_mask:0x3
  v_add_f32_dpp v30, v28, v28 row_mirror row_mask:0xf bank_mask:0xc
  v_add_f32_dpp v31, v29, v29 row_mirror row_mask:0xf bank_mask:0xc
  s_nop 0
  v_add_f32_dpp v32, v30, v30 row_half_mirror row_mask:0xf bank_mask:0x5
  v_add_f32_dpp v32, v31, v31 row_half_mirror row_mask:0xf bank_mask:0xa
  s_nop 1
  v_add_f32_dpp v32, v32, v32 quad_perm:[1,0,3,2] row_mask:0xf bank_mask:0xf
  s_nop 1
  v_add_f32_dpp v32, v32, v32 quad_perm:[2,3,0,1] row_mask:0xf bank_mask:0xf
  v_cvt_pk_bf16_f32 v32, 0, v32
  v_mul_f32 v32, s74, v32
  v_cvt_pk_bf16_f32 v32, 0, v32
  ds_write_b32 v25, v32 offset:4
  v_max_f32 v24, v24, v32
  v_add_u32 v25, 128, v25
  s_mov_b32 s73, 14
  s_nop 4
L_kloop:
  s_waitcnt vmcnt(4)
  buffer_load_dwordx4 v[64:67], v2, s[44:47], s72 offen offset:1024 nt
  v_dot2_f32_bf16 v26, v44, v12, 0
  v_dot2_f32_bf16 v26, v45, v13, v26
  v_dot2_f32_bf16 v26, v46, v14, v26
  v_dot2_f32_bf16 v26, v47, v15, v26
  s_waitcnt vmcnt(4)
  buffer_load_dwordx4 v[68:71], v2, s[44:47], s72 offen offset:2048 nt
  buffer_load_dwordx4 v[72:75], v2, s[44:47], s72 offen offset:3072 nt
  s_add_u32 s72, s72, 16384
  v_dot2_f32_bf16 v27, v48, v12, 0
  v_dot2_f32_bf16 v27, v49, v13, v27
  v_dot2_f32_bf16 v27, v50, v14, v27
  v_dot2_f32_bf16 v27, v51, v15, v27
  s_waitcnt vmcnt(5)
  v_dot2_f32_bf16 v28, v52, v12, 0
  v_dot2_f32_bf16 v28, v53, v13, v28
  v_dot2_f32_bf16 v28, v54, v14, v28
  v_dot2_f32_bf16 v28, v55, v15, v28
  s_waitcnt vmcnt(4)
  buffer_load_dwordx4 v[44:47], v2, s[44:47], s72 offen offset:0 nt
  v_dot2_f32_bf16 v29, v56, v12, 0
  v_dot2_f32_bf16 v29, v57, v13, v29
  v_dot2_f32_bf16 v29, v58, v14, v29
  v_dot2_f32_bf16 v29, v59, v15, v29
  v_add_f32_dpp v30, v26, v26 row_mirror row_mask:0xf bank_mask:0x3
  v_add_f32_dpp v31, v27, v27 row_mirror row_mask:0xf bank_mask:0x3
  v_add_f32_dpp v30, v28, v28 row_mirror row_mask:0xf bank_mask:0xc
  v_add_f32_dpp v31, v29, v29 row_mirror row_mask:0xf bank_mask:0xc
  s_nop 0
  v_add_f32_dpp v32, v30, v30 row_half_mirror row_mask:0xf bank_mask:0x5
  v_add_f32_dpp v32, v31, v31 row_half_mirror row_mask:0xf bank_mask:0xa
  s_nop 1
  v_add_f32_dpp v32, v32, v32 quad_perm:[1,0,3,2] row_mask:0xf bank_mask:0xf
  s_nop 1
  v_add_f32_dpp v32, v32, v32 quad_perm:[2,3,0,1] row_mask:0xf bank_mask:0xf
  v_cvt_pk_bf16_f32 v32, 0, v32
  v_mul_f32 v32, s74, v32
  v_cvt_pk_bf16_f32 v32, 0, v32
  ds_write_b32 v25, v32 offset:0
  v_max_f32 v24, v24, v32
  s_waitcnt vmcnt(4)
  buffer_load_dwordx4 v[48:51], v2, s[44:47], s72 offen offset:1024 nt
  buffer_load_dwordx4 v[52:55], v2, s[44:47], s72 offen offset:2048 nt
  v_dot2_f32_bf16 v26, v60, v12, 0
  v_dot2_f32_bf16 v26, v61, v13, v26
  v_dot2_f32_bf16 v26, v62, v14, v26
  v_dot2_f32_bf16 v26, v63, v15, v26
  s_waitcnt vmcnt(5)
  v_dot2_f32_bf16 v27, v64, v12, 0
  v_dot2_f32_bf16 v27, v65, v13, v27
  v_dot2_f32_bf16 v27, v66, v14, v27
  v_dot2_f32_bf16 v27, v67, v15, v27
  s_waitcnt vmcnt(4)
  buffer_load_dwordx4 v[56:59], v2, s[44:47], s72 offen offset:3072 nt
  s_add_u32 s72, s72, 16384
  buffer_load_dwordx4 v[60:63], v2, s[44:47], s72 offen offset:0 nt
  v_dot2_f32_bf16 v28, v68, v12, 0
  v_dot2_f32_bf16 v28, v69, v13, v28
  v_dot2_f32_bf16 v28, v70, v14, v28
  v_dot2_f32_bf16 v28, v71, v15, v28
  s_waitcnt vmcnt(5)
  v_dot2_f32_bf16 v29, v72, v12, 0
  v_dot2_f32_bf16 v29, v73, v13, v29
  v_dot2_f32_bf16 v29, v74, v14, v29
  v_dot2_f32_bf16 v29, v75, v15, v29
  v_add_f32_dpp v30, v26, v26 row_mirror row_mask:0xf bank_mask:0x3
  v_add_f32_dpp v31, v27, v27 row_mirror row_mask:0xf bank_mask:0x3
  v_add_f32_dpp v30, v28, v28 row_mirror row_mask:0xf bank_mask:0xc
  v_add_f32_dpp v31, v29, v29 row_mirror row_mask:0xf bank_mask:0xc
  s_nop 0
  v_add_f32_dpp v32, v30, v30 row_half_mirror row_mask:0xf bank_mask:0x5
  v_add_f32_dpp v32, v31, v31 row_half_mirror row_mask:0xf bank_mask:0xa
  s_nop 1
  v_add_f32_dpp v32, v32, v32 quad_perm:[1,0,3,2] row_mask:0xf bank_mask:0xf
  s_nop 1
  v_add_f32_dpp v32, v32, v32 quad_perm:[2,3,0,1] row_mask:0xf bank_mask:0xf
  v_cvt_pk_bf16_f32 v32, 0, v32
  v_mul_f32 v32, s74, v32
  v_cvt_pk_bf16_f32 v32, 0, v32
  ds_write_b32 v25, v32 offset:4
  v_max_f32 v24, v24, v32
  v_add_u32 v25, 128, v25
  s_sub_u32 s73, s73, 1
  s_cmp_lg_u32 s73, 0
  s_nop 4
  s_cbranch_scc1 L_kloop
  s_waitcnt vmcnt(4)
  buffer_load_dwordx4 v[64:67], v2, s[44:47], s72 offen offset:1024 nt
  v_dot2_f32_bf16 v26, v44, v12, 0
  v_dot2_f32_bf16 v26, v45, v13, v26
  v_dot2_f32_bf16 v26, v46, v14, v26
  v_dot2_f32_bf16 v26, v47, v15, v26
  s_waitcnt vmcnt(4)
  buffer_load_dwordx4 v[68:71], v2, s[44:47], s72 offen offset:2048 nt
  buffer_load_dwordx4 v[72:75], v2, s[44:47], s72 offen offset:3072 nt
  s_add_u32 s72, s72, 16384
  v_dot2_f32_bf16 v27, v48, v12, 0
  v_dot2_f32_bf16 v27, v49, v13, v27
  v_dot2_f32_bf16 v27, v50, v14, v27
  v_dot2_f32_bf16 v27, v51, v15, v27
  s_waitcnt vmcnt(5)
  v_dot2_f32_bf16 v28, v52, v12, 0
  v_dot2_f32_bf16 v28, v53, v13, v28
  v_dot2_f32_bf16 v28, v54, v14, v28
  v_dot2_f32_bf16 v28, v55, v15, v28
  s_waitcnt vmcnt(4)
  s_mov_b32 s72, s9
  buffer_load_dwordx4 v[44:47], v2, s[48:51], s72 offen offset:0 nt
  v_dot2_f32_bf16 v29, v56, v12, 0
  v_dot2_f32_bf16 v29, v57, v13, v29
  v_dot2_f32_bf16 v29, v58, v14, v29
  v_dot2_f32_bf16 v29, v59, v15, v29
  v_add_f32_dpp v30, v26, v26 row_mirror row_mask:0xf bank_mask:0x3
  v_add_f32_dpp v31, v27, v27 row_mirror row_mask:0xf bank_mask:0x3
  v_add_f32_dpp v30, v28, v28 row_mirror row_mask:0xf bank_mask:0xc
  v_add_f32_dpp v31, v29, v29 row_mirror row_mask:0xf bank_mask:0xc
  s_nop 0
  v_add_f32_dpp v32, v30, v30 row_half_mirror row_mask:0xf bank_mask:0x5
  v_add_f32_dpp v32, v31, v31 row_half_mirror row_mask:0xf bank_mask:0xa
  s_nop 1
  v_add_f32_dpp v32, v32, v32 quad_perm:[1,0,3,2] row_mask:0xf bank_mask:0xf
  s_nop 1
  v_add_f32_dpp v32, v32, v32 quad_perm:[2,3,0,1] row_mask:0xf bank_mask:0xf
  v_cvt_pk_bf16_f32 v32, 0, v32
  v_mul_f32 v32, s74, v32
  v_cvt_pk_bf16_f32 v32, 0, v32
  ds_write_b32 v25, v32 offset:0
  v_max_f32 v24, v24, v32
  s_waitcnt vmcnt(4)
  buffer_load_dwordx4 v[48:51], v2, s[48:51], s72 offen offset:1024 nt
  buffer_load_dwordx4 v[52:55], v2, s[48:51], s72 offen offset:2048 nt
  v_dot2_f32_bf16 v26, v60, v12, 0
  v_dot2_f32_bf16 v26, v61, v13, v26
  v_dot2_f32_bf16 v26, v62, v14, v26
  v_dot2_f32_bf16 v26, v63, v15, v26
  s_waitcnt vmcnt(5)
  v_dot2_f32_bf16 v27, v64, v12, 0
  v_dot2_f32_bf16 v27, v65, v13, v27
  v_dot2_f32_bf16 v27, v66, v14, v27
  v_dot2_f32_bf16 v27, v67, v15, v27
  s_waitcnt vmcnt(4)
  buffer_load_dwordx4 v[56:59], v2, s[48:51], s72 offen offset:3072 nt
  s_add_u32 s72, s72, 16384
  buffer_load_dwordx4 v[60:63], v2, s[48:51], s72 offen offset:0 nt
  v_dot2_f32_bf16 v28, v68, v12, 0
  v_dot2_f32_bf16 v28, v69, v13, v28
  v_dot2_f32_bf16 v28, v70, v14, v28
  v_dot2_f32_bf16 v28, v71, v15, v28
  s_waitcnt vmcnt(5)
  v_dot2_f32_bf16 v29, v72, v12, 0
  v_dot2_f32_bf16 v29, v73, v13, v29
  v_dot2_f32_bf16 v29, v74, v14, v29
  v_dot2_f32_bf16 v29, v75, v15, v29
  v_add_f32_dpp v30, v26, v26 row_mirror row_mask:0xf bank_mask:0x3
  v_add_f32_dpp v31, v27, v27 row_mirror row_mask:0xf bank_mask:0x3
  v_add_f32_dpp v30, v28, v28 row_mirror row_mask:0xf bank_mask:0xc
  v_add_f32_dpp v31, v29, v29 row_mirror row_mask:0xf bank_mask:0xc
  s_nop 0
  v_add_f32_dpp v32, v30, v30 row_half_mirror row_mask:0xf bank_mask:0x5
  v_add_f32_dpp v32, v31, v31 row_half_mirror row_mask:0xf bank_mask:0xa
  s_nop 1
  v_add_f32_dpp v32, v32, v32 quad_perm:[1,0,3,2] row_mask:0xf bank_mask:0xf
  s_nop 1
  v_add_f32_dpp v32, v32, v32 quad_perm:[2,3,0,1] row_mask:0xf bank_mask:0xf
  v_cvt_pk_bf16_f32 v32, 0, v32
  v_mul_f32 v32, s74, v32
  v_cvt_pk_bf16_f32 v32, 0, v32
  ds_write_b32 v25, v32 offset:4
  v_max_f32 v24, v24, v32
  v_add_u32 v25, 128, v25
  s_nop 0
  v_max_f32_dpp v24, v24, v24 quad_perm:[1,0,3,2] row_mask:0xf bank_mask:0xf
  s_nop 1
  v_max_f32_dpp v24, v24, v24 quad_perm:[2,3,0,1] row_mask:0xf bank_mask:0xf
  s_nop 1
  v_max_f32_dpp v24, v24, v24 row_half_mirror row_mask:0xf bank_mask:0xf
  s_nop 1
  v_max_f32_dpp v24, v24, v24 row_mirror row_mask:0xf bank_mask:0xf
  v_mov_b32 v6, v24
  s_nop 1
  v_permlane16_swap_b32 v24, v6
  v_max_f32 v24, v24, v6
  v_mov_b32 v6, v24
  s_nop 1
  v_permlane32_swap_b32 v24, v6
  v_max_f32 v24, v24, v6
  v_subrev_u32 v25, 4096, v25
  s_waitcnt lgkmcnt(0)
  ds_read_b64 v[36:37], v25
  v_add_u32 v25, 128, v25
  s_lshl_b32 s7, s79, 2
  s_add_u32 s7, s7, 3520
  v_mov_b32 v41, s7
  v_mov_b32 v42, 0
  s_waitcnt vmcnt(4)
  buffer_load_dwordx4 v[64:67], v2, s[48:51], s72 offen offset:1024 nt
  v_add_u32 v42, 1, v42
  ds_write_b32 v41, v42
  s_waitcnt lgkmcnt(0)
  v_sub_f32 v34, v36, v24
  v_sub_f32 v35, v37, v24
  ds_read_b64 v[36:37], v25
  v_add_u32 v25, 128, v25
  v_mul_f32 v34, s75, v34
  v_mul_f32 v35, s75, v35
  v_exp_f32 v34, v34
  v_exp_f32 v35, v35
  v_add_f32 v33, v33, v34
  v_add_f32 v33, v33, v35
  v_cvt_pk_bf16_f32 v38, v34, 0
  v_cvt_pk_bf16_f32 v39, 0, v34
  s_nop 0
  v_dot2c_f32_bf16_dpp v16, v38, v44 row_newbcast:0 row_mask:0xf bank_mask:0xf
  v_dot2c_f32_bf16_dpp v17, v39, v44 row_newbcast:0 row_mask:0xf bank_mask:0xf
  v_dot2c_f32_bf16_dpp v18, v38, v45 row_newbcast:0 row_mask:0xf bank_mask:0xf
  v_dot2c_f32_bf16_dpp v19, v39, v45 row_newbcast:0 row_mask:0xf bank_mask:0xf
  v_dot2c_f32_bf16_dpp v20, v38, v46 row_newbcast:0 row_mask:0xf bank_mask:0xf
  v_dot2c_f32_bf16_dpp v21, v39, v46 row_newbcast:0 row_mask:0xf bank_mask:0xf
  v_dot2c_f32_bf16_dpp v22, v38, v47 row_newbcast:0 row_mask:0xf bank_mask:0xf
  v_dot2c_f32_bf16_dpp v23, v39, v47 row_newbcast:0 row_mask:0xf bank_mask:0xf
  s_waitcnt vmcnt(4)
  buffer_load_dwordx4 v[68:71], v2, s[48:51], s72 offen offset:2048 nt
  v_dot2c_f32_bf16_dpp v16, v38, v48 row_newbcast:4 row_mask:0xf bank_mask:0xf
  v_dot2c_f32_bf16_dpp v17, v39, v48 row_newbcast:4 row_mask:0xf bank_mask:0xf
  v_dot2c_f32_bf16_dpp v18, v38, v49 row_newbcast:4 row_mask:0xf bank_mask:0xf
  v_dot2c_f32_bf16_dpp v19, v39, v49 row_newbcast:4 row_mask:0xf bank_mask:0xf
  v_dot2c_f32_bf16_dpp v20, v38, v50 row_newbcast:4 row_mask:0xf bank_mask:0xf
  v_dot2c_f32_bf16_dpp v21, v39, v50 row_newbcast:4 row_mask:0xf bank_mask:0xf
  v_dot2c_f32_bf16_dpp v22, v38, v51 row_newbcast:4 row_mask:0xf bank_mask:0xf
  v_dot2c_f32_bf16_dpp v23, v39, v51 row_newbcast:4 row_mask:0xf bank_mask:0xf
  s_waitcnt vmcnt(4)
  buffer_load_dwordx4 v[72:75], v2, s[48:51], s72 offen offset:3072 nt
  s_add_u32 s72, s72, 16384
  buffer_load_dwordx4 v[44:47], v2, s[48:51], s72 offen offset:0 nt
  v_add_u32 v42, 1, v42
  ds_write_b32 v41, v42
  v_dot2c_f32_bf16_dpp v16, v38, v52 row_newbcast:8 row_mask:0xf bank_mask:0xf
  v_dot2c_f32_bf16_dpp v17, v39, v52 row_newbcast:8 row_mask:0xf bank_mask:0xf
  v_dot2c_f32_bf16_dpp v18, v38, v53 row_newbcast:8 row_mask:0xf bank_mask:0xf
  v_dot2c_f32_bf16_dpp v19, v39, v53 row_newbcast:8 row_mask:0xf bank_mask:0xf
  v_dot2c_f32_bf16_dpp v20, v38, v54 row_newbcast:8 row_mask:0xf bank_mask:0xf
  v_dot2c_f32_bf16_dpp v21, v39, v54 row_newbcast:8 row_mask:0xf bank_mask:0xf
  v_dot2c_f32_bf16_dpp v22, v38, v55 row_newbcast:8 row_mask:0xf bank_mask:0xf
  v_dot2c_f32_bf16_dpp v23, v39, v55 row_newbcast:8 row_mask:0xf bank_mask:0xf
  s_waitcnt vmcnt(5)
  v_dot2c_f32_bf16_dpp v16, v38, v56 row_newbcast:12 row_mask:0xf bank_mask:0xf
  v_dot2c_f32_bf16_dpp v17, v39, v56 row_newbcast:12 row_mask:0xf bank_mask:0xf
  v_dot2c_f32_bf16_dpp v18, v38, v57 row_newbcast:12 row_mask:0xf bank_mask:0xf
  v_dot2c_f32_bf16_dpp v19, v39, v57 row_newbcast:12 row_mask:0xf bank_mask:0xf
  v_dot2c_f32_bf16_dpp v20, v38, v58 row_newbcast:12 row_mask:0xf bank_mask:0xf
  v_dot2c_f32_bf16_dpp v21, v39, v58 row_newbcast:12 row_mask:0xf bank_mask:0xf
  v_dot2c_f32_bf16_dpp v22, v38, v59 row_newbcast:12 row_mask:0xf bank_mask:0xf
  v_dot2c_f32_bf16_dpp v23, v39, v59 row_newbcast:12 row_mask:0xf bank_mask:0xf
  s_waitcnt vmcnt(4)
  buffer_load_dwordx4 v[48:51], v2, s[48:51], s72 offen offset:1024 nt
  v_add_u32 v42, 1, v42
  ds_write_b32 v41, v42
  v_cvt_pk_bf16_f32 v38, v35, 0
  v_cvt_pk_bf16_f32 v39, 0, v35
  s_nop 0
  v_dot2c_f32_bf16_dpp v16, v38, v60 row_newbcast:0 row_mask:0xf bank_mask:0xf
  v_dot2c_f32_bf16_dpp v17, v39, v60 row_newbcast:0 row_mask:0xf bank_mask:0xf
  v_dot2c_f32_bf16_dpp v18, v38, v61 row_newbcast:0 row_mask:0xf bank_mask:0xf
  v_dot2c_f32_bf16_dpp v19, v39, v61 row_newbcast:0 row_mask:0xf bank_mask:0xf
  v_dot2c_f32_bf16_dpp v20, v38, v62 row_newbcast:0 row_mask:0xf bank_mask:0xf
  v_dot2c_f32_bf16_dpp v21, v39, v62 row_newbcast:0 row_mask:0xf bank_mask:0xf
  v_dot2c_f32_bf16_dpp v22, v38, v63 row_newbcast:0 row_mask:0xf bank_mask:0xf
  v_dot2c_f32_bf16_dpp v23, v39, v63 row_newbcast:0 row_mask:0xf bank_mask:0xf
  s_waitcnt vmcnt(4)
  buffer_load_dwordx4 v[52:55], v2, s[48:51], s72 offen offset:2048 nt
  v_dot2c_f32_bf16_dpp v16, v38, v64 row_newbcast:4 row_mask:0xf bank_mask:0xf
  v_dot2c_f32_bf16_dpp v17, v39, v64 row_newbcast:4 row_mask:0xf bank_mask:0xf
  v_dot2c_f32_bf16_dpp v18, v38, v65 row_newbcast:4 row_mask:0xf bank_mask:0xf
  v_dot2c_f32_bf16_dpp v19, v39, v65 row_newbcast:4 row_mask:0xf bank_mask:0xf
  v_dot2c_f32_bf16_dpp v20, v38, v66 row_newbcast:4 row_mask:0xf bank_mask:0xf
  v_dot2c_f32_bf16_dpp v21, v39, v66 row_newbcast:4 row_mask:0xf bank_mask:0xf
  v_dot2c_f32_bf16_dpp v22, v38, v67 row_newbcast:4 row_mask:0xf bank_mask:0xf
  v_dot2c_f32_bf16_dpp v23, v39, v67 row_newbcast:4 row_mask:0xf bank_mask:0xf
  s_waitcnt vmcnt(4)
  buffer_load_dwordx4 v[56:59], v2, s[48:51], s72 offen offset:3072 nt
  s_add_u32 s72, s72, 16384
  buffer_load_dwordx4 v[60:63], v2, s[48:51], s72 offen offset:0 nt
  v_add_u32 v42, 1, v42
  ds_write_b32 v41, v42
  v_dot2c_f32_bf16_dpp v16, v38, v68 row_newbcast:8 row_mask:0xf bank_mask:0xf
  v_dot2c_f32_bf16_dpp v17, v39, v68 row_newbcast:8 row_mask:0xf bank_mask:0xf
  v_dot2c_f32_bf16_dpp v18, v38, v69 row_newbcast:8 row_mask:0xf bank_mask:0xf
  v_dot2c_f32_bf16_dpp v19, v39, v69 row_newbcast:8 row_mask:0xf bank_mask:0xf
  v_dot2c_f32_bf16_dpp v20, v38, v70 row_newbcast:8 row_mask:0xf bank_mask:0xf
  v_dot2c_f32_bf16_dpp v21, v39, v70 row_newbcast:8 row_mask:0xf bank_mask:0xf
  v_dot2c_f32_bf16_dpp v22, v38, v71 row_newbcast:8 row_mask:0xf bank_mask:0xf
  v_dot2c_f32_bf16_dpp v23, v39, v71 row_newbcast:8 row_mask:0xf bank_mask:0xf
  s_waitcnt vmcnt(5)
  v_dot2c_f32_bf16_dpp v16, v38, v72 row_newbcast:12 row_mask:0xf bank_mask:0xf
  v_dot2c_f32_bf16_dpp v17, v39, v72 row_newbcast:12 row_mask:0xf bank_mask:0xf
  v_dot2c_f32_bf16_dpp v18, v38, v73 row_newbcast:12 row_mask:0xf bank_mask:0xf
  v_dot2c_f32_bf16_dpp v19, v39, v73 row_newbcast:12 row_mask:0xf bank_mask:0xf
  v_dot2c_f32_bf16_dpp v20, v38, v74 row_newbcast:12 row_mask:0xf bank_mask:0xf
  v_dot2c_f32_bf16_dpp v21, v39, v74 row_newbcast:12 row_mask:0xf bank_mask:0xf
  v_dot2c_f32_bf16_dpp v22, v38, v75 row_newbcast:12 row_mask:0xf bank_mask:0xf
  v_dot2c_f32_bf16_dpp v23, v39, v75 row_newbcast:12 row_mask:0xf bank_mask:0xf
  s_waitcnt vmcnt(4)
  buffer_load_dwordx4 v[64:67], v2, s[48:51], s72 offen offset:1024 nt
  v_add_u32 v42, 1, v42
  ds_write_b32 v41, v42
  s_waitcnt lgkmcnt(0)
  v_sub_f32 v34, v36, v24
  v_sub_f32 v35, v37, v24
  ds_read_b64 v[36:37], v25
  v_add_u32 v25, 128, v25
  v_mul_f32 v34, s75, v34
  v_mul_f32 v35, s75, v35
  v_exp_f32 v34, v34
  v_exp_f32 v35, v35
  v_add_f32 v33, v33, v34
  v_add_f32 v33, v33, v35
  v_cvt_pk_bf16_f32 v38, v34, 0
  v_cvt_pk_bf16_f32 v39, 0, v34
  s_nop 0
  v_dot2c_f32_bf16_dpp v16, v38, v44 row_newbcast:0 row_mask:0xf bank_mask:0xf
  v_dot2c_f32_bf16_dpp v17, v39, v44 row_newbcast:0 row_mask:0xf bank_mask:0xf
  v_dot2c_f32_bf16_dpp v18, v38, v45 row_newbcast:0 row_mask:0xf bank_mask:0xf
  v_dot2c_f32_bf16_dpp v19, v39, v45 row_newbcast:0 row_mask:0xf bank_mask:0xf
  v_dot2c_f32_bf16_dpp v20, v38, v46 row_newbcast:0 row_mask:0xf bank_mask:0xf
  v_dot2c_f32_bf16_dpp v21, v39, v46 row_newbcast:0 row_mask:0xf bank_mask:0xf
  v_dot2c_f32_bf16_dpp v22, v38, v47 row_newbcast:0 row_mask:0xf bank_mask:0xf
  v_dot2c_f32_bf16_dpp v23, v39, v47 row_newbcast:0 row_mask:0xf bank_mask:0xf
  s_waitcnt vmcnt(4)
  buffer_load_dwordx4 v[68:71], v2, s[48:51], s72 offen offset:2048 nt
  v_dot2c_f32_bf16_dpp v16, v38, v48 row_newbcast:4 row_mask:0xf bank_mask:0xf
  v_dot2c_f32_bf16_dpp v17, v39, v48 row_newbcast:4 row_mask:0xf bank_mask:0xf
  v_dot2c_f32_bf16_dpp v18, v38, v49 row_newbcast:4 row_mask:0xf bank_mask:0xf
  v_dot2c_f32_bf16_dpp v19, v39, v49 row_newbcast:4 row_mask:0xf bank_mask:0xf
  v_dot2c_f32_bf16_dpp v20, v38, v50 row_newbcast:4 row_mask:0xf bank_mask:0xf
  v_dot2c_f32_bf16_dpp v21, v39, v50 row_newbcast:4 row_mask:0xf bank_mask:0xf
  v_dot2c_f32_bf16_dpp v22, v38, v51 row_newbcast:4 row_mask:0xf bank_mask:0xf
  v_dot2c_f32_bf16_dpp v23, v39, v51 row_newbcast:4 row_mask:0xf bank_mask:0xf
  s_waitcnt vmcnt(4)
  buffer_load_dwordx4 v[72:75], v2, s[48:51], s72 offen offset:3072 nt
  s_add_u32 s72, s72, 16384
  buffer_load_dwordx4 v[44:47], v2, s[48:51], s72 offen offset:0 nt
  v_add_u32 v42, 1, v42
  ds_write_b32 v41, v42
  v_dot2c_f32_bf16_dpp v16, v38, v52 row_newbcast:8 row_mask:0xf bank_mask:0xf
  v_dot2c_f32_bf16_dpp v17, v39, v52 row_newbcast:8 row_mask:0xf bank_mask:0xf
  v_dot2c_f32_bf16_dpp v18, v38, v53 row_newbcast:8 row_mask:0xf bank_mask:0xf
  v_dot2c_f32_bf16_dpp v19, v39, v53 row_newbcast:8 row_mask:0xf bank_mask:0xf
  v_dot2c_f32_bf16_dpp v20, v38, v54 row_newbcast:8 row_mask:0xf bank_mask:0xf
  v_dot2c_f32_bf16_dpp v21, v39, v54 row_newbcast:8 row_mask:0xf bank_mask:0xf
  v_dot2c_f32_bf16_dpp v22, v38, v55 row_newbcast:8 row_mask:0xf bank_mask:0xf
  v_dot2c_f32_bf16_dpp v23, v39, v55 row_newbcast:8 row_mask:0xf bank_mask:0xf
  s_waitcnt vmcnt(5)
  v_dot2c_f32_bf16_dpp v16, v38, v56 row_newbcast:12 row_mask:0xf bank_mask:0xf
  v_dot2c_f32_bf16_dpp v17, v39, v56 row_newbcast:12 row_mask:0xf bank_mask:0xf
  v_dot2c_f32_bf16_dpp v18, v38, v57 row_newbcast:12 row_mask:0xf bank_mask:0xf
  v_dot2c_f32_bf16_dpp v19, v39, v57 row_newbcast:12 row_mask:0xf bank_mask:0xf
  v_dot2c_f32_bf16_dpp v20, v38, v58 row_newbcast:12 row_mask:0xf bank_mask:0xf
  v_dot2c_f32_bf16_dpp v21, v39, v58 row_newbcast:12 row_mask:0xf bank_mask:0xf
  v_dot2c_f32_bf16_dpp v22, v38, v59 row_newbcast:12 row_mask:0xf bank_mask:0xf
  v_dot2c_f32_bf16_dpp v23, v39, v59 row_newbcast:12 row_mask:0xf bank_mask:0xf
  s_waitcnt vmcnt(4)
  buffer_load_dwordx4 v[48:51], v2, s[48:51], s72 offen offset:1024 nt
  v_add_u32 v42, 1, v42
  ds_write_b32 v41, v42
  v_cvt_pk_bf16_f32 v38, v35, 0
  v_cvt_pk_bf16_f32 v39, 0, v35
  s_nop 0
  v_dot2c_f32_bf16_dpp v16, v38, v60 row_newbcast:0 row_mask:0xf bank_mask:0xf
  v_dot2c_f32_bf16_dpp v17, v39, v60 row_newbcast:0 row_mask:0xf bank_mask:0xf
  v_dot2c_f32_bf16_dpp v18, v38, v61 row_newbcast:0 row_mask:0xf bank_mask:0xf
  v_dot2c_f32_bf16_dpp v19, v39, v61 row_newbcast:0 row_mask:0xf bank_mask:0xf
  v_dot2c_f32_bf16_dpp v20, v38, v62 row_newbcast:0 row_mask:0xf bank_mask:0xf
  v_dot2c_f32_bf16_dpp v21, v39, v62 row_newbcast:0 row_mask:0xf bank_mask:0xf
  v_dot2c_f32_bf16_dpp v22, v38, v63 row_newbcast:0 row_mask:0xf bank_mask:0xf
  v_dot2c_f32_bf16_dpp v23, v39, v63 row_newbcast:0 row_mask:0xf bank_mask:0xf
  s_waitcnt vmcnt(4)
  buffer_load_dwordx4 v[52:55], v2, s[48:51], s72 offen offset:2048 nt
  v_dot2c_f32_bf16_dpp v16, v38, v64 row_newbcast:4 row_mask:0xf bank_mask:0xf
  v_dot2c_f32_bf16_dpp v17, v39, v64 row_newbcast:4 row_mask:0xf bank_mask:0xf
  v_dot2c_f32_bf16_dpp v18, v38, v65 row_newbcast:4 row_mask:0xf bank_mask:0xf
  v_dot2c_f32_bf16_dpp v19, v39, v65 row_newbcast:4 row_mask:0xf bank_mask:0xf
  v_dot2c_f32_bf16_dpp v20, v38, v66 row_newbcast:4 row_mask:0xf bank_mask:0xf
  v_dot2c_f32_bf16_dpp v21, v39, v66 row_newbcast:4 row_mask:0xf bank_mask:0xf
  v_dot2c_f32_bf16_dpp v22, v38, v67 row_newbcast:4 row_mask:0xf bank_mask:0xf
  v_dot2c_f32_bf16_dpp v23, v39, v67 row_newbcast:4 row_mask:0xf bank_mask:0xf
  s_waitcnt vmcnt(4)
  buffer_load_dwordx4 v[56:59], v2, s[48:51], s72 offen offset:3072 nt
  s_add_u32 s72, s72, 16384
  buffer_load_dwordx4 v[60:63], v2, s[48:51], s72 offen offset:0 nt
  v_add_u32 v42, 1, v42
  ds_write_b32 v41, v42
  v_dot2c_f32_bf16_dpp v16, v38, v68 row_newbcast:8 row_mask:0xf bank_mask:0xf
  v_dot2c_f32_bf16_dpp v17, v39, v68 row_newbcast:8 row_mask:0xf bank_mask:0xf
  v_dot2c_f32_bf16_dpp v18, v38, v69 row_newbcast:8 row_mask:0xf bank_mask:0xf
  v_dot2c_f32_bf16_dpp v19, v39, v69 row_newbcast:8 row_mask:0xf bank_mask:0xf
  v_dot2c_f32_bf16_dpp v20, v38, v70 row_newbcast:8 row_mask:0xf bank_mask:0xf
  v_dot2c_f32_bf16_dpp v21, v39, v70 row_newbcast:8 row_mask:0xf bank_mask:0xf
  v_dot2c_f32_bf16_dpp v22, v38, v71 row_newbcast:8 row_mask:0xf bank_mask:0xf
  v_dot2c_f32_bf16_dpp v23, v39, v71 row_newbcast:8 row_mask:0xf bank_mask:0xf
  s_waitcnt vmcnt(5)
  v_dot2c_f32_bf16_dpp v16, v38, v72 row_newbcast:12 row_mask:0xf bank_mask:0xf
  v_dot2c_f32_bf16_dpp v17, v39, v72 row_newbcast:12 row_mask:0xf bank_mask:0xf
  v_dot2c_f32_bf16_dpp v18, v38, v73 row_newbcast:12 row_mask:0xf bank_mask:0xf
  v_dot2c_f32_bf16_dpp v19, v39, v73 row_newbcast:12 row_mask:0xf bank_mask:0xf
  v_dot2c_f32_bf16_dpp v20, v38, v74 row_newbcast:12 row_mask:0xf bank_mask:0xf
  v_dot2c_f32_bf16_dpp v21, v39, v74 row_newbcast:12 row_mask:0xf bank_mask:0xf
  v_dot2c_f32_bf16_dpp v22, v38, v75 row_newbcast:12 row_mask:0xf bank_mask:0xf
  v_dot2c_f32_bf16_dpp v23, v39, v75 row_newbcast:12 row_mask:0xf bank_mask:0xf
  s_mov_b32 s73, 24
  v_mov_b32 v5, 0
  ds_read_b32 v43, v5 offset:3536
  s_nop 4
L_vh5:
  s_waitcnt lgkmcnt(0)
  v_readfirstlane_b32 s10, v43
  v_mov_b32 v5, 0
  ds_read_b32 v43, v5 offset:3536
  s_cmp_eq_u32 s73, 1
  s_nop 0
  s_cselect_b32 s10, 0, s10
  s_cmp_eq_u32 s10, 1
  s_cbranch_scc1 L_vB
  s_cmp_eq_u32 s10, 2
  s_cbranch_scc1 L_vS
L_vA:
  s_waitcnt vmcnt(4)
  buffer_load_dwordx4 v[64:67], v2, s[48:51], s72 offen offset:1024 nt
  v_add_u32 v42, 1, v42
  ds_write_b32 v41, v42
  s_waitcnt lgkmcnt(0)
  v_sub_f32 v34, v36, v24
  v_sub_f32 v35, v37, v24
  ds_read_b64 v[36:37], v25
  v_add_u32 v25, 128, v25
  v_mul_f32 v34, s75, v34
  v_mul_f32 v35, s75, v35
  v_exp_f32 v34, v34
  v_exp_f32 v35, v35
  v_add_f32 v33, v33, v34
  v_add_f32 v33, v33, v35
  v_cvt_pk_bf16_f32 v38, v34, 0
  v_cvt_pk_bf16_f32 v39, 0, v34
  s_nop 0
  v_dot2c_f32_bf16_dpp v16, v38, v44 row_newbcast:0 row_mask:0xf bank_mask:0xf
  v_dot2c_f32_bf16_dpp v17, v39, v44 row_newbcast:0 row_mask:0xf bank_mask:0xf
  v_dot2c_f32_bf16_dpp v18, v38, v45 row_newbcast:0 row_mask:0xf bank_mask:0xf
  v_dot2c_f32_bf16_dpp v19, v39, v45 row_newbcast:0 row_mask:0xf bank_mask:0xf
  v_dot2c_f32_bf16_dpp v20, v38, v46 row_newbcast:0 row_mask:0xf bank_mask:0xf
  v_dot2c_f32_bf16_dpp v21, v39, v46 row_newbcast:0 row_mask:0xf bank_mask:0xf
  v_dot2c_f32_bf16_dpp v22, v38, v47 row_newbcast:0 row_mask:0xf bank_mask:0xf
  v_dot2c_f32_bf16_dpp v23, v39, v47 row_newbcast:0 row_mask:0xf bank_mask:0xf
  s_waitcnt vmcnt(4)
  buffer_load_dwordx4 v[68:71], v2, s[48:51], s72 offen offset:2048 nt
  v_dot2c_f32_bf16_dpp v16, v38, v48 row_newbcast:4 row_mask:0xf bank_mask:0xf
  v_dot2c_f32_bf16_dpp v17, v39, v48 row_newbcast:4 row_mask:0xf bank_mask:0xf
  v_dot2c_f32_bf16_dpp v18, v38, v49 row_newbcast:4 row_mask:0xf bank_mask:0xf
  v_dot2c_f32_bf16_dpp v19, v39, v49 row_newbcast:4 row_mask:0xf bank_mask:0xf
  v_dot2c_f32_bf16_dpp v20, v38, v50 row_newbcast:4 row_mask:0xf bank_mask:0xf
  v_dot2c_f32_bf16_dpp v21, v39, v50 row_newbcast:4 row_mask:0xf bank_mask:0xf
  v_dot2c_f32_bf16_dpp v22, v38, v51 row_newbcast:4 row_mask:0xf bank_mask:0xf
  v_dot2c_f32_bf16_dpp v23, v39, v51 row_newbcast:4 row_mask:0xf bank_mask:0xf
  s_waitcnt vmcnt(4)
  buffer_load_dwordx4 v[72:75], v2, s[48:51], s72 offen offset:3072 nt
  s_add_u32 s72, s72, 16384
  buffer_load_dwordx4 v[44:47], v2, s[48:51], s72 offen offset:0 nt
  v_add_u32 v42, 1, v42
  ds_write_b32 v41, v42
  v_dot2c_f32_bf16_dpp v16, v38, v52 row_newbcast:8 row_mask:0xf bank_mask:0xf
  v_dot2c_f32_bf16_dpp v17, v39, v52 row_newbcast:8 row_mask:0xf bank_mask:0xf
  v_dot2c_f32_bf16_dpp v18, v38, v53 row_newbcast:8 row_mask:0xf bank_mask:0xf
  v_dot2c_f32_bf16_dpp v19, v39, v53 row_newbcast:8 row_mask:0xf bank_mask:0xf
  v_dot2c_f32_bf16_dpp v20, v38, v54 row_newbcast:8 row_mask:0xf bank_mask:0xf
  v_dot2c_f32_bf16_dpp v21, v39, v54 row_newbcast:8 row_mask:0xf bank_mask:0xf
  v_dot2c_f32_bf16_dpp v22, v38, v55 row_newbcast:8 row_mask:0xf bank_mask:0xf
  v_dot2c_f32_bf16_dpp v23, v39, v55 row_newbcast:8 row_mask:0xf bank_mask:0xf
  s_waitcnt vmcnt(5)
  v_dot2c_f32_bf16_dpp v16, v38, v56 row_newbcast:12 row_mask:0xf bank_mask:0xf
  v_dot2c_f32_bf16_dpp v17, v39, v56 row_newbcast:12 row_mask:0xf bank_mask:0xf
  v_dot2c_f32_bf16_dpp v18, v38, v57 row_newbcast:12 row_mask:0xf bank_mask:0xf
  v_dot2c_f32_bf16_dpp v19, v39, v57 row_newbcast:12 row_mask:0xf bank_mask:0xf
  v_dot2c_f32_bf16_dpp v20, v38, v58 row_newbcast:12 row_mask:0xf bank_mask:0xf
  v_dot2c_f32_bf16_dpp v21, v39, v58 row_newbcast:12 row_mask:0xf bank_mask:0xf
  v_dot2c_f32_bf16_dpp v22, v38, v59 row_newbcast:12 row_mask:0xf bank_mask:0xf
  v_dot2c_f32_bf16_dpp v23, v39, v59 row_newbcast:12 row_mask:0xf bank_mask:0xf
  s_waitcnt vmcnt(4)
  buffer_load_dwordx4 v[48:51], v2, s[48:51], s72 offen offset:1024 nt
  v_add_u32 v42, 1, v42
  ds_write_b32 v41, v42
  v_cvt_pk_bf16_f32 v38, v35, 0
  v_cvt_pk_bf16_f32 v39, 0, v35
  s_nop 0
  v_dot2c_f32_bf16_dpp v16, v38, v60 row_newbcast:0 row_mask:0xf bank_mask:0xf
  v_dot2c_f32_bf16_dpp v17, v39, v60 row_newbcast:0 row_mask:0xf bank_mask:0xf
  v_dot2c_f32_bf16_dpp v18, v38, v61 row_newbcast:0 row_mask:0xf bank_mask:0xf
  v_dot2c_f32_bf16_dpp v19, v39, v61 row_newbcast:0 row_mask:0xf bank_mask:0xf
  v_dot2c_f32_bf16_dpp v20, v38, v62 row_newbcast:0 row_mask:0xf bank_mask:0xf
  v_dot2c_f32_bf16_dpp v21, v39, v62 row_newbcast:0 row_mask:0xf bank_mask:0xf
  v_dot2c_f32_bf16_dpp v22, v38, v63 row_newbcast:0 row_mask:0xf bank_mask:0xf
  v_dot2c_f32_bf16_dpp v23, v39, v63 row_newbcast:0 row_mask:0xf bank_mask:0xf
  s_waitcnt vmcnt(4)
  buffer_load_dwordx4 v[52:55], v2, s[48:51], s72 offen offset:2048 nt
  v_dot2c_f32_bf16_dpp v16, v38, v64 row_newbcast:4 row_mask:0xf bank_mask:0xf
  v_dot2c_f32_bf16_dpp v17, v39, v64 row_newbcast:4 row_mask:0xf bank_mask:0xf
  v_dot2c_f32_bf16_dpp v18, v38, v65 row_newbcast:4 row_mask:0xf bank_mask:0xf
  v_dot2c_f32_bf16_dpp v19, v39, v65 row_newbcast:4 row_mask:0xf bank_mask:0xf
  v_dot2c_f32_bf16_dpp v20, v38, v66 row_newbcast:4 row_mask:0xf bank_mask:0xf
  v_dot2c_f32_bf16_dpp v21, v39, v66 row_newbcast:4 row_mask:0xf bank_mask:0xf
  v_dot2c_f32_bf16_dpp v22, v38, v67 row_newbcast:4 row_mask:0xf bank_mask:0xf
  v_dot2c_f32_bf16_dpp v23, v39, v67 row_newbcast:4 row_mask:0xf bank_mask:0xf
  s_waitcnt vmcnt(4)
  buffer_load_dwordx4 v[56:59], v2, s[48:51], s72 offen offset:3072 nt
  s_add_u32 s72, s72, 16384
  buffer_load_dwordx4 v[60:63], v2, s[48:51], s72 offen offset:0 nt
  v_add_u32 v42, 1, v42
  ds_write_b32 v41, v42
  v_dot2c_f32_bf16_dpp v16, v38, v68 row_newbcast:8 row_mask:0xf bank_mask:0xf
  v_dot2c_f32_bf16_dpp v17, v39, v68 row_newbcast:8 row_mask:0xf bank_mask:0xf
  v_dot2c_f32_bf16_dpp v18, v38, v69 row_newbcast:8 row_mask:0xf bank_mask:0xf
  v_dot2c_f32_bf16_dpp v19, v39, v69 row_newbcast:8 row_mask:0xf bank_mask:0xf
  v_dot2c_f32_bf16_dpp v20, v38, v70 row_newbcast:8 row_mask:0xf bank_mask:0xf
  v_dot2c_f32_bf16_dpp v21, v39, v70 row_newbcast:8 row_mask:0xf bank_mask:0xf
  v_dot2c_f32_bf16_dpp v22, v38, v71 row_newbcast:8 row_mask:0xf bank_mask:0xf
  v_dot2c_f32_bf16_dpp v23, v39, v71 row_newbcast:8 row_mask:0xf bank_mask:0xf
  s_waitcnt vmcnt(5)
  v_dot2c_f32_bf16_dpp v16, v38, v72 row_newbcast:12 row_mask:0xf bank_mask:0xf
  v_dot2c_f32_bf16_dpp v17, v39, v72 row_newbcast:12 row_mask:0xf bank_mask:0xf
  v_dot2c_f32_bf16_dpp v18, v38, v73 row_newbcast:12 row_mask:0xf bank_mask:0xf
  v_dot2c_f32_bf16_dpp v19, v39, v73 row_newbcast:12 row_mask:0xf bank_mask:0xf
  v_dot2c_f32_bf16_dpp v20, v38, v74 row_newbcast:12 row_mask:0xf bank_mask:0xf
  v_dot2c_f32_bf16_dpp v21, v39, v74 row_newbcast:12 row_mask:0xf bank_mask:0xf
  v_dot2c_f32_bf16_dpp v22, v38, v75 row_newbcast:12 row_mask:0xf bank_mask:0xf
  v_dot2c_f32_bf16_dpp v23, v39, v75 row_newbcast:12 row_mask:0xf bank_mask:0xf
  s_sub_u32 s73, s73, 1
  s_cmp_lg_u32 s73, 0
  s_nop 4
  s_cbranch_scc1 L_vh5
  s_branch L_vexit
L_vS:
  s_waitcnt vmcnt(4)
  buffer_load_dwordx4 v[64:67], v2, s[48:51], s72 offen offset:1024 nt
  v_add_u32 v42, 1, v42
  ds_write_b32 v41, v42
  s_waitcnt lgkmcnt(0)
  v_sub_f32 v34, v36, v24
  v_sub_f32 v35, v37, v24
  ds_read_b64 v[36:37], v25
  v_add_u32 v25, 128, v25
  v_mul_f32 v34, s75, v34
  v_mul_f32 v35, s75, v35
  v_exp_f32 v34, v34
  v_exp_f32 v35, v35
  v_add_f32 v33, v33, v34
  v_add_f32 v33, v33, v35
  v_cvt_pk_bf16_f32 v38, v34, 0
  v_cvt_pk_bf16_f32 v39, 0, v34
  s_nop 0
  v_dot2c_f32_bf16_dpp v16, v38, v44 row_newbcast:0 row_mask:0xf bank_mask:0xf
  v_dot2c_f32_bf16_dpp v17, v39, v44 row_newbcast:0 row_mask:0xf bank_mask:0xf
  v_dot2c_f32_bf16_dpp v18, v38, v45 row_newbcast:0 row_mask:0xf bank_mask:0xf
  v_dot2c_f32_bf16_dpp v19, v39, v45 row_newbcast:0 row_mask:0xf bank_mask:0xf
  v_dot2c_f32_bf16_dpp v20, v38, v46 row_newbcast:0 row_mask:0xf bank_mask:0xf
  v_dot2c_f32_bf16_dpp v21, v39, v46 row_newbcast:0 row_mask:0xf bank_mask:0xf
  v_dot2c_f32_bf16_dpp v22, v38, v47 row_newbcast:0 row_mask:0xf bank_mask:0xf
  v_dot2c_f32_bf16_dpp v23, v39, v47 row_newbcast:0 row_mask:0xf bank_mask:0xf
  s_waitcnt vmcnt(4)
  buffer_load_dwordx4 v[68:71], v2, s[48:51], s72 offen offset:2048 nt
  v_dot2c_f32_bf16_dpp v16, v38, v48 row_newbcast:4 row_mask:0xf bank_mask:0xf
  v_dot2c_f32_bf16_dpp v17, v39, v48 row_newbcast:4 row_mask:0xf bank_mask:0xf
  v_dot2c_f32_bf16_dpp v18, v38, v49 row_newbcast:4 row_mask:0xf bank_mask:0xf
  v_dot2c_f32_bf16_dpp v19, v39, v49 row_newbcast:4 row_mask:0xf bank_mask:0xf
  v_dot2c_f32_bf16_dpp v20, v38, v50 row_newbcast:4 row_mask:0xf bank_mask:0xf
  v_dot2c_f32_bf16_dpp v21, v39, v50 row_newbcast:4 row_mask:0xf bank_mask:0xf
  v_dot2c_f32_bf16_dpp v22, v38, v51 row_newbcast:4 row_mask:0xf bank_mask:0xf
  v_dot2c_f32_bf16_dpp v23, v39, v51 row_newbcast:4 row_mask:0xf bank_mask:0xf
  s_waitcnt vmcnt(4)
  buffer_load_dwordx4 v[72:75], v2, s[48:51], s72 offen offset:3072 nt
  s_add_u32 s72, s72, 16384
  v_add_u32 v42, 1, v42
  ds_write_b32 v41, v42
  v_dot2c_f32_bf16_dpp v16, v38, v52 row_newbcast:8 row_mask:0xf bank_mask:0xf
  v_dot2c_f32_bf16_dpp v17, v39, v52 row_newbcast:8 row_mask:0xf bank_mask:0xf
  v_dot2c_f32_bf16_dpp v18, v38, v53 row_newbcast:8 row_mask:0xf bank_mask:0xf
  v_dot2c_f32_bf16_dpp v19, v39, v53 row_newbcast:8 row_mask:0xf bank_mask:0xf
  v_dot2c_f32_bf16_dpp v20, v38, v54 row_newbcast:8 row_mask:0xf bank_mask:0xf
  v_dot2c_f32_bf16_dpp v21, v39, v54 row_newbcast:8 row_mask:0xf bank_mask:0xf
  v_dot2c_f32_bf16_dpp v22, v38, v55 row_newbcast:8 row_mask:0xf bank_mask:0xf
  v_dot2c_f32_bf16_dpp v23, v39, v55 row_newbcast:8 row_mask:0xf bank_mask:0xf
  s_waitcnt vmcnt(4)
  buffer_load_dwordx4 v[44:47], v2, s[48:51], s72 offen offset:0 nt
  v_dot2c_f32_bf16_dpp v16, v38, v56 row_newbcast:12 row_mask:0xf bank_mask:0xf
  v_dot2c_f32_bf16_dpp v17, v39, v56 row_newbcast:12 row_mask:0xf bank_mask:0xf
  v_dot2c_f32_bf16_dpp v18, v38, v57 row_newbcast:12 row_mask:0xf bank_mask:0xf
  v_dot2c_f32_bf16_dpp v19, v39, v57 row_newbcast:12 row_mask:0xf bank_mask:0xf
  v_dot2c_f32_bf16_dpp v20, v38, v58 row_newbcast:12 row_mask:0xf bank_mask:0xf
  v_dot2c_f32_bf16_dpp v21, v39, v58 row_newbcast:12 row_mask:0xf bank_mask:0xf
  v_dot2c_f32_bf16_dpp v22, v38, v59 row_newbcast:12 row_mask:0xf bank_mask:0xf
  v_dot2c_f32_bf16_dpp v23, v39, v59 row_newbcast:12 row_mask:0xf bank_mask:0xf
  s_waitcnt vmcnt(4)
  buffer_load_dwordx4 v[48:51], v2, s[48:51], s72 offen offset:1024 nt
  v_add_u32 v42, 1, v42
  ds_write_b32 v41, v42
  v_cvt_pk_bf16_f32 v38, v35, 0
  v_cvt_pk_bf16_f32 v39, 0, v35
  s_nop 0
  v_dot2c_f32_bf16_dpp v16, v38, v60 row_newbcast:0 row_mask:0xf bank_mask:0xf
  v_dot2c_f32_bf16_dpp v17, v39, v60 row_newbcast:0 row_mask:0xf bank_mask:0xf
  v_dot2c_f32_bf16_dpp v18, v38, v61 row_newbcast:0 row_mask:0xf bank_mask:0xf
  v_dot2c_f32_bf16_dpp v19, v39, v61 row_newbcast:0 row_mask:0xf bank_mask:0xf
  v_dot2c_f32_bf16_dpp v20, v38, v62 row_newbcast:0 row_mask:0xf bank_mask:0xf
  v_dot2c_f32_bf16_dpp v21, v39, v62 row_newbcast:0 row_mask:0xf bank_mask:0xf
  v_dot2c_f32_bf16_dpp v22, v38, v63 row_newbcast:0 row_mask:0xf bank_mask:0xf
  v_dot2c_f32_bf16_dpp v23, v39, v63 row_newbcast:0 row_mask:0xf bank_mask:0xf
  s_waitcnt vmcnt(4)
  buffer_load_dwordx4 v[52:55], v2, s[48:51], s72 offen offset:2048 nt
  v_dot2c_f32_bf16_dpp v16, v38, v64 row_newbcast:4 row_mask:0xf bank_mask:0xf
  v_dot2c_f32_bf16_dpp v17, v39, v64 row_newbcast:4 row_mask:0xf bank_mask:0xf
  v_dot2c_f32_bf16_dpp v18, v38, v65 row_newbcast:4 row_mask:0xf bank_mask:0xf
  v_dot2c_f32_bf16_dpp v19, v39, v65 row_newbcast:4 row_mask:0xf bank_mask:0xf
  v_dot2c_f32_bf16_dpp v20, v38, v66 row_newbcast:4 row_mask:0xf bank_mask:0xf
  v_dot2c_f32_bf16_dpp v21, v39, v66 row_newbcast:4 row_mask:0xf bank_mask:0xf
  v_dot2c_f32_bf16_dpp v22, v38, v67 row_newbcast:4 row_mask:0xf bank_mask:0xf
  v_dot2c_f32_bf16_dpp v23, v39, v67 row_newbcast:4 row_mask:0xf bank_mask:0xf
  s_waitcnt vmcnt(4)
  v_add_u32 v42, 1, v42
  ds_write_b32 v41, v42
  v_dot2c_f32_bf16_dpp v16, v38, v68 row_newbcast:8 row_mask:0xf bank_mask:0xf
  v_dot2c_f32_bf16_dpp v17, v39, v68 row_newbcast:8 row_mask:0xf bank_mask:0xf
  v_dot2c_f32_bf16_dpp v18, v38, v69 row_newbcast:8 row_mask:0xf bank_mask:0xf
  v_dot2c_f32_bf16_dpp v19, v39, v69 row_newbcast:8 row_mask:0xf bank_mask:0xf
  v_dot2c_f32_bf16_dpp v20, v38, v70 row_newbcast:8 row_mask:0xf bank_mask:0xf
  v_dot2c_f32_bf16_dpp v21, v39, v70 row_newbcast:8 row_mask:0xf bank_mask:0xf
  v_dot2c_f32_bf16_dpp v22, v38, v71 row_newbcast:8 row_mask:0xf bank_mask:0xf
  v_dot2c_f32_bf16_dpp v23, v39, v71 row_newbcast:8 row_mask:0xf bank_mask:0xf
  s_waitcnt vmcnt(3)
  buffer_load_dwordx4 v[56:59], v2, s[48:51], s72 offen offset:3072 nt
  s_add_u32 s72, s72, 16384
  buffer_load_dwordx4 v[60:63], v2, s[48:51], s72 offen offset:0 nt
  v_dot2c_f32_bf16_dpp v16, v38, v72 row_newbcast:12 row_mask:0xf bank_mask:0xf
  v_dot2c_f32_bf16_dpp v17, v39, v72 row_newbcast:12 row_mask:0xf bank_mask:0xf
  v_dot2c_f32_bf16_dpp v18, v38, v73 row_newbcast:12 row_mask:0xf bank_mask:0xf
  v_dot2c_f32_bf16_dpp v19, v39, v73 row_newbcast:12 row_mask:0xf bank_mask:0xf
  v_dot2c_f32_bf16_dpp v20, v38, v74 row_newbcast:12 row_mask:0xf bank_mask:0xf
  v_dot2c_f32_bf16_dpp v21, v39, v74 row_newbcast:12 row_mask:0xf bank_mask:0xf
  v_dot2c_f32_bf16_dpp v22, v38, v75 row_newbcast:12 row_mask:0xf bank_mask:0xf
  v_dot2c_f32_bf16_dpp v23, v39, v75 row_newbcast:12 row_mask:0xf bank_mask:0xf
  s_sub_u32 s73, s73, 1
  s_cmp_lg_u32 s73, 0
  s_nop 4
  s_cbranch_scc1 L_vh5
  s_branch L_vexit
L_vB:
  s_waitcnt vmcnt(4)
  buffer_load_dwordx4 v[64:67], v2, s[48:51], s72 offen offset:1024 nt
  buffer_load_dwordx4 v[68:71], v2, s[48:51], s72 offen offset:2048 nt
  v_add_u32 v42, 1, v42
  ds_write_b32 v41, v42
  s_waitcnt lgkmcnt(0)
  v_sub_f32 v34, v36, v24
  v_sub_f32 v35, v37, v24
  ds_read_b64 v[36:37], v25
  v_add_u32 v25, 128, v25
  v_mul_f32 v34, s75, v34
  v_mul_f32 v35, s75, v35
  v_exp_f32 v34, v34
  v_exp_f32 v35, v35
  v_add_f32 v33, v33, v34
  v_add_f32 v33, v33, v35
  v_cvt_pk_bf16_f32 v38, v34, 0
  v_cvt_pk_bf16_f32 v39, 0, v34
  s_nop 0
  v_dot2c_f32_bf16_dpp v16, v38, v44 row_newbcast:0 row_mask:0xf bank_mask:0xf
  v_dot2c_f32_bf16_dpp v17, v39, v44 row_newbcast:0 row_mask:0xf bank_mask:0xf
  v_dot2c_f32_bf16_dpp v18, v38, v45 row_newbcast:0 row_mask:0xf bank_mask:0xf
  v_dot2c_f32_bf16_dpp v19, v39, v45 row_newbcast:0 row_mask:0xf bank_mask:0xf
  v_dot2c_f32_bf16_dpp v20, v38, v46 row_newbcast:0 row_mask:0xf bank_mask:0xf
  v_dot2c_f32_bf16_dpp v21, v39, v46 row_newbcast:0 row_mask:0xf bank_mask:0xf
  v_dot2c_f32_bf16_dpp v22, v38, v47 row_newbcast:0 row_mask:0xf bank_mask:0xf
  v_dot2c_f32_bf16_dpp v23, v39, v47 row_newbcast:0 row_mask:0xf bank_mask:0xf
  s_waitcnt vmcnt(5)
  buffer_load_dwordx4 v[72:75], v2, s[48:51], s72 offen offset:3072 nt
  s_add_u32 s72, s72, 16384
  v_dot2c_f32_bf16_dpp v16, v38, v48 row_newbcast:4 row_mask:0xf bank_mask:0xf
  v_dot2c_f32_bf16_dpp v17, v39, v48 row_newbcast:4 row_mask:0xf bank_mask:0xf
  v_dot2c_f32_bf16_dpp v18, v38, v49 row_newbcast:4 row_mask:0xf bank_mask:0xf
  v_dot2c_f32_bf16_dpp v19, v39, v49 row_newbcast:4 row_mask:0xf bank_mask:0xf
  v_dot2c_f32_bf16_dpp v20, v38, v50 row_newbcast:4 row_mask:0xf bank_mask:0xf
  v_dot2c_f32_bf16_dpp v21, v39, v50 row_newbcast:4 row_mask:0xf bank_mask:0xf
  v_dot2c_f32_bf16_dpp v22, v38, v51 row_newbcast:4 row_mask:0xf bank_mask:0xf
  v_dot2c_f32_bf16_dpp v23, v39, v51 row_newbcast:4 row_mask:0xf bank_mask:0xf
  s_waitcnt vmcnt(5)
  buffer_load_dwordx4 v[44:47], v2, s[48:51], s72 offen offset:0 nt
  v_add_u32 v42, 1, v42
  ds_write_b32 v41, v42
  v_dot2c_f32_bf16_dpp v16, v38, v52 row_newbcast:8 row_mask:0xf bank_mask:0xf
  v_dot2c_f32_bf16_dpp v17, v39, v52 row_newbcast:8 row_mask:0xf bank_mask:0xf
  v_dot2c_f32_bf16_dpp v18, v38, v53 row_newbcast:8 row_mask:0xf bank_mask:0xf
  v_dot2c_f32_bf16_dpp v19, v39, v53 row_newbcast:8 row_mask:0xf bank_mask:0xf
  v_dot2c_f32_bf16_dpp v20, v38, v54 row_newbcast:8 row_mask:0xf bank_mask:0xf
  v_dot2c_f32_bf16_dpp v21, v39, v54 row_newbcast:8 row_mask:0xf bank_mask:0xf
  v_dot2c_f32_bf16_dpp v22, v38, v55 row_newbcast:8 row_mask:0xf bank_mask:0xf
  v_dot2c_f32_bf16_dpp v23, v39, v55 row_newbcast:8 row_mask:0xf bank_mask:0xf
  s_waitcnt vmcnt(5)
  buffer_load_dwordx4 v[48:51], v2, s[48:51], s72 offen offset:1024 nt
  v_dot2c_f32_bf16_dpp v16, v38, v56 row_newbcast:12 row_mask:0xf bank_mask:0xf
  v_dot2c_f32_bf16_dpp v17, v39, v56 row_newbcast:12 row_mask:0xf bank_mask:0xf
  v_dot2c_f32_bf16_dpp v18, v38, v57 row_newbcast:12 row_mask:0xf bank_mask:0xf
  v_dot2c_f32_bf16_dpp v19, v39, v57 row_newbcast:12 row_mask:0xf bank_mask:0xf
  v_dot2c_f32_bf16_dpp v20, v38, v58 row_newbcast:12 row_mask:0xf bank_mask:0xf
  v_dot2c_f32_bf16_dpp v21, v39, v58 row_newbcast:12 row_mask:0xf bank_mask:0xf
  v_dot2c_f32_bf16_dpp v22, v38, v59 row_newbcast:12 row_mask:0xf bank_mask:0xf
  v_dot2c_f32_bf16_dpp v23, v39, v59 row_newbcast:12 row_mask:0xf bank_mask:0xf
  s_waitcnt vmcnt(5)
  buffer_load_dwordx4 v[52:55], v2, s[48:51], s72 offen offset:2048 nt
  v_add_u32 v42, 1, v42
  ds_write_b32 v41, v42
  v_cvt_pk_bf16_f32 v38, v35, 0
  v_cvt_pk_bf16_f32 v39, 0, v35
  s_nop 0
  v_dot2c_f32_bf16_dpp v16, v38, v60 row_newbcast:0 row_mask:0xf bank_mask:0xf
  v_dot2c_f32_bf16_dpp v17, v39, v60 row_newbcast:0 row_mask:0xf bank_mask:0xf
  v_dot2c_f32_bf16_dpp v18, v38, v61 row_newbcast:0 row_mask:0xf bank_mask:0xf
  v_dot2c_f32_bf16_dpp v19, v39, v61 row_newbcast:0 row_mask:0xf bank_mask:0xf
  v_dot2c_f32_bf16_dpp v20, v38, v62 row_newbcast:0 row_mask:0xf bank_mask:0xf
  v_dot2c_f32_bf16_dpp v21, v39, v62 row_newbcast:0 row_mask:0xf bank_mask:0xf
  v_dot2c_f32_bf16_dpp v22, v38, v63 row_newbcast:0 row_mask:0xf bank_mask:0xf
  v_dot2c_f32_bf16_dpp v23, v39, v63 row_newbcast:0 row_mask:0xf bank_mask:0xf
  s_waitcnt vmcnt(5)
  buffer_load_dwordx4 v[56:59], v2, s[48:51], s72 offen offset:3072 nt
  s_add_u32 s72, s72, 16384
  v_dot2c_f32_bf16_dpp v16, v38, v64 row_newbcast:4 row_mask:0xf bank_mask:0xf
  v_dot2c_f32_bf16_dpp v17, v39, v64 row_newbcast:4 row_mask:0xf bank_mask:0xf
  v_dot2c_f32_bf16_dpp v18, v38, v65 row_newbcast:4 row_mask:0xf bank_mask:0xf
  v_dot2c_f32_bf16_dpp v19, v39, v65 row_newbcast:4 row_mask:0xf bank_mask:0xf
  v_dot2c_f32_bf16_dpp v20, v38, v66 row_newbcast:4 row_mask:0xf bank_mask:0xf
  v_dot2c_f32_bf16_dpp v21, v39, v66 row_newbcast:4 row_mask:0xf bank_mask:0xf
  v_dot2c_f32_bf16_dpp v22, v38, v67 row_newbcast:4 row_mask:0xf bank_mask:0xf
  v_dot2c_f32_bf16_dpp v23, v39, v67 row_newbcast:4 row_mask:0xf bank_mask:0xf
  s_waitcnt vmcnt(5)
  buffer_load_dwordx4 v[60:63], v2, s[48:51], s72 offen offset:0 nt
  v_add_u32 v42, 1, v42
  ds_write_b32 v41, v42
  v_dot2c_f32_bf16_dpp v16, v38, v68 row_newbcast:8 row_mask:0xf bank_mask:0xf
  v_dot2c_f32_bf16_dpp v17, v39, v68 row_newbcast:8 row_mask:0xf bank_mask:0xf
  v_dot2c_f32_bf16_dpp v18, v38, v69 row_newbcast:8 row_mask:0xf bank_mask:0xf
  v_dot2c_f32_bf16_dpp v19, v39, v69 row_newbcast:8 row_mask:0xf bank_mask:0xf
  v_dot2c_f32_bf16_dpp v20, v38, v70 row_newbcast:8 row_mask:0xf bank_mask:0xf
  v_dot2c_f32_bf16_dpp v21, v39, v70 row_newbcast:8 row_mask:0xf bank_mask:0xf
  v_dot2c_f32_bf16_dpp v22, v38, v71 row_newbcast:8 row_mask:0xf bank_mask:0xf
  v_dot2c_f32_bf16_dpp v23, v39, v71 row_newbcast:8 row_mask:0xf bank_mask:0xf
  s_waitcnt vmcnt(5)
  buffer_load_dwordx4 v[64:67], v2, s[48:51], s72 offen offset:1024 nt
  v_dot2c_f32_bf16_dpp v16, v38, v72 row_newbcast:12 row_mask:0xf bank_mask:0xf
  v_dot2c_f32_bf16_dpp v17, v39, v72 row_newbcast:12 row_mask:0xf bank_mask:0xf
  v_dot2c_f32_bf16_dpp v18, v38, v73 row_newbcast:12 row_mask:0xf bank_mask:0xf
  v_dot2c_f32_bf16_dpp v19, v39, v73 row_newbcast:12 row_mask:0xf bank_mask:0xf
  v_dot2c_f32_bf16_dpp v20, v38, v74 row_newbcast:12 row_mask:0xf bank_mask:0xf
  v_dot2c_f32_bf16_dpp v21, v39, v74 row_newbcast:12 row_mask:0xf bank_mask:0xf
  v_dot2c_f32_bf16_dpp v22, v38, v75 row_newbcast:12 row_mask:0xf bank_mask:0xf
  v_dot2c_f32_bf16_dpp v23, v39, v75 row_newbcast:12 row_mask:0xf bank_mask:0xf
  s_sub_u32 s73, s73, 1
  s_cmp_lg_u32 s73, 0
  s_nop 4
  s_cbranch_scc1 L_vh6
L_vh6:
  s_waitcnt lgkmcnt(0)
  v_readfirstlane_b32 s10, v43
  v_mov_b32 v5, 0
  ds_read_b32 v43, v5 offset:3536
  s_cmp_eq_u32 s73, 1
  s_nop 0
  s_cselect_b32 s10, 0, s10
  s_cmp_eq_u32 s10, 1
  s_cbranch_scc0 L_vD
L_vC:
  s_waitcnt vmcnt(5)
  buffer_load_dwordx4 v[68:71], v2, s[48:51], s72 offen offset:2048 nt
  v_add_u32 v42, 1, v42
  ds_write_b32 v41, v42
  s_waitcnt lgkmcnt(0)
  v_sub_f32 v34, v36, v24
  v_sub_f32 v35, v37, v24
  ds_read_b64 v[36:37], v25
  v_add_u32 v25, 128, v25
  v_mul_f32 v34, s75, v34
  v_mul_f32 v35, s75, v35
  v_exp_f32 v34, v34
  v_exp_f32 v35, v35
  v_add_f32 v33, v33, v34
  v_add_f32 v33, v33, v35
  v_cvt_pk_bf16_f32 v38, v34, 0
  v_cvt_pk_bf16_f32 v39, 0, v34
  s_nop 0
  v_dot2c_f32_bf16_dpp v16, v38, v44 row_newbcast:0 row_mask:0xf bank_mask:0xf
  v_dot2c_f32_bf16_dpp v17, v39, v44 row_newbcast:0 row_mask:0xf bank_mask:0xf
  v_dot2c_f32_bf16_dpp v18, v38, v45 row_newbcast:0 row_mask:0xf bank_mask:0xf
  v_dot2c_f32_bf16_dpp v19, v39, v45 row_newbcast:0 row_mask:0xf bank_mask:0xf
  v_dot2c_f32_bf16_dpp v20, v38, v46 row_newbcast:0 row_mask:0xf bank_mask:0xf
  v_dot2c_f32_bf16_dpp v21, v39, v46 row_newbcast:0 row_mask:0xf bank_mask:0xf
  v_dot2c_f32_bf16_dpp v22, v38, v47 row_newbcast:0 row_mask:0xf bank_mask:0xf
  v_dot2c_f32_bf16_dpp v23, v39, v47 row_newbcast:0 row_mask:0xf bank_mask:0xf
  s_waitcnt vmcnt(5)
  buffer_load_dwordx4 v[72:75], v2, s[48:51], s72 offen offset:3072 nt
  s_add_u32 s72, s72, 16384
  v_dot2c_f32_bf16_dpp v16, v38, v48 row_newbcast:4 row_mask:0xf bank_mask:0xf
  v_dot2c_f32_bf16_dpp v17, v39, v48 row_newbcast:4 row_mask:0xf bank_mask:0xf
  v_dot2c_f32_bf16_dpp v18, v38, v49 row_newbcast:4 row_mask:0xf bank_mask:0xf
  v_dot2c_f32_bf16_dpp v19, v39, v49 row_newbcast:4 row_mask:0xf bank_mask:0xf
  v_dot2c_f32_bf16_dpp v20, v38, v50 row_newbcast:4 row_mask:0xf bank_mask:0xf
  v_dot2c_f32_bf16_dpp v21, v39, v50 row_newbcast:4 row_mask:0xf bank_mask:0xf
  v_dot2c_f32_bf16_dpp v22, v38, v51 row_newbcast:4 row_mask:0xf bank_mask:0xf
  v_dot2c_f32_bf16_dpp v23, v39, v51 row_newbcast:4 row_mask:0xf bank_mask:0xf
  s_waitcnt vmcnt(5)
  buffer_load_dwordx4 v[44:47], v2, s[48:51], s72 offen offset:0 nt
  v_add_u32 v42, 1, v42
  ds_write_b32 v41, v42
  v_dot2c_f32_bf16_dpp v16, v38, v52 row_newbcast:8 row_mask:0xf bank_mask:0xf
  v_dot2c_f32_bf16_dpp v17, v39, v52 row_newbcast:8 row_mask:0xf bank_mask:0xf
  v_dot2c_f32_bf16_dpp v18, v38, v53 row_newbcast:8 row_mask:0xf bank_mask:0xf
  v_dot2c_f32_bf16_dpp v19, v39, v53 row_newbcast:8 row_mask:0xf bank_mask:0xf
  v_dot2c_f32_bf16_dpp v20, v38, v54 row_newbcast:8 row_mask:0xf bank_mask:0xf
  v_dot2c_f32_bf16_dpp v21, v39, v54 row_newbcast:8 row_mask:0xf bank_mask:0xf
  v_dot2c_f32_bf16_dpp v22, v38, v55 row_newbcast:8 row_mask:0xf bank_mask:0xf
  v_dot2c_f32_bf16_dpp v23, v39, v55 row_newbcast:8 row_mask:0xf bank_mask:0xf
  s_waitcnt vmcnt(5)
  buffer_load_dwordx4 v[48:51], v2, s[48:51], s72 offen offset:1024 nt
  v_dot2c_f32_bf16_dpp v16, v38, v56 row_newbcast:12 row_mask:0xf bank_mask:0xf
  v_dot2c_f32_bf16_dpp v17, v39, v56 row_newbcast:12 row_mask:0xf bank_mask:0xf
  v_dot2c_f32_bf16_dpp v18, v38, v57 row_newbcast:12 row_mask:0xf bank_mask:0xf
  v_dot2c_f32_bf16_dpp v19, v39, v57 row_newbcast:12 row_mask:0xf bank_mask:0xf
  v_dot2c_f32_bf16_dpp v20, v38, v58 row_newbcast:12 row_mask:0xf bank_mask:0xf
  v_dot2c_f32_bf16_dpp v21, v39, v58 row_newbcast:12 row_mask:0xf bank_mask:0xf
  v_dot2c_f32_bf16_dpp v22, v38, v59 row_newbcast:12 row_mask:0xf bank_mask:0xf
  v_dot2c_f32_bf16_dpp v23, v39, v59 row_newbcast:12 row_mask:0xf bank_mask:0xf
  s_waitcnt vmcnt(5)
  buffer_load_dwordx4 v[52:55], v2, s[48:51], s72 offen offset:2048 nt
  v_add_u32 v42, 1, v42
  ds_write_b32 v41, v42
  v_cvt_pk_bf16_f32 v38, v35, 0
  v_cvt_pk_bf16_f32 v39, 0, v35
  s_nop 0
  v_dot2c_f32_bf16_dpp v16, v38, v60 row_newbcast:0 row_mask:0xf bank_mask:0xf
  v_dot2c_f32_bf16_dpp v17, v39, v60 row_newbcast:0 row_mask:0xf bank_mask:0xf
  v_dot2c_f32_bf16_dpp v18, v38, v61 row_newbcast:0 row_mask:0xf bank_mask:0xf
  v_dot2c_f32_bf16_dpp v19, v39, v61 row_newbcast:0 row_mask:0xf bank_mask:0xf
  v_dot2c_f32_bf16_dpp v20, v38, v62 row_newbcast:0 row_mask:0xf bank_mask:0xf
  v_dot2c_f32_bf16_dpp v21, v39, v62 row_newbcast:0 row_mask:0xf bank_mask:0xf
  v_dot2c_f32_bf16_dpp v22, v38, v63 row_newbcast:0 row_mask:0xf bank_mask:0xf
  v_dot2c_f32_bf16_dpp v23, v39, v63 row_newbcast:0 row_mask:0xf bank_mask:0xf
  s_waitcnt vmcnt(5)
  buffer_load_dwordx4 v[56:59], v2, s[48:51], s72 offen offset:3072 nt
  s_add_u32 s72, s72, 16384
  v_dot2c_f32_bf16_dpp v16, v38, v64 row_newbcast:4 row_mask:0xf bank_mask:0xf
  v_dot2c_f32_bf16_dpp v17, v39, v64 row_newbcast:4 row_mask:0xf bank_mask:0xf
  v_dot2c_f32_bf16_dpp v18, v38, v65 row_newbcast:4 row_mask:0xf bank_mask:0xf
  v_dot2c_f32_bf16_dpp v19, v39, v65 row_newbcast:4 row_mask:0xf bank_mask:0xf
  v_dot2c_f32_bf16_dpp v20, v38, v66 row_newbcast:4 row_mask:0xf bank_mask:0xf
  v_dot2c_f32_bf16_dpp v21, v39, v66 row_newbcast:4 row_mask:0xf bank_mask:0xf
  v_dot2c_f32_bf16_dpp v22, v38, v67 row_newbcast:4 row_mask:0xf bank_mask:0xf
  v_dot2c_f32_bf16_dpp v23, v39, v67 row_newbcast:4 row_mask:0xf bank_mask:0xf
  s_waitcnt vmcnt(5)
  buffer_load_dwordx4 v[60:63], v2, s[48:51], s72 offen offset:0 nt
  v_add_u32 v42, 1, v42
  ds_write_b32 v41, v42
  v_dot2c_f32_bf16_dpp v16, v38, v68 row_newbcast:8 row_mask:0xf bank_mask:0xf
  v_dot2c_f32_bf16_dpp v17, v39, v68 row_newbcast:8 row_mask:0xf bank_mask:0xf
  v_dot2c_f32_bf16_dpp v18, v38, v69 row_newbcast:8 row_mask:0xf bank_mask:0xf
  v_dot2c_f32_bf16_dpp v19, v39, v69 row_newbcast:8 row_mask:0xf bank_mask:0xf
  v_dot2c_f32_bf16_dpp v20, v38, v70 row_newbcast:8 row_mask:0xf bank_mask:0xf
  v_dot2c_f32_bf16_dpp v21, v39, v70 row_newbcast:8 row_mask:0xf bank_mask:0xf
  v_dot2c_f32_bf16_dpp v22, v38, v71 row_newbcast:8 row_mask:0xf bank_mask:0xf
  v_dot2c_f32_bf16_dpp v23, v39, v71 row_newbcast:8 row_mask:0xf bank_mask:0xf
  s_waitcnt vmcnt(5)
  buffer_load_dwordx4 v[64:67], v2, s[48:51], s72 offen offset:1024 nt
  v_dot2c_f32_bf16_dpp v16, v38, v72 row_newbcast:12 row_mask:0xf bank_mask:0xf
  v_dot2c_f32_bf16_dpp v17, v39, v72 row_newbcast:12 row_mask:0xf bank_mask:0xf
  v_dot2c_f32_bf16_dpp v18, v38, v73 row_newbcast:12 row_mask:0xf bank_mask:0xf
  v_dot2c_f32_bf16_dpp v19, v39, v73 row_newbcast:12 row_mask:0xf bank_mask:0xf
  v_dot2c_f32_bf16_dpp v20, v38, v74 row_newbcast:12 row_mask:0xf bank_mask:0xf
  v_dot2c_f32_bf16_dpp v21, v39, v74 row_newbcast:12 row_mask:0xf bank_mask:0xf
  v_dot2c_f32_bf16_dpp v22, v38, v75 row_newbcast:12 row_mask:0xf bank_mask:0xf
  v_dot2c_f32_bf16_dpp v23, v39, v75 row_newbcast:12 row_mask:0xf bank_mask:0xf
  s_sub_u32 s73, s73, 1
  s_cmp_lg_u32 s73, 0
  s_nop 4
  s_cbranch_scc1 L_vh6
L_vD:
  s_waitcnt vmcnt(5)
  v_add_u32 v42, 1, v42
  ds_write_b32 v41, v42
  s_waitcnt lgkmcnt(0)
  v_sub_f32 v34, v36, v24
  v_sub_f32 v35, v37, v24
  ds_read_b64 v[36:37], v25
  v_add_u32 v25, 128, v25
  v_mul_f32 v34, s75, v34
  v_mul_f32 v35, s75, v35
  v_exp_f32 v34, v34
  v_exp_f32 v35, v35
  v_add_f32 v33, v33, v34
  v_add_f32 v33, v33, v35
  v_cvt_pk_bf16_f32 v38, v34, 0
  v_cvt_pk_bf16_f32 v39, 0, v34
  s_nop 0
  v_dot2c_f32_bf16_dpp v16, v38, v44 row_newbcast:0 row_mask:0xf bank_mask:0xf
  v_dot2c_f32_bf16_dpp v17, v39, v44 row_newbcast:0 row_mask:0xf bank_mask:0xf
  v_dot2c_f32_bf16_dpp v18, v38, v45 row_newbcast:0 row_mask:0xf bank_mask:0xf
  v_dot2c_f32_bf16_dpp v19, v39, v45 row_newbcast:0 row_mask:0xf bank_mask:0xf
  v_dot2c_f32_bf16_dpp v20, v38, v46 row_newbcast:0 row_mask:0xf bank_mask:0xf
  v_dot2c_f32_bf16_dpp v21, v39, v46 row_newbcast:0 row_mask:0xf bank_mask:0xf
  v_dot2c_f32_bf16_dpp v22, v38, v47 row_newbcast:0 row_mask:0xf bank_mask:0xf
  v_dot2c_f32_bf16_dpp v23, v39, v47 row_newbcast:0 row_mask:0xf bank_mask:0xf
  s_waitcnt vmcnt(4)
  buffer_load_dwordx4 v[68:71], v2, s[48:51], s72 offen offset:2048 nt
  v_dot2c_f32_bf16_dpp v16, v38, v48 row_newbcast:4 row_mask:0xf bank_mask:0xf
  v_dot2c_f32_bf16_dpp v17, v39, v48 row_newbcast:4 row_mask:0xf bank_mask:0xf
  v_dot2c_f32_bf16_dpp v18, v38, v49 row_newbcast:4 row_mask:0xf bank_mask:0xf
  v_dot2c_f32_bf16_dpp v19, v39, v49 row_newbcast:4 row_mask:0xf bank_mask:0xf
  v_dot2c_f32_bf16_dpp v20, v38, v50 row_newbcast:4 row_mask:0xf bank_mask:0xf
  v_dot2c_f32_bf16_dpp v21, v39, v50 row_newbcast:4 row_mask:0xf bank_mask:0xf
  v_dot2c_f32_bf16_dpp v22, v38, v51 row_newbcast:4 row_mask:0xf bank_mask:0xf
  v_dot2c_f32_bf16_dpp v23, v39, v51 row_newbcast:4 row_mask:0xf bank_mask:0xf
  s_waitcnt vmcnt(4)
  buffer_load_dwordx4 v[72:75], v2, s[48:51], s72 offen offset:3072 nt
  s_add_u32 s72, s72, 16384
  buffer_load_dwordx4 v[44:47], v2, s[48:51], s72 offen offset:0 nt
  v_add_u32 v42, 1, v42
  ds_write_b32 v41, v42
  v_dot2c_f32_bf16_dpp v16, v38, v52 row_newbcast:8 row_mask:0xf bank_mask:0xf
  v_dot2c_f32_bf16_dpp v17, v39, v52 row_newbcast:8 row_mask:0xf bank_mask:0xf
  v_dot2c_f32_bf16_dpp v18, v38, v53 row_newbcast:8 row_mask:0xf bank_mask:0xf
  v_dot2c_f32_bf16_dpp v19, v39, v53 row_newbcast:8 row_mask:0xf bank_mask:0xf
  v_dot2c_f32_bf16_dpp v20, v38, v54 row_newbcast:8 row_mask:0xf bank_mask:0xf
  v_dot2c_f32_bf16_dpp v21, v39, v54 row_newbcast:8 row_mask:0xf bank_mask:0xf
  v_dot2c_f32_bf16_dpp v22, v38, v55 row_newbcast:8 row_mask:0xf bank_mask:0xf
  v_dot2c_f32_bf16_dpp v23, v39, v55 row_newbcast:8 row_mask:0xf bank_mask:0xf
  s_waitcnt vmcnt(5)
  v_dot2c_f32_bf16_dpp v16, v38, v56 row_newbcast:12 row_mask:0xf bank_mask:0xf
  v_dot2c_f32_bf16_dpp v17, v39, v56 row_newbcast:12 row_mask:0xf bank_mask:0xf
  v_dot2c_f32_bf16_dpp v18, v38, v57 row_newbcast:12 row_mask:0xf bank_mask:0xf
  v_dot2c_f32_bf16_dpp v19, v39, v57 row_newbcast:12 row_mask:0xf bank_mask:0xf
  v_dot2c_f32_bf16_dpp v20, v38, v58 row_newbcast:12 row_mask:0xf bank_mask:0xf
  v_dot2c_f32_bf16_dpp v21, v39, v58 row_newbcast:12 row_mask:0xf bank_mask:0xf
  v_dot2c_f32_bf16_dpp v22, v38, v59 row_newbcast:12 row_mask:0xf bank_mask:0xf
  v_dot2c_f32_bf16_dpp v23, v39, v59 row_newbcast:12 row_mask:0xf bank_mask:0xf
  s_waitcnt vmcnt(4)
  buffer_load_dwordx4 v[48:51], v2, s[48:51], s72 offen offset:1024 nt
  v_add_u32 v42, 1, v42
  ds_write_b32 v41, v42
  v_cvt_pk_bf16_f32 v38, v35, 0
  v_cvt_pk_bf16_f32 v39, 0, v35
  s_nop 0
  v_dot2c_f32_bf16_dpp v16, v38, v60 row_newbcast:0 row_mask:0xf bank_mask:0xf
  v_dot2c_f32_bf16_dpp v17, v39, v60 row_newbcast:0 row_mask:0xf bank_mask:0xf
  v_dot2c_f32_bf16_dpp v18, v38, v61 row_newbcast:0 row_mask:0xf bank_mask:0xf
  v_dot2c_f32_bf16_dpp v19, v39, v61 row_newbcast:0 row_mask:0xf bank_mask:0xf
  v_dot2c_f32_bf16_dpp v20, v38, v62 row_newbcast:0 row_mask:0xf bank_mask:0xf
  v_dot2c_f32_bf16_dpp v21, v39, v62 row_newbcast:0 row_mask:0xf bank_mask:0xf
  v_dot2c_f32_bf16_dpp v22, v38, v63 row_newbcast:0 row_mask:0xf bank_mask:0xf
  v_dot2c_f32_bf16_dpp v23, v39, v63 row_newbcast:0 row_mask:0xf bank_mask:0xf
  s_waitcnt vmcnt(4)
  buffer_load_dwordx4 v[52:55], v2, s[48:51], s72 offen offset:2048 nt
  v_dot2c_f32_bf16_dpp v16, v38, v64 row_newbcast:4 row_mask:0xf bank_mask:0xf
  v_dot2c_f32_bf16_dpp v17, v39, v64 row_newbcast:4 row_mask:0xf bank_mask:0xf
  v_dot2c_f32_bf16_dpp v18, v38, v65 row_newbcast:4 row_mask:0xf bank_mask:0xf
  v_dot2c_f32_bf16_dpp v19, v39, v65 row_newbcast:4 row_mask:0xf bank_mask:0xf
  v_dot2c_f32_bf16_dpp v20, v38, v66 row_newbcast:4 row_mask:0xf bank_mask:0xf
  v_dot2c_f32_bf16_dpp v21, v39, v66 row_newbcast:4 row_mask:0xf bank_mask:0xf
  v_dot2c_f32_bf16_dpp v22, v38, v67 row_newbcast:4 row_mask:0xf bank_mask:0xf
  v_dot2c_f32_bf16_dpp v23, v39, v67 row_newbcast:4 row_mask:0xf bank_mask:0xf
  s_waitcnt vmcnt(4)
  buffer_load_dwordx4 v[56:59], v2, s[48:51], s72 offen offset:3072 nt
  s_add_u32 s72, s72, 16384
  buffer_load_dwordx4 v[60:63], v2, s[48:51], s72 offen offset:0 nt
  v_add_u32 v42, 1, v42
  ds_write_b32 v41, v42
  v_dot2c_f32_bf16_dpp v16, v38, v68 row_newbcast:8 row_mask:0xf bank_mask:0xf
  v_dot2c_f32_bf16_dpp v17, v39, v68 row_newbcast:8 row_mask:0xf bank_mask:0xf
  v_dot2c_f32_bf16_dpp v18, v38, v69 row_newbcast:8 row_mask:0xf bank_mask:0xf
  v_dot2c_f32_bf16_dpp v19, v39, v69 row_newbcast:8 row_mask:0xf bank_mask:0xf
  v_dot2c_f32_bf16_dpp v20, v38, v70 row_newbcast:8 row_mask:0xf bank_mask:0xf
  v_dot2c_f32_bf16_dpp v21, v39, v70 row_newbcast:8 row_mask:0xf bank_mask:0xf
  v_dot2c_f32_bf16_dpp v22, v38, v71 row_newbcast:8 row_mask:0xf bank_mask:0xf
  v_dot2c_f32_bf16_dpp v23, v39, v71 row_newbcast:8 row_mask:0xf bank_mask:0xf
  s_waitcnt vmcnt(5)
  v_dot2c_f32_bf16_dpp v16, v38, v72 row_newbcast:12 row_mask:0xf bank_mask:0xf
  v_dot2c_f32_bf16_dpp v17, v39, v72 row_newbcast:12 row_mask:0xf bank_mask:0xf
  v_dot2c_f32_bf16_dpp v18, v38, v73 row_newbcast:12 row_mask:0xf bank_mask:0xf
  v_dot2c_f32_bf16_dpp v19, v39, v73 row_newbcast:12 row_mask:0xf bank_mask:0xf
  v_dot2c_f32_bf16_dpp v20, v38, v74 row_newbcast:12 row_mask:0xf bank_mask:0xf
  v_dot2c_f32_bf16_dpp v21, v39, v74 row_newbcast:12 row_mask:0xf bank_mask:0xf
  v_dot2c_f32_bf16_dpp v22, v38, v75 row_newbcast:12 row_mask:0xf bank_mask:0xf
  v_dot2c_f32_bf16_dpp v23, v39, v75 row_newbcast:12 row_mask:0xf bank_mask:0xf
  s_sub_u32 s73, s73, 1
  s_cmp_lg_u32 s73, 0
  s_nop 4
  s_cbranch_scc1 L_vh5
  s_branch L_vexit
L_vexit:
  s_waitcnt vmcnt(4)
  buffer_load_dwordx4 v[64:67], v2, s[48:51], s72 offen offset:1024 nt
  v_add_u32 v42, 1, v42
  ds_write_b32 v41, v42
  s_waitcnt lgkmcnt(0)
  v_sub_f32 v34, v36, v24
  v_sub_f32 v35, v37, v24
  ds_read_b64 v[36:37], v25
  v_add_u32 v25, 128, v25
  v_mul_f32 v34, s75, v34
  v_mul_f32 v35, s75, v35
  v_exp_f32 v34, v34
  v_exp_f32 v35, v35
  v_add_f32 v33, v33, v34
  v_add_f32 v33, v33, v35
  v_cvt_pk_bf16_f32 v38, v34, 0
  v_cvt_pk_bf16_f32 v39, 0, v34
  s_nop 0
  v_dot2c_f32_bf16_dpp v16, v38, v44 row_newbcast:0 row_mask:0xf bank_mask:0xf
  v_dot2c_f32_bf16_dpp v17, v39, v44 row_newbcast:0 row_mask:0xf bank_mask:0xf
  v_dot2c_f32_bf16_dpp v18, v38, v45 row_newbcast:0 row_mask:0xf bank_mask:0xf
  v_dot2c_f32_bf16_dpp v19, v39, v45 row_newbcast:0 row_mask:0xf bank_mask:0xf
  v_dot2c_f32_bf16_dpp v20, v38, v46 row_newbcast:0 row_mask:0xf bank_mask:0xf
  v_dot2c_f32_bf16_dpp v21, v39, v46 row_newbcast:0 row_mask:0xf bank_mask:0xf
  v_dot2c_f32_bf16_dpp v22, v38, v47 row_newbcast:0 row_mask:0xf bank_mask:0xf
  v_dot2c_f32_bf16_dpp v23, v39, v47 row_newbcast:0 row_mask:0xf bank_mask:0xf
  s_waitcnt vmcnt(4)
  buffer_load_dwordx4 v[68:71], v2, s[48:51], s72 offen offset:2048 nt
  v_dot2c_f32_bf16_dpp v16, v38, v48 row_newbcast:4 row_mask:0xf bank_mask:0xf
  v_dot2c_f32_bf16_dpp v17, v39, v48 row_newbcast:4 row_mask:0xf bank_mask:0xf
  v_dot2c_f32_bf16_dpp v18, v38, v49 row_newbcast:4 row_mask:0xf bank_mask:0xf
  v_dot2c_f32_bf16_dpp v19, v39, v49 row_newbcast:4 row_mask:0xf bank_mask:0xf
  v_dot2c_f32_bf16_dpp v20, v38, v50 row_newbcast:4 row_mask:0xf bank_mask:0xf
  v_dot2c_f32_bf16_dpp v21, v39, v50 row_newbcast:4 row_mask:0xf bank_mask:0xf
  v_dot2c_f32_bf16_dpp v22, v38, v51 row_newbcast:4 row_mask:0xf bank_mask:0xf
  v_dot2c_f32_bf16_dpp v23, v39, v51 row_newbcast:4 row_mask:0xf bank_mask:0xf
  s_waitcnt vmcnt(4)
  buffer_load_dwordx4 v[72:75], v2, s[48:51], s72 offen offset:3072 nt
  s_add_u32 s72, s72, 16384
  buffer_load_dwordx4 v[44:47], v2, s[48:51], s72 offen offset:0 nt
  v_add_u32 v42, 1, v42
  ds_write_b32 v41, v42
  v_dot2c_f32_bf16_dpp v16, v38, v52 row_newbcast:8 row_mask:0xf bank_mask:0xf
  v_dot2c_f32_bf16_dpp v17, v39, v52 row_newbcast:8 row_mask:0xf bank_mask:0xf
  v_dot2c_f32_bf16_dpp v18, v38, v53 row_newbcast:8 row_mask:0xf bank_mask:0xf
  v_dot2c_f32_bf16_dpp v19, v39, v53 row_newbcast:8 row_mask:0xf bank_mask:0xf
  v_dot2c_f32_bf16_dpp v20, v38, v54 row_newbcast:8 row_mask:0xf bank_mask:0xf
  v_dot2c_f32_bf16_dpp v21, v39, v54 row_newbcast:8 row_mask:0xf bank_mask:0xf
  v_dot2c_f32_bf16_dpp v22, v38, v55 row_newbcast:8 row_mask:0xf bank_mask:0xf
  v_dot2c_f32_bf16_dpp v23, v39, v55 row_newbcast:8 row_mask:0xf bank_mask:0xf
  s_waitcnt vmcnt(5)
  v_dot2c_f32_bf16_dpp v16, v38, v56 row_newbcast:12 row_mask:0xf bank_mask:0xf
  v_dot2c_f32_bf16_dpp v17, v39, v56 row_newbcast:12 row_mask:0xf bank_mask:0xf
  v_dot2c_f32_bf16_dpp v18, v38, v57 row_newbcast:12 row_mask:0xf bank_mask:0xf
  v_dot2c_f32_bf16_dpp v19, v39, v57 row_newbcast:12 row_mask:0xf bank_mask:0xf
  v_dot2c_f32_bf16_dpp v20, v38, v58 row_newbcast:12 row_mask:0xf bank_mask:0xf
  v_dot2c_f32_bf16_dpp v21, v39, v58 row_newbcast:12 row_mask:0xf bank_mask:0xf
  v_dot2c_f32_bf16_dpp v22, v38, v59 row_newbcast:12 row_mask:0xf bank_mask:0xf
  v_dot2c_f32_bf16_dpp v23, v39, v59 row_newbcast:12 row_mask:0xf bank_mask:0xf
  s_waitcnt vmcnt(4)
  buffer_load_dwordx4 v[48:51], v2, s[48:51], s72 offen offset:1024 nt
  v_add_u32 v42, 1, v42
  ds_write_b32 v41, v42
  v_cvt_pk_bf16_f32 v38, v35, 0
  v_cvt_pk_bf16_f32 v39, 0, v35
  s_nop 0
  v_dot2c_f32_bf16_dpp v16, v38, v60 row_newbcast:0 row_mask:0xf bank_mask:0xf
  v_dot2c_f32_bf16_dpp v17, v39, v60 row_newbcast:0 row_mask:0xf bank_mask:0xf
  v_dot2c_f32_bf16_dpp v18, v38, v61 row_newbcast:0 row_mask:0xf bank_mask:0xf
  v_dot2c_f32_bf16_dpp v19, v39, v61 row_newbcast:0 row_mask:0xf bank_mask:0xf
  v_dot2c_f32_bf16_dpp v20, v38, v62 row_newbcast:0 row_mask:0xf bank_mask:0xf
  v_dot2c_f32_bf16_dpp v21, v39, v62 row_newbcast:0 row_mask:0xf bank_mask:0xf
  v_dot2c_f32_bf16_dpp v22, v38, v63 row_newbcast:0 row_mask:0xf bank_mask:0xf
  v_dot2c_f32_bf16_dpp v23, v39, v63 row_newbcast:0 row_mask:0xf bank_mask:0xf
  s_waitcnt vmcnt(4)
  buffer_load_dwordx4 v[52:55], v2, s[48:51], s72 offen offset:2048 nt
  v_dot2c_f32_bf16_dpp v16, v38, v64 row_newbcast:4 row_mask:0xf bank_mask:0xf
  v_dot2c_f32_bf16_dpp v17, v39, v64 row_newbcast:4 row_mask:0xf bank_mask:0xf
  v_dot2c_f32_bf16_dpp v18, v38, v65 row_newbcast:4 row_mask:0xf bank_mask:0xf
  v_dot2c_f32_bf16_dpp v19, v39, v65 row_newbcast:4 row_mask:0xf bank_mask:0xf
  v_dot2c_f32_bf16_dpp v20, v38, v66 row_newbcast:4 row_mask:0xf bank_mask:0xf
  v_dot2c_f32_bf16_dpp v21, v39, v66 row_newbcast:4 row_mask:0xf bank_mask:0xf
  v_dot2c_f32_bf16_dpp v22, v38, v67 row_newbcast:4 row_mask:0xf bank_mask:0xf
  v_dot2c_f32_bf16_dpp v23, v39, v67 row_newbcast:4 row_mask:0xf bank_mask:0xf
  s_waitcnt vmcnt(4)
  buffer_load_dwordx4 v[56:59], v2, s[48:51], s72 offen offset:3072 nt
  s_add_u32 s72, s72, 16384
  buffer_load_dwordx4 v[60:63], v2, s[48:51], s72 offen offset:0 nt
  v_add_u32 v42, 1, v42
  ds_write_b32 v41, v42
  v_dot2c_f32_bf16_dpp v16, v38, v68 row_newbcast:8 row_mask:0xf bank_mask:0xf
  v_dot2c_f32_bf16_dpp v17, v39, v68 row_newbcast:8 row_mask:0xf bank_mask:0xf
  v_dot2c_f32_bf16_dpp v18, v38, v69 row_newbcast:8 row_mask:0xf bank_mask:0xf
  v_dot2c_f32_bf16_dpp v19, v39, v69 row_newbcast:8 row_mask:0xf bank_mask:0xf
  v_dot2c_f32_bf16_dpp v20, v38, v70 row_newbcast:8 row_mask:0xf bank_mask:0xf
  v_dot2c_f32_bf16_dpp v21, v39, v70 row_newbcast:8 row_mask:0xf bank_mask:0xf
  v_dot2c_f32_bf16_dpp v22, v38, v71 row_newbcast:8 row_mask:0xf bank_mask:0xf
  v_dot2c_f32_bf16_dpp v23, v39, v71 row_newbcast:8 row_mask:0xf bank_mask:0xf
  s_waitcnt vmcnt(5)
  v_dot2c_f32_bf16_dpp v16, v38, v72 row_newbcast:12 row_mask:0xf bank_mask:0xf
  v_dot2c_f32_bf16_dpp v17, v39, v72 row_newbcast:12 row_mask:0xf bank_mask:0xf
  v_dot2c_f32_bf16_dpp v18, v38, v73 row_newbcast:12 row_mask:0xf bank_mask:0xf
  v_dot2c_f32_bf16_dpp v19, v39, v73 row_newbcast:12 row_mask:0xf bank_mask:0xf
  v_dot2c_f32_bf16_dpp v20, v38, v74 row_newbcast:12 row_mask:0xf bank_mask:0xf
  v_dot2c_f32_bf16_dpp v21, v39, v74 row_newbcast:12 row_mask:0xf bank_mask:0xf
  v_dot2c_f32_bf16_dpp v22, v38, v75 row_newbcast:12 row_mask:0xf bank_mask:0xf
  v_dot2c_f32_bf16_dpp v23, v39, v75 row_newbcast:12 row_mask:0xf bank_mask:0xf
  s_waitcnt vmcnt(4)
  buffer_load_dwordx4 v[64:67], v2, s[48:51], s72 offen offset:1024 nt
  v_add_u32 v42, 1, v42
  ds_write_b32 v41, v42
  s_waitcnt lgkmcnt(0)
  v_sub_f32 v34, v36, v24
  v_sub_f32 v35, v37, v24
  ds_read_b64 v[36:37], v25
  v_add_u32 v25, 128, v25
  v_mul_f32 v34, s75, v34
  v_mul_f32 v35, s75, v35
  v_exp_f32 v34, v34
  v_exp_f32 v35, v35
  v_add_f32 v33, v33, v34
  v_add_f32 v33, v33, v35
  v_cvt_pk_bf16_f32 v38, v34, 0
  v_cvt_pk_bf16_f32 v39, 0, v34
  s_nop 0
  v_dot2c_f32_bf16_dpp v16, v38, v44 row_newbcast:0 row_mask:0xf bank_mask:0xf
  v_dot2c_f32_bf16_dpp v17, v39, v44 row_newbcast:0 row_mask:0xf bank_mask:0xf
  v_dot2c_f32_bf16_dpp v18, v38, v45 row_newbcast:0 row_mask:0xf bank_mask:0xf
  v_dot2c_f32_bf16_dpp v19, v39, v45 row_newbcast:0 row_mask:0xf bank_mask:0xf
  v_dot2c_f32_bf16_dpp v20, v38, v46 row_newbcast:0 row_mask:0xf bank_mask:0xf
  v_dot2c_f32_bf16_dpp v21, v39, v46 row_newbcast:0 row_mask:0xf bank_mask:0xf
  v_dot2c_f32_bf16_dpp v22, v38, v47 row_newbcast:0 row_mask:0xf bank_mask:0xf
  v_dot2c_f32_bf16_dpp v23, v39, v47 row_newbcast:0 row_mask:0xf bank_mask:0xf
  s_waitcnt vmcnt(4)
  buffer_load_dwordx4 v[68:71], v2, s[48:51], s72 offen offset:2048 nt
  v_dot2c_f32_bf16_dpp v16, v38, v48 row_newbcast:4 row_mask:0xf bank_mask:0xf
  v_dot2c_f32_bf16_dpp v17, v39, v48 row_newbcast:4 row_mask:0xf bank_mask:0xf
  v_dot2c_f32_bf16_dpp v18, v38, v49 row_newbcast:4 row_mask:0xf bank_mask:0xf
  v_dot2c_f32_bf16_dpp v19, v39, v49 row_newbcast:4 row_mask:0xf bank_mask:0xf
  v_dot2c_f32_bf16_dpp v20, v38, v50 row_newbcast:4 row_mask:0xf bank_mask:0xf
  v_dot2c_f32_bf16_dpp v21, v39, v50 row_newbcast:4 row_mask:0xf bank_mask:0xf
  v_dot2c_f32_bf16_dpp v22, v38, v51 row_newbcast:4 row_mask:0xf bank_mask:0xf
  v_dot2c_f32_bf16_dpp v23, v39, v51 row_newbcast:4 row_mask:0xf bank_mask:0xf
  s_waitcnt vmcnt(4)
  buffer_load_dwordx4 v[72:75], v2, s[48:51], s72 offen offset:3072 nt
  s_add_u32 s72, s72, 16384
  buffer_load_dwordx4 v[44:47], v2, s[48:51], s72 offen offset:0 nt
  v_add_u32 v42, 1, v42
  ds_write_b32 v41, v42
  v_dot2c_f32_bf16_dpp v16, v38, v52 row_newbcast:8 row_mask:0xf bank_mask:0xf
  v_dot2c_f32_bf16_dpp v17, v39, v52 row_newbcast:8 row_mask:0xf bank_mask:0xf
  v_dot2c_f32_bf16_dpp v18, v38, v53 row_newbcast:8 row_mask:0xf bank_mask:0xf
  v_dot2c_f32_bf16_dpp v19, v39, v53 row_newbcast:8 row_mask:0xf bank_mask:0xf
  v_dot2c_f32_bf16_dpp v20, v38, v54 row_newbcast:8 row_mask:0xf bank_mask:0xf
  v_dot2c_f32_bf16_dpp v21, v39, v54 row_newbcast:8 row_mask:0xf bank_mask:0xf
  v_dot2c_f32_bf16_dpp v22, v38, v55 row_newbcast:8 row_mask:0xf bank_mask:0xf
  v_dot2c_f32_bf16_dpp v23, v39, v55 row_newbcast:8 row_mask:0xf bank_mask:0xf
  s_waitcnt vmcnt(5)
  v_dot2c_f32_bf16_dpp v16, v38, v56 row_newbcast:12 row_mask:0xf bank_mask:0xf
  v_dot2c_f32_bf16_dpp v17, v39, v56 row_newbcast:12 row_mask:0xf bank_mask:0xf
  v_dot2c_f32_bf16_dpp v18, v38, v57 row_newbcast:12 row_mask:0xf bank_mask:0xf
  v_dot2c_f32_bf16_dpp v19, v39, v57 row_newbcast:12 row_mask:0xf bank_mask:0xf
  v_dot2c_f32_bf16_dpp v20, v38, v58 row_newbcast:12 row_mask:0xf bank_mask:0xf
  v_dot2c_f32_bf16_dpp v21, v39, v58 row_newbcast:12 row_mask:0xf bank_mask:0xf
  v_dot2c_f32_bf16_dpp v22, v38, v59 row_newbcast:12 row_mask:0xf bank_mask:0xf
  v_dot2c_f32_bf16_dpp v23, v39, v59 row_newbcast:12 row_mask:0xf bank_mask:0xf
  s_waitcnt vmcnt(4)
  buffer_load_dwordx4 v[48:51], v2, s[48:51], s72 offen offset:1024 nt
  v_add_u32 v42, 1, v42
  ds_write_b32 v41, v42
  v_cvt_pk_bf16_f32 v38, v35, 0
  v_cvt_pk_bf16_f32 v39, 0, v35
  s_nop 0
  v_dot2c_f32_bf16_dpp v16, v38, v60 row_newbcast:0 row_mask:0xf bank_mask:0xf
  v_dot2c_f32_bf16_dpp v17, v39, v60 row_newbcast:0 row_mask:0xf bank_mask:0xf
  v_dot2c_f32_bf16_dpp v18, v38, v61 row_newbcast:0 row_mask:0xf bank_mask:0xf
  v_dot2c_f32_bf16_dpp v19, v39, v61 row_newbcast:0 row_mask:0xf bank_mask:0xf
  v_dot2c_f32_bf16_dpp v20, v38, v62 row_newbcast:0 row_mask:0xf bank_mask:0xf
  v_dot2c_f32_bf16_dpp v21, v39, v62 row_newbcast:0 row_mask:0xf bank_mask:0xf
  v_dot2c_f32_bf16_dpp v22, v38, v63 row_newbcast:0 row_mask:0xf bank_mask:0xf
  v_dot2c_f32_bf16_dpp v23, v39, v63 row_newbcast:0 row_mask:0xf bank_mask:0xf
  s_waitcnt vmcnt(4)
  buffer_load_dwordx4 v[52:55], v2, s[48:51], s72 offen offset:2048 nt
  v_dot2c_f32_bf16_dpp v16, v38, v64 row_newbcast:4 row_mask:0xf bank_mask:0xf
  v_dot2c_f32_bf16_dpp v17, v39, v64 row_newbcast:4 row_mask:0xf bank_mask:0xf
  v_dot2c_f32_bf16_dpp v18, v38, v65 row_newbcast:4 row_mask:0xf bank_mask:0xf
  v_dot2c_f32_bf16_dpp v19, v39, v65 row_newbcast:4 row_mask:0xf bank_mask:0xf
  v_dot2c_f32_bf16_dpp v20, v38, v66 row_newbcast:4 row_mask:0xf bank_mask:0xf
  v_dot2c_f32_bf16_dpp v21, v39, v66 row_newbcast:4 row_mask:0xf bank_mask:0xf
  v_dot2c_f32_bf16_dpp v22, v38, v67 row_newbcast:4 row_mask:0xf bank_mask:0xf
  v_dot2c_f32_bf16_dpp v23, v39, v67 row_newbcast:4 row_mask:0xf bank_mask:0xf
  s_waitcnt vmcnt(4)
  buffer_load_dwordx4 v[56:59], v2, s[48:51], s72 offen offset:3072 nt
  s_add_u32 s72, s72, 16384
  buffer_load_dwordx4 v[60:63], v2, s[48:51], s72 offen offset:0 nt
  v_add_u32 v42, 1, v42
  ds_write_b32 v41, v42
  v_dot2c_f32_bf16_dpp v16, v38, v68 row_newbcast:8 row_mask:0xf bank_mask:0xf
  v_dot2c_f32_bf16_dpp v17, v39, v68 row_newbcast:8 row_mask:0xf bank_mask:0xf
  v_dot2c_f32_bf16_dpp v18, v38, v69 row_newbcast:8 row_mask:0xf bank_mask:0xf
  v_dot2c_f32_bf16_dpp v19, v39, v69 row_newbcast:8 row_mask:0xf bank_mask:0xf
  v_dot2c_f32_bf16_dpp v20, v38, v70 row_newbcast:8 row_mask:0xf bank_mask:0xf
  v_dot2c_f32_bf16_dpp v21, v39, v70 row_newbcast:8 row_mask:0xf bank_mask:0xf
  v_dot2c_f32_bf16_dpp v22, v38, v71 row_newbcast:8 row_mask:0xf bank_mask:0xf
  v_dot2c_f32_bf16_dpp v23, v39, v71 row_newbcast:8 row_mask:0xf bank_mask:0xf
  s_waitcnt vmcnt(5)
  buffer_load_dwordx4 v[64:67], v2, s[48:51], s72 offen offset:1024 nt
  buffer_load_dwordx4 v[68:71], v2, s[48:51], s72 offen offset:2048 nt
  v_dot2c_f32_bf16_dpp v16, v38, v72 row_newbcast:12 row_mask:0xf bank_mask:0xf
  v_dot2c_f32_bf16_dpp v17, v39, v72 row_newbcast:12 row_mask:0xf bank_mask:0xf
  v_dot2c_f32_bf16_dpp v18, v38, v73 row_newbcast:12 row_mask:0xf bank_mask:0xf
  v_dot2c_f32_bf16_dpp v19, v39, v73 row_newbcast:12 row_mask:0xf bank_mask:0xf
  v_dot2c_f32_bf16_dpp v20, v38, v74 row_newbcast:12 row_mask:0xf bank_mask:0xf
  v_dot2c_f32_bf16_dpp v21, v39, v74 row_newbcast:12 row_mask:0xf bank_mask:0xf
  v_dot2c_f32_bf16_dpp v22, v38, v75 row_newbcast:12 row_mask:0xf bank_mask:0xf
  v_dot2c_f32_bf16_dpp v23, v39, v75 row_newbcast:12 row_mask:0xf bank_mask:0xf
  s_waitcnt vmcnt(6)
  buffer_load_dwordx4 v[72:75], v2, s[48:51], s72 offen offset:3072 nt
  s_add_u32 s72, s72, 16384
  v_add_u32 v42, 1, v42
  ds_write_b32 v41, v42
  s_waitcnt lgkmcnt(0)
  v_sub_f32 v34, v36, v24
  v_sub_f32 v35, v37, v24
  ds_read_b64 v[36:37], v25
  v_add_u32 v25, 128, v25
  v_mul_f32 v34, s75, v34
  v_mul_f32 v35, s75, v35
  v_exp_f32 v34, v34
  v_exp_f32 v35, v35
  v_add_f32 v33, v33, v34
  v_add_f32 v33, v33, v35
  v_cvt_pk_bf16_f32 v38, v34, 0
  v_cvt_pk_bf16_f32 v39, 0, v34
  s_nop 0
  v_dot2c_f32_bf16_dpp v16, v38, v44 row_newbcast:0 row_mask:0xf bank_mask:0xf
  v_dot2c_f32_bf16_dpp v17, v39, v44 row_newbcast:0 row_mask:0xf bank_mask:0xf
  v_dot2c_f32_bf16_dpp v18, v38, v45 row_newbcast:0 row_mask:0xf bank_mask:0xf
  v_dot2c_f32_bf16_dpp v19, v39, v45 row_newbcast:0 row_mask:0xf bank_mask:0xf
  v_dot2c_f32_bf16_dpp v20, v38, v46 row_newbcast:0 row_mask:0xf bank_mask:0xf
  v_dot2c_f32_bf16_dpp v21, v39, v46 row_newbcast:0 row_mask:0xf bank_mask:0xf
  v_dot2c_f32_bf16_dpp v22, v38, v47 row_newbcast:0 row_mask:0xf bank_mask:0xf
  v_dot2c_f32_bf16_dpp v23, v39, v47 row_newbcast:0 row_mask:0xf bank_mask:0xf
  s_waitcnt vmcnt(6)
  buffer_load_dwordx4 v[44:47], v2, s[48:51], s72 offen offset:0 nt
  v_dot2c_f32_bf16_dpp v16, v38, v48 row_newbcast:4 row_mask:0xf bank_mask:0xf
  v_dot2c_f32_bf16_dpp v17, v39, v48 row_newbcast:4 row_mask:0xf bank_mask:0xf
  v_dot2c_f32_bf16_dpp v18, v38, v49 row_newbcast:4 row_mask:0xf bank_mask:0xf
  v_dot2c_f32_bf16_dpp v19, v39, v49 row_newbcast:4 row_mask:0xf bank_mask:0xf
  v_dot2c_f32_bf16_dpp v20, v38, v50 row_newbcast:4 row_mask:0xf bank_mask:0xf
  v_dot2c_f32_bf16_dpp v21, v39, v50 row_newbcast:4 row_mask:0xf bank_mask:0xf
  v_dot2c_f32_bf16_dpp v22, v38, v51 row_newbcast:4 row_mask:0xf bank_mask:0xf
  v_dot2c_f32_bf16_dpp v23, v39, v51 row_newbcast:4 row_mask:0xf bank_mask:0xf
  s_waitcnt vmcnt(6)
  buffer_load_dwordx4 v[48:51], v2, s[48:51], s72 offen offset:1024 nt
  v_add_u32 v42, 1, v42
  ds_write_b32 v41, v42
  v_dot2c_f32_bf16_dpp v16, v38, v52 row_newbcast:8 row_mask:0xf bank_mask:0xf
  v_dot2c_f32_bf16_dpp v17, v39, v52 row_newbcast:8 row_mask:0xf bank_mask:0xf
  v_dot2c_f32_bf16_dpp v18, v38, v53 row_newbcast:8 row_mask:0xf bank_mask:0xf
  v_dot2c_f32_bf16_dpp v19, v39, v53 row_newbcast:8 row_mask:0xf bank_mask:0xf
  v_dot2c_f32_bf16_dpp v20, v38, v54 row_newbcast:8 row_mask:0xf bank_mask:0xf
  v_dot2c_f32_bf16_dpp v21, v39, v54 row_newbcast:8 row_mask:0xf bank_mask:0xf
  v_dot2c_f32_bf16_dpp v22, v38, v55 row_newbcast:8 row_mask:0xf bank_mask:0xf
  v_dot2c_f32_bf16_dpp v23, v39, v55 row_newbcast:8 row_mask:0xf bank_mask:0xf
  s_waitcnt vmcnt(6)
  buffer_load_dwordx4 v[52:55], v2, s[48:51], s72 offen offset:2048 nt
  v_dot2c_f32_bf16_dpp v16, v38, v56 row_newbcast:12 row_mask:0xf bank_mask:0xf
  v_dot2c_f32_bf16_dpp v17, v39, v56 row_newbcast:12 row_mask:0xf bank_mask:0xf
  v_dot2c_f32_bf16_dpp v18, v38, v57 row_newbcast:12 row_mask:0xf bank_mask:0xf
  v_dot2c_f32_bf16_dpp v19, v39, v57 row_newbcast:12 row_mask:0xf bank_mask:0xf
  v_dot2c_f32_bf16_dpp v20, v38, v58 row_newbcast:12 row_mask:0xf bank_mask:0xf
  v_dot2c_f32_bf16_dpp v21, v39, v58 row_newbcast:12 row_mask:0xf bank_mask:0xf
  v_dot2c_f32_bf16_dpp v22, v38, v59 row_newbcast:12 row_mask:0xf bank_mask:0xf
  v_dot2c_f32_bf16_dpp v23, v39, v59 row_newbcast:12 row_mask:0xf bank_mask:0xf
  s_waitcnt vmcnt(6)
  buffer_load_dwordx4 v[56:59], v2, s[48:51], s72 offen offset:3072 nt
  s_add_u32 s72, s72, 16384
  v_add_u32 v42, 1, v42
  ds_write_b32 v41, v42
  v_cvt_pk_bf16_f32 v38, v35, 0
  v_cvt_pk_bf16_f32 v39, 0, v35
  s_nop 0
  v_dot2c_f32_bf16_dpp v16, v38, v60 row_newbcast:0 row_mask:0xf bank_mask:0xf
  v_dot2c_f32_bf16_dpp v17, v39, v60 row_newbcast:0 row_mask:0xf bank_mask:0xf
  v_dot2c_f32_bf16_dpp v18, v38, v61 row_newbcast:0 row_mask:0xf bank_mask:0xf
  v_dot2c_f32_bf16_dpp v19, v39, v61 row_newbcast:0 row_mask:0xf bank_mask:0xf
  v_dot2c_f32_bf16_dpp v20, v38, v62 row_newbcast:0 row_mask:0xf bank_mask:0xf
  v_dot2c_f32_bf16_dpp v21, v39, v62 row_newbcast:0 row_mask:0xf bank_mask:0xf
  v_dot2c_f32_bf16_dpp v22, v38, v63 row_newbcast:0 row_mask:0xf bank_mask:0xf
  v_dot2c_f32_bf16_dpp v23, v39, v63 row_newbcast:0 row_mask:0xf bank_mask:0xf
  s_waitcnt vmcnt(6)
  buffer_load_dwordx4 v[60:63], v2, s[48:51], s72 offen offset:0 nt
  v_dot2c_f32_bf16_dpp v16, v38, v64 row_newbcast:4 row_mask:0xf bank_mask:0xf
  v_dot2c_f32_bf16_dpp v17, v39, v64 row_newbcast:4 row_mask:0xf bank_mask:0xf
  v_dot2c_f32_bf16_dpp v18, v38, v65 row_newbcast:4 row_mask:0xf bank_mask:0xf
  v_dot2c_f32_bf16_dpp v19, v39, v65 row_newbcast:4 row_mask:0xf bank_mask:0xf
  v_dot2c_f32_bf16_dpp v20, v38, v66 row_newbcast:4 row_mask:0xf bank_mask:0xf
  v_dot2c_f32_bf16_dpp v21, v39, v66 row_newbcast:4 row_mask:0xf bank_mask:0xf
  v_dot2c_f32_bf16_dpp v22, v38, v67 row_newbcast:4 row_mask:0xf bank_mask:0xf
  v_dot2c_f32_bf16_dpp v23, v39, v67 row_newbcast:4 row_mask:0xf bank_mask:0xf
  s_waitcnt vmcnt(6)
  buffer_load_dwordx4 v[64:67], v2, s[48:51], s72 offen offset:1024 nt
  v_add_u32 v42, 1, v42
  ds_write_b32 v41, v42
  v_dot2c_f32_bf16_dpp v16, v38, v68 row_newbcast:8 row_mask:0xf bank_mask:0xf
  v_dot2c_f32_bf16_dpp v17, v39, v68 row_newbcast:8 row_mask:0xf bank_mask:0xf
  v_dot2c_f32_bf16_dpp v18, v38, v69 row_newbcast:8 row_mask:0xf bank_mask:0xf
  v_dot2c_f32_bf16_dpp v19, v39, v69 row_newbcast:8 row_mask:0xf bank_mask:0xf
  v_dot2c_f32_bf16_dpp v20, v38, v70 row_newbcast:8 row_mask:0xf bank_mask:0xf
  v_dot2c_f32_bf16_dpp v21, v39, v70 row_newbcast:8 row_mask:0xf bank_mask:0xf
  v_dot2c_f32_bf16_dpp v22, v38, v71 row_newbcast:8 row_mask:0xf bank_mask:0xf
  v_dot2c_f32_bf16_dpp v23, v39, v71 row_newbcast:8 row_mask:0xf bank_mask:0xf
  s_waitcnt vmcnt(6)
  buffer_load_dwordx4 v[68:71], v2, s[48:51], s72 offen offset:2048 nt
  v_dot2c_f32_bf16_dpp v16, v38, v72 row_newbcast:12 row_mask:0xf bank_mask:0xf
  v_dot2c_f32_bf16_dpp v17, v39, v72 row_newbcast:12 row_mask:0xf bank_mask:0xf
  v_dot2c_f32_bf16_dpp v18, v38, v73 row_newbcast:12 row_mask:0xf bank_mask:0xf
  v_dot2c_f32_bf16_dpp v19, v39, v73 row_newbcast:12 row_mask:0xf bank_mask:0xf
  v_dot2c_f32_bf16_dpp v20, v38, v74 row_newbcast:12 row_mask:0xf bank_mask:0xf
  v_dot2c_f32_bf16_dpp v21, v39, v74 row_newbcast:12 row_mask:0xf bank_mask:0xf
  v_dot2c_f32_bf16_dpp v22, v38, v75 row_newbcast:12 row_mask:0xf bank_mask:0xf
  v_dot2c_f32_bf16_dpp v23, v39, v75 row_newbcast:12 row_mask:0xf bank_mask:0xf
  s_mov_b32 s73, 2
  s_nop 4
L_tloop:
  s_waitcnt vmcnt(6)
  buffer_load_dwordx4 v[72:75], v2, s[48:51], s72 offen offset:3072 nt
  s_add_u32 s72, s72, 16384
  v_add_u32 v42, 1, v42
  ds_write_b32 v41, v42
  s_waitcnt lgkmcnt(0)
  v_sub_f32 v34, v36, v24
  v_sub_f32 v35, v37, v24
  ds_read_b64 v[36:37], v25
  v_add_u32 v25, 128, v25
  v_mul_f32 v34, s75, v34
  v_mul_f32 v35, s75, v35
  v_exp_f32 v34, v34
  v_exp_f32 v35, v35
  v_add_f32 v33, v33, v34
  v_add_f32 v33, v33, v35
  v_cvt_pk_bf16_f32 v38, v34, 0
  v_cvt_pk_bf16_f32 v39, 0, v34
  s_nop 0
  v_dot2c_f32_bf16_dpp v16, v38, v44 row_newbcast:0 row_mask:0xf bank_mask:0xf
  v_dot2c_f32_bf16_dpp v17, v39, v44 row_newbcast:0 row_mask:0xf bank_mask:0xf
  v_dot2c_f32_bf16_dpp v18, v38, v45 row_newbcast:0 row_mask:0xf bank_mask:0xf
  v_dot2c_f32_bf16_dpp v19, v39, v45 row_newbcast:0 row_mask:0xf bank_mask:0xf
  v_dot2c_f32_bf16_dpp v20, v38, v46 row_newbcast:0 row_mask:0xf bank_mask:0xf
  v_dot2c_f32_bf16_dpp v21, v39, v46 row_newbcast:0 row_mask:0xf bank_mask:0xf
  v_dot2c_f32_bf16_dpp v22, v38, v47 row_newbcast:0 row_mask:0xf bank_mask:0xf
  v_dot2c_f32_bf16_dpp v23, v39, v47 row_newbcast:0 row_mask:0xf bank_mask:0xf
  s_waitcnt vmcnt(6)
  buffer_load_dwordx4 v[44:47], v2, s[48:51], s72 offen offset:0 nt
  v_dot2c_f32_bf16_dpp v16, v38, v48 row_newbcast:4 row_mask:0xf bank_mask:0xf
  v_dot2c_f32_bf16_dpp v17, v39, v48 row_newbcast:4 row_mask:0xf bank_mask:0xf
  v_dot2c_f32_bf16_dpp v18, v38, v49 row_newbcast:4 row_mask:0xf bank_mask:0xf
  v_dot2c_f32_bf16_dpp v19, v39, v49 row_newbcast:4 row_mask:0xf bank_mask:0xf
  v_dot2c_f32_bf16_dpp v20, v38, v50 row_newbcast:4 row_mask:0xf bank_mask:0xf
  v_dot2c_f32_bf16_dpp v21, v39, v50 row_newbcast:4 row_mask:0xf bank_mask:0xf
  v_dot2c_f32_bf16_dpp v22, v38, v51 row_newbcast:4 row_mask:0xf bank_mask:0xf
  v_dot2c_f32_bf16_dpp v23, v39, v51 row_newbcast:4 row_mask:0xf bank_mask:0xf
  s_waitcnt vmcnt(6)
  buffer_load_dwordx4 v[48:51], v2, s[48:51], s72 offen offset:1024 nt
  v_add_u32 v42, 1, v42
  ds_write_b32 v41, v42
  v_dot2c_f32_bf16_dpp v16, v38, v52 row_newbcast:8 row_mask:0xf bank_mask:0xf
  v_dot2c_f32_bf16_dpp v17, v39, v52 row_newbcast:8 row_mask:0xf bank_mask:0xf
  v_dot2c_f32_bf16_dpp v18, v38, v53 row_newbcast:8 row_mask:0xf bank_mask:0xf
  v_dot2c_f32_bf16_dpp v19, v39, v53 row_newbcast:8 row_mask:0xf bank_mask:0xf
  v_dot2c_f32_bf16_dpp v20, v38, v54 row_newbcast:8 row_mask:0xf bank_mask:0xf
  v_dot2c_f32_bf16_dpp v21, v39, v54 row_newbcast:8 row_mask:0xf bank_mask:0xf
  v_dot2c_f32_bf16_dpp v22, v38, v55 row_newbcast:8 row_mask:0xf bank_mask:0xf
  v_dot2c_f32_bf16_dpp v23, v39, v55 row_newbcast:8 row_mask:0xf bank_mask:0xf
  s_waitcnt vmcnt(6)
  buffer_load_dwordx4 v[52:55], v2, s[48:51], s72 offen offset:2048 nt
  v_dot2c_f32_bf16_dpp v16, v38, v56 row_newbcast:12 row_mask:0xf bank_mask:0xf
  v_dot2c_f32_bf16_dpp v17, v39, v56 row_newbcast:12 row_mask:0xf bank_mask:0xf
  v_dot2c_f32_bf16_dpp v18, v38, v57 row_newbcast:12 row_mask:0xf bank_mask:0xf
  v_dot2c_f32_bf16_dpp v19, v39, v57 row_newbcast:12 row_mask:0xf bank_mask:0xf
  v_dot2c_f32_bf16_dpp v20, v38, v58 row_newbcast:12 row_mask:0xf bank_mask:0xf
  v_dot2c_f32_bf16_dpp v21, v39, v58 row_newbcast:12 row_mask:0xf bank_mask:0xf
  v_dot2c_f32_bf16_dpp v22, v38, v59 row_newbcast:12 row_mask:0xf bank_mask:0xf
  v_dot2c_f32_bf16_dpp v23, v39, v59 row_newbcast:12 row_mask:0xf bank_mask:0xf
  s_waitcnt vmcnt(6)
  buffer_load_dwordx4 v[56:59], v2, s[48:51], s72 offen offset:3072 nt
  s_add_u32 s72, s72, 16384
  v_add_u32 v42, 1, v42
  ds_write_b32 v41, v42
  v_cvt_pk_bf16_f32 v38, v35, 0
  v_cvt_pk_bf16_f32 v39, 0, v35
  s_nop 0
  v_dot2c_f32_bf16_dpp v16, v38, v60 row_newbcast:0 row_mask:0xf bank_mask:0xf
  v_dot2c_f32_bf16_dpp v17, v39, v60 row_newbcast:0 row_mask:0xf bank_mask:0xf
  v_dot2c_f32_bf16_dpp v18, v38, v61 row_newbcast:0 row_mask:0xf bank_mask:0xf
  v_dot2c_f32_bf16_dpp v19, v39, v61 row_newbcast:0 row_mask:0xf bank_mask:0xf
  v_dot2c_f32_bf16_dpp v20, v38, v62 row_newbcast:0 row_mask:0xf bank_mask:0xf
  v_dot2c_f32_bf16_dpp v21, v39, v62 row_newbcast:0 row_mask:0xf bank_mask:0xf
  v_dot2c_f32_bf16_dpp v22, v38, v63 row_newbcast:0 row_mask:0xf bank_mask:0xf
  v_dot2c_f32_bf16_dpp v23, v39, v63 row_newbcast:0 row_mask:0xf bank_mask:0xf
  s_waitcnt vmcnt(6)
  buffer_load_dwordx4 v[60:63], v2, s[48:51], s72 offen offset:0 nt
  v_dot2c_f32_bf16_dpp v16, v38, v64 row_newbcast:4 row_mask:0xf bank_mask:0xf
  v_dot2c_f32_bf16_dpp v17, v39, v64 row_newbcast:4 row_mask:0xf bank_mask:0xf
  v_dot2c_f32_bf16_dpp v18, v38, v65 row_newbcast:4 row_mask:0xf bank_mask:0xf
  v_dot2c_f32_bf16_dpp v19, v39, v65 row_newbcast:4 row_mask:0xf bank_mask:0xf
  v_dot2c_f32_bf16_dpp v20, v38, v66 row_newbcast:4 row_mask:0xf bank_mask:0xf
  v_dot2c_f32_bf16_dpp v21, v39, v66 row_newbcast:4 row_mask:0xf bank_mask:0xf
  v_dot2c_f32_bf16_dpp v22, v38, v67 row_newbcast:4 row_mask:0xf bank_mask:0xf
  v_dot2c_f32_bf16_dpp v23, v39, v67 row_newbcast:4 row_mask:0xf bank_mask:0xf
  s_waitcnt vmcnt(6)
  buffer_load_dwordx4 v[64:67], v2, s[48:51], s72 offen offset:1024 nt
  v_add_u32 v42, 1, v42
  ds_write_b32 v41, v42
  v_dot2c_f32_bf16_dpp v16, v38, v68 row_newbcast:8 row_mask:0xf bank_mask:0xf
  v_dot2c_f32_bf16_dpp v17, v39, v68 row_newbcast:8 row_mask:0xf bank_mask:0xf
  v_dot2c_f32_bf16_dpp v18, v38, v69 row_newbcast:8 row_mask:0xf bank_mask:0xf
  v_dot2c_f32_bf16_dpp v19, v39, v69 row_newbcast:8 row_mask:0xf bank_mask:0xf
  v_dot2c_f32_bf16_dpp v20, v38, v70 row_newbcast:8 row_mask:0xf bank_mask:0xf
  v_dot2c_f32_bf16_dpp v21, v39, v70 row_newbcast:8 row_mask:0xf bank_mask:0xf
  v_dot2c_f32_bf16_dpp v22, v38, v71 row_newbcast:8 row_mask:0xf bank_mask:0xf
  v_dot2c_f32_bf16_dpp v23, v39, v71 row_newbcast:8 row_mask:0xf bank_mask:0xf
  s_waitcnt vmcnt(6)
  buffer_load_dwordx4 v[68:71], v2, s[48:51], s72 offen offset:2048 nt
  v_dot2c_f32_bf16_dpp v16, v38, v72 row_newbcast:12 row_mask:0xf bank_mask:0xf
  v_dot2c_f32_bf16_dpp v17, v39, v72 row_newbcast:12 row_mask:0xf bank_mask:0xf
  v_dot2c_f32_bf16_dpp v18, v38, v73 row_newbcast:12 row_mask:0xf bank_mask:0xf
  v_dot2c_f32_bf16_dpp v19, v39, v73 row_newbcast:12 row_mask:0xf bank_mask:0xf
  v_dot2c_f32_bf16_dpp v20, v38, v74 row_newbcast:12 row_mask:0xf bank_mask:0xf
  v_dot2c_f32_bf16_dpp v21, v39, v74 row_newbcast:12 row_mask:0xf bank_mask:0xf
  v_dot2c_f32_bf16_dpp v22, v38, v75 row_newbcast:12 row_mask:0xf bank_mask:0xf
  v_dot2c_f32_bf16_dpp v23, v39, v75 row_newbcast:12 row_mask:0xf bank_mask:0xf
  s_sub_u32 s73, s73, 1
  s_cmp_lg_u32 s73, 0
  s_nop 4
  s_cbranch_scc1 L_tloop
  s_waitcnt vmcnt(6)
  buffer_load_dwordx4 v[72:75], v2, s[48:51], s72 offen offset:3072 nt
  s_add_u32 s72, s72, 16384
  v_add_u32 v42, 1, v42
  ds_write_b32 v41, v42
  s_waitcnt lgkmcnt(0)
  v_sub_f32 v34, v36, v24
  v_sub_f32 v35, v37, v24
  ds_read_b64 v[36:37], v25
  v_add_u32 v25, 128, v25
  v_mul_f32 v34, s75, v34
  v_mul_f32 v35, s75, v35
  v_exp_f32 v34, v34
  v_exp_f32 v35, v35
  v_add_f32 v33, v33, v34
  v_add_f32 v33, v33, v35
  v_cvt_pk_bf16_f32 v38, v34, 0
  v_cvt_pk_bf16_f32 v39, 0, v34
  s_nop 0
  v_dot2c_f32_bf16_dpp v16, v38, v44 row_newbcast:0 row_mask:0xf bank_mask:0xf
  v_dot2c_f32_bf16_dpp v17, v39, v44 row_newbcast:0 row_mask:0xf bank_mask:0xf
  v_dot2c_f32_bf16_dpp v18, v38, v45 row_newbcast:0 row_mask:0xf bank_mask:0xf
  v_dot2c_f32_bf16_dpp v19, v39, v45 row_newbcast:0 row_mask:0xf bank_mask:0xf
  v_dot2c_f32_bf16_dpp v20, v38, v46 row_newbcast:0 row_mask:0xf bank_mask:0xf
  v_dot2c_f32_bf16_dpp v21, v39, v46 row_newbcast:0 row_mask:0xf bank_mask:0xf
  v_dot2c_f32_bf16_dpp v22, v38, v47 row_newbcast:0 row_mask:0xf bank_mask:0xf
  v_dot2c_f32_bf16_dpp v23, v39, v47 row_newbcast:0 row_mask:0xf bank_mask:0xf
  s_waitcnt vmcnt(6)
  v_dot2c_f32_bf16_dpp v16, v38, v48 row_newbcast:4 row_mask:0xf bank_mask:0xf
  v_dot2c_f32_bf16_dpp v17, v39, v48 row_newbcast:4 row_mask:0xf bank_mask:0xf
  v_dot2c_f32_bf16_dpp v18, v38, v49 row_newbcast:4 row_mask:0xf bank_mask:0xf
  v_dot2c_f32_bf16_dpp v19, v39, v49 row_newbcast:4 row_mask:0xf bank_mask:0xf
  v_dot2c_f32_bf16_dpp v20, v38, v50 row_newbcast:4 row_mask:0xf bank_mask:0xf
  v_dot2c_f32_bf16_dpp v21, v39, v50 row_newbcast:4 row_mask:0xf bank_mask:0xf
  v_dot2c_f32_bf16_dpp v22, v38, v51 row_newbcast:4 row_mask:0xf bank_mask:0xf
  v_dot2c_f32_bf16_dpp v23, v39, v51 row_newbcast:4 row_mask:0xf bank_mask:0xf
  s_waitcnt vmcnt(5)
  v_add_u32 v42, 1, v42
  ds_write_b32 v41, v42
  v_dot2c_f32_bf16_dpp v16, v38, v52 row_newbcast:8 row_mask:0xf bank_mask:0xf
  v_dot2c_f32_bf16_dpp v17, v39, v52 row_newbcast:8 row_mask:0xf bank_mask:0xf
  v_dot2c_f32_bf16_dpp v18, v38, v53 row_newbcast:8 row_mask:0xf bank_mask:0xf
  v_dot2c_f32_bf16_dpp v19, v39, v53 row_newbcast:8 row_mask:0xf bank_mask:0xf
  v_dot2c_f32_bf16_dpp v20, v38, v54 row_newbcast:8 row_mask:0xf bank_mask:0xf
  v_dot2c_f32_bf16_dpp v21, v39, v54 row_newbcast:8 row_mask:0xf bank_mask:0xf
  v_dot2c_f32_bf16_dpp v22, v38, v55 row_newbcast:8 row_mask:0xf bank_mask:0xf
  v_dot2c_f32_bf16_dpp v23, v39, v55 row_newbcast:8 row_mask:0xf bank_mask:0xf
  s_waitcnt vmcnt(4)
  v_dot2c_f32_bf16_dpp v16, v38, v56 row_newbcast:12 row_mask:0xf bank_mask:0xf
  v_dot2c_f32_bf16_dpp v17, v39, v56 row_newbcast:12 row_mask:0xf bank_mask:0xf
  v_dot2c_f32_bf16_dpp v18, v38, v57 row_newbcast:12 row_mask:0xf bank_mask:0xf
  v_dot2c_f32_bf16_dpp v19, v39, v57 row_newbcast:12 row_mask:0xf bank_mask:0xf
  v_dot2c_f32_bf16_dpp v20, v38, v58 row_newbcast:12 row_mask:0xf bank_mask:0xf
  v_dot2c_f32_bf16_dpp v21, v39, v58 row_newbcast:12 row_mask:0xf bank_mask:0xf
  v_dot2c_f32_bf16_dpp v22, v38, v59 row_newbcast:12 row_mask:0xf bank_mask:0xf
  v_dot2c_f32_bf16_dpp v23, v39, v59 row_newbcast:12 row_mask:0xf bank_mask:0xf
  s_waitcnt vmcnt(3)
  v_add_u32 v42, 1, v42
  ds_write_b32 v41, v42
  v_cvt_pk_bf16_f32 v38, v35, 0
  v_cvt_pk_bf16_f32 v39, 0, v35
  s_nop 0
  v_dot2c_f32_bf16_dpp v16, v38, v60 row_newbcast:0 row_mask:0xf bank_mask:0xf
  v_dot2c_f32_bf16_dpp v17, v39, v60 row_newbcast:0 row_mask:0xf bank_mask:0xf
  v_dot2c_f32_bf16_dpp v18, v38, v61 row_newbcast:0 row_mask:0xf bank_mask:0xf
  v_dot2c_f32_bf16_dpp v19, v39, v61 row_newbcast:0 row_mask:0xf bank_mask:0xf
  v_dot2c_f32_bf16_dpp v20, v38, v62 row_newbcast:0 row_mask:0xf bank_mask:0xf
  v_dot2c_f32_bf16_dpp v21, v39, v62 row_newbcast:0 row_mask:0xf bank_mask:0xf
  v_dot2c_f32_bf16_dpp v22, v38, v63 row_newbcast:0 row_mask:0xf bank_mask:0xf
  v_dot2c_f32_bf16_dpp v23, v39, v63 row_newbcast:0 row_mask:0xf bank_mask:0xf
  s_waitcnt vmcnt(2)
  v_dot2c_f32_bf16_dpp v16, v38, v64 row_newbcast:4 row_mask:0xf bank_mask:0xf
  v_dot2c_f32_bf16_dpp v17, v39, v64 row_newbcast:4 row_mask:0xf bank_mask:0xf
  v_dot2c_f32_bf16_dpp v18, v38, v65 row_newbcast:4 row_mask:0xf bank_mask:0xf
  v_dot2c_f32_bf16_dpp v19, v39, v65 row_newbcast:4 row_mask:0xf bank_mask:0xf
  v_dot2c_f32_bf16_dpp v20, v38, v66 row_newbcast:4 row_mask:0xf bank_mask:0xf
  v_dot2c_f32_bf16_dpp v21, v39, v66 row_newbcast:4 row_mask:0xf bank_mask:0xf
  v_dot2c_f32_bf16_dpp v22, v38, v67 row_newbcast:4 row_mask:0xf bank_mask:0xf
  v_dot2c_f32_bf16_dpp v23, v39, v67 row_newbcast:4 row_mask:0xf bank_mask:0xf
  s_waitcnt vmcnt(1)
  v_add_u32 v42, 1, v42
  ds_write_b32 v41, v42
  v_dot2c_f32_bf16_dpp v16, v38, v68 row_newbcast:8 row_mask:0xf bank_mask:0xf
  v_dot2c_f32_bf16_dpp v17, v39, v68 row_newbcast:8 row_mask:0xf bank_mask:0xf
  v_dot2c_f32_bf16_dpp v18, v38, v69 row_newbcast:8 row_mask:0xf bank_mask:0xf
  v_dot2c_f32_bf16_dpp v19, v39, v69 row_newbcast:8 row_mask:0xf bank_mask:0xf
  v_dot2c_f32_bf16_dpp v20, v38, v70 row_newbcast:8 row_mask:0xf bank_mask:0xf
  v_dot2c_f32_bf16_dpp v21, v39, v70 row_newbcast:8 row_mask:0xf bank_mask:0xf
  v_dot2c_f32_bf16_dpp v22, v38, v71 row_newbcast:8 row_mask:0xf bank_mask:0xf
  v_dot2c_f32_bf16_dpp v23, v39, v71 row_newbcast:8 row_mask:0xf bank_mask:0xf
  s_waitcnt vmcnt(0)
  v_dot2c_f32_bf16_dpp v16, v38, v72 row_newbcast:12 row_mask:0xf bank_mask:0xf
  v_dot2c_f32_bf16_dpp v17, v39, v72 row_newbcast:12 row_mask:0xf bank_mask:0xf
  v_dot2c_f32_bf16_dpp v18, v38, v73 row_newbcast:12 row_mask:0xf bank_mask:0xf
  v_dot2c_f32_bf16_dpp v19, v39, v73 row_newbcast:12 row_mask:0xf bank_mask:0xf
  v_dot2c_f32_bf16_dpp v20, v38, v74 row_newbcast:12 row_mask:0xf bank_mask:0xf
  v_dot2c_f32_bf16_dpp v21, v39, v74 row_newbcast:12 row_mask:0xf bank_mask:0xf
  v_dot2c_f32_bf16_dpp v22, v38, v75 row_newbcast:12 row_mask:0xf bank_mask:0xf
  v_dot2c_f32_bf16_dpp v23, v39, v75 row_newbcast:12 row_mask:0xf bank_mask:0xf
  v_add_f32_dpp v33, v33, v33 row_half_mirror row_mask:0xf bank_mask:0xf
  s_nop 1
  v_add_f32_dpp v33, v33, v33 row_mirror row_mask:0xf bank_mask:0xf
  v_mov_b32 v6, v33
  s_nop 1
  v_permlane16_swap_b32 v33, v6
  v_add_f32 v33, v33, v6
  v_mov_b32 v6, v33
  s_nop 1
  v_permlane32_swap_b32 v33, v6
  v_add_f32 v35, v33, v6
  v_mov_b32 v34, v24
  v_permlane32_swap_b32 v16, v17
  v_permlane32_swap_b32 v18, v19
  v_permlane32_swap_b32 v20, v21
  v_permlane32_swap_b32 v22, v23
  v_add_f32 v16, v16, v17
  v_add_f32 v18, v18, v19
  v_add_f32 v20, v20, v21
  v_add_f32 v22, v22, v23
  v_permlane16_swap_b32 v16, v18
  s_nop 0
  v_permlane16_swap_b32 v20, v22
  v_add_f32 v7, v16, v18
  v_add_f32 v8, v20, v22
  s_lshl_b32 s7, s79, 9
  v_add_u32 v5, s7, v11
  v_add_u32 v5, 3584, v5
  ds_write2_b32 v5, v7, v8 offset0:0 offset1:4
  s_lshl_b32 s7, s79, 3
  v_mov_b32 v5, s7
  ds_write_b64 v5, v[34:35] offset:3456
  s_waitcnt lgkmcnt(0)
  s_barrier
L_fin:
L_end:
  s_endpgm
L_probe:
  ds_read_b32 v14, v18 offset:3520
  v_lshrrev_b32 v17, 16, v16
  v_cmp_eq_u32 vcc, s11, v17
  v_and_b32 v16, 0xffff, v16
  s_nop 0
  v_cndmask_b32 v16, 0, v16, vcc
  s_nop 0
  s_bcnt1_i32_b64 s7, vcc
  v_add_u32_dpp v16, v16, v16 quad_perm:[1,0,3,2] row_mask:0xf bank_mask:0xf
  s_nop 1
  v_add_u32_dpp v16, v16, v16 quad_perm:[2,3,0,1] row_mask:0xf bank_mask:0xf
  s_nop 1
  v_add_u32_dpp v16, v16, v16 row_half_mirror row_mask:0xf bank_mask:0xf
  s_nop 1
  v_add_u32_dpp v16, v16, v16 row_mirror row_mask:0xf bank_mask:0xf
  v_mov_b32 v17, v16
  s_nop 1
  v_permlane16_swap_b32 v16, v17
  v_add_u32 v16, v16, v17
  v_mov_b32 v17, v16
  s_nop 1
  v_permlane32_swap_b32 v16, v17
  v_add_u32 v16, v16, v17
  s_nop 0
  v_readfirstlane_b32 s76, v16
  s_mul_i32 s13, s13, s7
  s_nop 2
  s_lshl_b32 s76, s76, 1
  s_sub_i32 s13, s13, s76
  s_mul_i32 s76, s7, 2
  s_mul_i32 s77, s7, 0
  s_mov_b32 s15, 0
  s_cmp_gt_i32 s13, s77
  s_cselect_b32 s15, 2, s15
  s_sub_i32 s76, 0, s76
  s_cmp_lt_i32 s13, s76
  s_cselect_b32 s15, 1, s15
  s_cmp_lt_u32 s7, 16
  s_cselect_b32 s15, 0, s15
  v_mov_b32 v17, s15
  ds_write_b32 v18, v17 offset:3536
  s_waitcnt lgkmcnt(0)
  s_mov_b32 s13, s14
  v_readfirstlane_b32 s14, v14
  s_nop 3
  s_add_u32 s13, s13, s14
  s_or_b32 s15, s12, s14
  v_mov_b32 v15, s15
  s_mov_b64 exec, 1
  global_store_dword v13, v15, s[40:41]
  s_mov_b64 exec, -1
  global_load_dword v16, v12, s[40:41] sc1
  s_nop 4
  s_setpc_b64 s[94:95]
.section .rodata,"a"
.p2align 6
.amdhsa_kernel parallel_sum__gqa_block_cached__mixer_channel_mlp__decode_kernel
  .amdhsa_next_free_vgpr 256
  .amdhsa_next_free_sgpr 102
  .amdhsa_accum_offset 256
  .amdhsa_group_segment_fixed_size 0
  .amdhsa_kernarg_size 104
  .amdhsa_user_sgpr_count 2
  .amdhsa_user_sgpr_kernarg_segment_ptr 1
  .amdhsa_system_sgpr_workgroup_id_x 1
  .amdhsa_float_denorm_mode_32 3
.end_amdhsa_kernel
```
